```python
import torch

def _softmax(x, axis=-1):
    return torch.softmax(x, dim=axis)
def _gelu(x):
    return torch.nn.functional.gelu(x, approximate="tanh")
def _silu(x):
    return torch.nn.functional.silu(x)
def _sigmoid(x):
    return torch.sigmoid(x)
def _layernorm(x, axis=-1, eps=1e-5):
    m = x.mean(dim=axis, keepdim=True)
    v = x.var(dim=axis, keepdim=True, unbiased=False)
    return (x - m) / torch.sqrt(v + eps)
def _scatter_add(tgt, idx, src, axis=0):
    return tgt.clone().index_add_(axis, idx, src)
def _segment_sum(src, seg, n):
    out = torch.zeros((n,) + src.shape[1:], dtype=src.dtype)
    return out.index_add_(0, seg, src)
def _pad(x, pw):
    flat = tuple(v for pair in reversed(pw) for v in pair)
    return torch.nn.functional.pad(x, flat)

kernel_name = 'parallel_sum__spectral_fnet__dense_activation_relu__prompt'

def setup_inputs():

    _w = (lambda a: (lambda t: t.to(torch.bfloat16) if t.is_floating_point() else t)(torch.as_tensor(a)))
    def _A_setup():
        B, S, D = 1, 2048, 1024
        ns = torch.arange(S)[:, None] * torch.arange(S)[None, :]
        nd = torch.arange(D)[:, None] * torch.arange(D)[None, :]
        Ws_re = torch.cos(-2.0 * torch.pi * ns / S).to(float)
        Ws_im = torch.sin(-2.0 * torch.pi * ns / S).to(float)
        Wd_re = torch.cos(-2.0 * torch.pi * nd / D).to(float)
        Wd_im = torch.sin(-2.0 * torch.pi * nd / D).to(float)
        return {
            "x": _w((lambda *s: torch.randn(*s, dtype=torch.bfloat16) * 0.05)(B, S, D)),
            "dft_seq_re": _w(Ws_re),
            "dft_seq_im": _w(Ws_im),
            "dft_hid_re": _w(Wd_re),
            "dft_hid_im": _w(Wd_im),
        }
    _A_in = _A_setup()

    def _B_setup():
        B, S, D, Dff = 1, 2048, 1024, 3584
        return {
            "x": _w((lambda *s: torch.randn(*s, dtype=torch.bfloat16) * 0.05)(B, S, D)),
            "w1": _w((lambda *s: torch.randn(*s, dtype=torch.bfloat16) * 0.4)(D, Dff)),
            "w2": _w((lambda *s: torch.randn(*s, dtype=torch.bfloat16) * 0.4)(Dff, D)),
        }
    _B_in = _B_setup()

    return {
        "A_x": _A_in["x"],
        "A_dft_seq_re": _A_in["dft_seq_re"],
        "A_dft_seq_im": _A_in["dft_seq_im"],
        "A_dft_hid_re": _A_in["dft_hid_re"],
        "A_dft_hid_im": _A_in["dft_hid_im"],
        "B_x": _B_in["x"],
        "B_w1": _B_in["w1"],
        "B_w2": _B_in["w2"],
    }

def reference(A_x, A_dft_seq_re, A_dft_seq_im, A_dft_hid_re, A_dft_hid_im, B_x, B_w1, B_w2):
    def _A_ref(x, dft_seq_re, dft_seq_im, dft_hid_re, dft_hid_im):
        a = torch.einsum("bsd,ed->bse", x, dft_hid_re)
        b = torch.einsum("bsd,ed->bse", x, dft_hid_im)
        y = torch.einsum("ts,bse->bte", dft_seq_re, a) - torch.einsum("ts,bse->bte", dft_seq_im, b)
        return y

    def _B_ref(x, w1, w2):
        h = torch.einsum("bsd,df->bsf", x, w1)
        zero = torch.zeros_like(h)
        h = torch.maximum(h, zero)
        return torch.einsum("bsf,fd->bsd", h, w2)

    x = A_x
    xn = _layernorm(x, axis=-1)
    return x + _A_ref(xn, A_dft_seq_re, A_dft_seq_im, A_dft_hid_re, A_dft_hid_im) + _B_ref(xn, B_w1, B_w2)
```

```asm
; @launch kernel=pk_kernel grid=(256,1,1) block=(512,1,1) lds=163840
.amdgcn_target "amdgcn-amd-amdhsa--gfx950"
.text
.globl pk_kernel
.p2align 8
.type pk_kernel,@function
pk_kernel:
    s_cmp_ge_u32 s2, 256
    s_cbranch_scc1 L_end
    s_load_dwordx2 s[4:5], s[0:1], 0
    s_load_dwordx4 s[88:91], s[0:1], 48
    s_load_dwordx2 s[6:7], s[0:1], 80
    s_load_dwordx4 s[8:11], s[0:1], 8
    s_load_dwordx4 s[12:15], s[0:1], 24
    s_load_dwordx4 s[92:95], s[0:1], 64
    v_lshrrev_b32 v1, 6, v0
    s_and_b32 s33, s2, 3
    v_readfirstlane_b32 s32, v1
    s_bfe_u32 s34, s2, 0x10002
    v_and_b32 v1, 63, v0
    s_bfe_u32 s35, s2, 0x20003
    s_lshr_b32 s36, s2, 5
    s_and_b32 s37, s2, 31
    s_lshr_b32 s3, s2, 7
    s_xor_b32 s3, s3, s2
    s_and_b32 s3, s3, 1
    s_waitcnt lgkmcnt(0)
    s_mov_b32 s20, s88
    s_and_b32 s21, s89, 0xffff
    s_mov_b32 s22, 7340032
    s_mov_b32 s23, 0x00020000
    s_mov_b32 s16, s4
    s_and_b32 s17, s5, 0xffff
    s_mov_b32 s18, 4194304
    s_mov_b32 s19, 0x00020000
    s_mov_b32 s24, s6
    s_and_b32 s25, s7, 0xffff
    s_mov_b32 s26, 268435456
    s_mov_b32 s27, 0x00020000
    s_mov_b32 s68, s90
    s_and_b32 s69, s91, 0xffff
    s_mov_b32 s70, 7340032
    s_mov_b32 s71, 0x00020000
    s_mov_b32 s64, s94
    s_and_b32 s65, s95, 0xffff
    s_mov_b32 s66, 256
    s_mov_b32 s67, 0x00020000
    s_mov_b32 s72, s92
    s_and_b32 s73, s93, 0xffff
    s_mov_b32 s74, 4194304
    s_mov_b32 s75, 0x00020000
    s_mov_b32 s76, s8
    s_and_b32 s77, s9, 0xffff
    s_mov_b32 s78, 8388608
    s_mov_b32 s79, 0x00020000
    s_mov_b32 s80, s10
    s_and_b32 s81, s11, 0xffff
    s_mov_b32 s82, 8388608
    s_mov_b32 s83, 0x00020000
    s_cmp_eq_u32 s36, 0
    s_cbranch_scc1 L_special
    s_cmp_ge_u32 s32, 4
    s_cbranch_scc1 L_prod
    s_setprio 1
    s_lshr_b32 s40, s32, 1
    s_and_b32 s41, s32, 1
    v_and_b32 v2, 15, v1
    v_lshrrev_b32 v3, 4, v1
    s_lshl_b32 s38, s40, 12
    s_lshl_b32 s39, s41, 12
    v_lshlrev_b32 v20, 4, v1
    v_bfe_u32 v4, v1, 2, 2
    v_lshl_add_u32 v5, v3, 3, v4
    v_lshlrev_b32 v5, 8, v5
    v_and_b32 v6, 1, v3
    v_lshl_add_u32 v4, v6, 2, v4
    s_lshl_b32 s84, s41, 1
    v_xor_b32 v4, s84, v4
    v_lshl_add_u32 v5, v4, 5, v5
    v_and_b32 v4, 3, v1
    v_lshl_add_u32 v12, v4, 3, v5
    v_xor_b32 v13, 32, v12
    v_xor_b32 v14, 128, v12
    v_xor_b32 v15, 160, v12
    v_lshrrev_b32 v4, 1, v2
    v_xor_b32 v4, v3, v4
    v_lshl_add_u32 v5, v2, 7, s38
    v_lshl_add_u32 v8, v4, 4, v5
    v_xor_b32 v9, 64, v8
    v_add_u32 v10, s38, v20
    v_add_u32 v11, s39, v20
    s_lshl_b32 s84, s40, 9
    s_add_u32 s84, s84, 147456
    v_lshl_add_u32 v18, v2, 5, s84
    s_lshl_b32 s84, s32, 11
    v_and_b32 v4, 7, v1
    v_lshl_add_u32 v4, v3, 3, v4
    v_lshl_add_u32 v4, v4, 4, s84
    v_xor_b32 v16, 4096, v4
    v_add_u32 v19, 151552, v4
    v_add_u32 v16, 151552, v16
    v_mov_b32 v44, 0x3f803f80
    v_mov_b32 v45, 0x3f803f80
    v_mov_b32 v46, 0x3f803f80
    v_mov_b32 v47, 0x3f803f80
    s_lshl_b32 s53, s40, 13
    s_lshl_b32 s54, s40, 6
    v_xor_b32 v12, s53, v12
    v_xor_b32 v13, s53, v13
    v_xor_b32 v14, s53, v14
    v_xor_b32 v15, s53, v15
    v_xor_b32 v8, s54, v8
    v_xor_b32 v9, s54, v9
    v_xor_b32 v24, 8192, v12
    v_xor_b32 v25, 8192, v13
    v_xor_b32 v26, 8192, v14
    v_xor_b32 v27, 8192, v15
    s_lshl_b32 s84, s34, 2
    s_add_u32 s84, s84, s35
    s_mul_i32 s84, s84, 56
    s_mul_i32 s85, s33, 7
    s_add_u32 s84, s84, s85
    s_add_u32 s84, s84, s36
    s_sub_u32 s84, s84, 1
    s_lshl_b32 s42, s84, 15
    s_add_u32 s42, s42, s38
    s_lshl_b32 s84, s41, 10
    s_add_u32 s42, s42, s84
    s_lshl_b32 s84, s40, 5
    v_add_u32 v4, s84, v2
    s_lshr_b32 s84, s33, 1
    s_lshl_b32 s84, s84, 6
    v_xor_b32 v4, s84, v4
    s_lshl_b32 s84, s35, 8
    s_add_u32 s84, s84, s34
    v_lshl_add_u32 v4, v4, 1, s84
    v_bfrev_b32 v5, 1
    v_cmp_eq_u32 vcc, 0, v4
    s_nop 1
    v_cndmask_b32 v22, 0, v5, vcc
    v_cmp_eq_u32 vcc, 128, v4
    s_nop 1
    v_cndmask_b32 v23, 0, v5, vcc
    s_and_b32 s84, s32, 3
    s_lshl2_add_u32 s84, s35, s84
    s_lshl1_add_u32 s84, s84, s34
    s_mul_i32 s84, s84, 8
    v_lshrrev_b32 v2, 1, v1
    v_add_u32 v2, s84, v2
    v_mul_u32_u24 v2, 7168, v2
    v_and_b32 v3, 1, v1
    v_lshl_add_u32 v2, v3, 7, v2
    v_add_u32 v3, 48, v1
    v_lshrrev_b32 v3, 6, v3
    v_lshl_add_u32 v28, v3, 30, v2
    s_mul_i32 s55, s33, 0
    s_mul_i32 s85, s33, 7
    s_add_u32 s85, s85, s36
    s_sub_u32 s85, s85, 1
    s_lshl_b32 s85, s85, 8
    v_add_u32 v28, s85, v28
    s_and_b32 s55, s55, 1023
    s_mul_i32 s85, s55, 7168
    s_add_u32 s55, s55, 256
    buffer_load_dword v43, v28, s[20:23], s85 offen
    s_sub_u32 s84, s36, 1
    s_lshl2_add_u32 s84, s84, s33
    s_lshl2_add_u32 s84, s84, s32
    v_lshrrev_b32 v2, 2, v1
    v_mul_u32_u24 v2, 112, v2
    v_add_u32 v4, s84, v2
    v_and_b32 v2, 127, v4
    s_lshl_b32 s85, s35, 8
    s_add_u32 s85, s85, s34
    v_lshl_add_u32 v2, v2, 1, s85
    v_sub_u32 v3, 2048, v2
    v_and_b32 v3, 2047, v3
    v_cmp_lt_u32 vcc, 127, v4
    s_nop 1
    v_cndmask_b32 v2, v2, v3, vcc
    v_and_b32 v3, 3, v1
    v_lshlrev_b32 v3, 7, v3
    v_lshl_add_u32 v2, v2, 11, v3
    v_lshrrev_b32 v3, 8, v4
    v_min_u32 v3, 1, v3
    v_lshl_add_u32 v30, v3, 30, v2
    s_mul_i32 s57, s33, 0
    s_and_b32 s57, s57, 2047
    buffer_load_dword v43, v30, s[16:19], s57 offen
    s_add_u32 s57, s57, 512
    s_and_b32 s57, s57, 2047
    buffer_load_dword v43, v30, s[16:19], s57 offen
    s_add_u32 s57, s57, 512
    s_barrier
    ds_read_b64_tr_b16 v[96:97], v12 offset:0
    ds_read_b64_tr_b16 v[98:99], v12 offset:1024
    ds_read_b128 v[64:67], v8 offset:16384
    ds_read_b64_tr_b16 v[100:101], v13 offset:0
    ds_read_b64_tr_b16 v[102:103], v13 offset:1024
    ds_read_b64_tr_b16 v[104:105], v14 offset:0
    ds_read_b64_tr_b16 v[106:107], v14 offset:1024
    ds_read_b64_tr_b16 v[108:109], v15 offset:0
    ds_read_b64_tr_b16 v[110:111], v15 offset:1024
    ds_read_b128 v[68:71], v8 offset:18432
    ds_read_b128 v[72:75], v8 offset:24576
    ds_read_b128 v[76:79], v8 offset:26624
    ds_read_b64_tr_b16 v[112:113], v24 offset:0
    ds_read_b64_tr_b16 v[114:115], v24 offset:1024
    ds_read_b128 v[80:83], v9 offset:16384
    ds_read_b64_tr_b16 v[116:117], v25 offset:0
    ds_read_b64_tr_b16 v[118:119], v25 offset:1024
    ds_read_b64_tr_b16 v[120:121], v26 offset:0
    ds_read_b64_tr_b16 v[122:123], v26 offset:1024
    ds_read_b64_tr_b16 v[124:125], v27 offset:0
    ds_read_b64_tr_b16 v[126:127], v27 offset:1024
    ds_read_b128 v[84:87], v9 offset:18432
    ds_read_b128 v[88:91], v9 offset:24576
    ds_read_b128 v[92:95], v9 offset:26624
    s_waitcnt lgkmcnt(15)
    v_mfma_f32_16x16x32_bf16 v[128:131], v[96:99], v[64:67], 0
    s_and_b32 s55, s55, 1023
    s_mul_i32 s85, s55, 7168
    v_mfma_f32_16x16x32_bf16 v[132:135], v[100:103], v[64:67], 0
    s_add_u32 s55, s55, 256
    buffer_load_dword v43, v28, s[20:23], s85 offen
    s_and_b32 s57, s57, 2047
    buffer_load_dword v43, v30, s[16:19], s57 offen
    v_mfma_f32_16x16x32_bf16 v[136:139], v[104:107], v[64:67], 0
    s_add_u32 s57, s57, 512
    s_cmp_eq_u32 s40, 1
    s_cselect_b32 s28, s14, s12
    s_cselect_b32 s29, s15, s13
    v_mfma_f32_16x16x32_bf16 v[140:143], v[108:111], v[64:67], 0
    s_and_b32 s29, s29, 0xffff
    s_mov_b32 s30, 2097152
    v_mfma_f32_16x16x32_bf16 v[48:51], v[96:99], v[44:47], 0
    s_mov_b32 s31, 0x00020000
    s_lshr_b32 s84, s2, 3
    v_mfma_f32_16x16x32_bf16 v[52:55], v[100:103], v[44:47], 0
    s_sub_u32 s84, s84, 4
    s_lshl1_add_u32 s84, s84, s41
    v_mfma_f32_16x16x32_bf16 v[56:59], v[104:107], v[44:47], 0
    v_lshrrev_b32 v2, 2, v1
    v_mul_u32_u24 v2, 56, v2
    v_mfma_f32_16x16x32_bf16 v[60:63], v[108:111], v[44:47], 0
    s_waitcnt lgkmcnt(0)
    s_barrier
    ds_read_b128 v[64:67], v8 offset:32768
    v_add_u32 v2, s84, v2
    v_mfma_f32_16x16x32_bf16 v[144:147], v[96:99], v[68:71], 0
    v_and_b32 v3, 3, v1
    v_lshlrev_b32 v3, 7, v3
    v_mfma_f32_16x16x32_bf16 v[148:151], v[100:103], v[68:71], 0
    v_lshl_add_u32 v3, v2, 11, v3
    v_lshrrev_b32 v2, 8, v2
    v_mfma_f32_16x16x32_bf16 v[152:155], v[104:107], v[68:71], 0
    v_min_u32 v2, 1, v2
    v_lshl_add_u32 v2, v2, 30, v3
    v_mfma_f32_16x16x32_bf16 v[156:159], v[108:111], v[68:71], 0
    ds_read_b128 v[68:71], v8 offset:34816
    buffer_load_dword v43, v2, s[28:31], 0 offen
    v_mfma_f32_16x16x32_bf16 v[160:163], v[96:99], v[72:75], 0
    v_mfma_f32_16x16x32_bf16 v[164:167], v[100:103], v[72:75], 0
    v_mfma_f32_16x16x32_bf16 v[168:171], v[104:107], v[72:75], 0
    s_lshr_b32 s84, s2, 3
    s_sub_u32 s84, s84, 4
    v_mfma_f32_16x16x32_bf16 v[172:175], v[108:111], v[72:75], 0
    ds_read_b128 v[72:75], v8 offset:40960
    s_lshl2_add_u32 s84, s84, s32
    s_lshl_b32 s84, s84, 10
    v_mfma_f32_16x16x32_bf16 v[176:179], v[96:99], v[76:79], 0
    v_and_b32 v2, 7, v1
    v_lshl_add_u32 v2, v2, 7, s84
    v_mfma_f32_16x16x32_bf16 v[180:183], v[100:103], v[76:79], 0
    v_min_u32 v2, L_end-pk_kernel, v2
    s_getpc_b64 s[58:59]
L_pc0:
    s_sub_u32 s58, s58, L_pc0-pk_kernel
    s_subb_u32 s59, s59, 0
    v_mfma_f32_16x16x32_bf16 v[184:187], v[104:107], v[76:79], 0
    global_load_dword v43, v2, s[58:59]
    v_mfma_f32_16x16x32_bf16 v[188:191], v[108:111], v[76:79], 0
    ds_read_b128 v[76:79], v8 offset:43008
    v_mfma_f32_16x16x32_bf16 v[128:131], v[112:115], v[80:83], v[128:131]
    v_mfma_f32_16x16x32_bf16 v[132:135], v[116:119], v[80:83], v[132:135]
    v_mfma_f32_16x16x32_bf16 v[136:139], v[120:123], v[80:83], v[136:139]
    v_mfma_f32_16x16x32_bf16 v[140:143], v[124:127], v[80:83], v[140:143]
    ds_read_b128 v[80:83], v9 offset:32768
    v_mfma_f32_16x16x32_bf16 v[144:147], v[112:115], v[84:87], v[144:147]
    v_mfma_f32_16x16x32_bf16 v[148:151], v[116:119], v[84:87], v[148:151]
    v_mfma_f32_16x16x32_bf16 v[152:155], v[120:123], v[84:87], v[152:155]
    v_mfma_f32_16x16x32_bf16 v[156:159], v[124:127], v[84:87], v[156:159]
    ds_read_b128 v[84:87], v9 offset:34816
    v_mfma_f32_16x16x32_bf16 v[160:163], v[112:115], v[88:91], v[160:163]
    v_mfma_f32_16x16x32_bf16 v[164:167], v[116:119], v[88:91], v[164:167]
    v_mfma_f32_16x16x32_bf16 v[168:171], v[120:123], v[88:91], v[168:171]
    v_mfma_f32_16x16x32_bf16 v[172:175], v[124:127], v[88:91], v[172:175]
    ds_read_b128 v[88:91], v9 offset:40960
    v_mfma_f32_16x16x32_bf16 v[176:179], v[112:115], v[92:95], v[176:179]
    v_mfma_f32_16x16x32_bf16 v[180:183], v[116:119], v[92:95], v[180:183]
    v_mfma_f32_16x16x32_bf16 v[184:187], v[120:123], v[92:95], v[184:187]
    v_mfma_f32_16x16x32_bf16 v[188:191], v[124:127], v[92:95], v[188:191]
    ds_read_b128 v[92:95], v9 offset:43008
    s_waitcnt lgkmcnt(7)
    v_mfma_f32_16x16x32_bf16 v[192:195], v[96:99], v[64:67], 0
    v_mfma_f32_16x16x32_bf16 v[196:199], v[100:103], v[64:67], 0
    v_mfma_f32_16x16x32_bf16 v[200:203], v[104:107], v[64:67], 0
    v_mfma_f32_16x16x32_bf16 v[204:207], v[108:111], v[64:67], 0
    s_waitcnt lgkmcnt(6)
    v_mfma_f32_16x16x32_bf16 v[208:211], v[96:99], v[68:71], 0
    v_mfma_f32_16x16x32_bf16 v[212:215], v[100:103], v[68:71], 0
    v_mfma_f32_16x16x32_bf16 v[216:219], v[104:107], v[68:71], 0
    v_mfma_f32_16x16x32_bf16 v[220:223], v[108:111], v[68:71], 0
    s_waitcnt lgkmcnt(0)
    s_barrier
    v_add_u32 v8, 65536, v8
    v_add_u32 v9, 65536, v9
    ds_read_b128 v[64:67], v8 offset:0
    v_mfma_f32_16x16x32_bf16 v[224:227], v[96:99], v[72:75], 0
    ds_read_b128 v[68:71], v8 offset:2048
    v_mfma_f32_16x16x32_bf16 v[228:231], v[100:103], v[72:75], 0
    v_mfma_f32_16x16x32_bf16 v[232:235], v[104:107], v[72:75], 0
    v_mfma_f32_16x16x32_bf16 v[236:239], v[108:111], v[72:75], 0
    ds_read_b128 v[72:75], v8 offset:8192
    v_mfma_f32_16x16x32_bf16 v[240:243], v[96:99], v[76:79], 0
    ds_read_b64_tr_b16 v[96:97], v12 offset:49152
    ds_read_b64_tr_b16 v[98:99], v12 offset:50176
    v_mfma_f32_16x16x32_bf16 v[244:247], v[100:103], v[76:79], 0
    ds_read_b64_tr_b16 v[100:101], v13 offset:49152
    ds_read_b64_tr_b16 v[102:103], v13 offset:50176
    v_mfma_f32_16x16x32_bf16 v[248:251], v[104:107], v[76:79], 0
    ds_read_b64_tr_b16 v[104:105], v14 offset:49152
    ds_read_b64_tr_b16 v[106:107], v14 offset:50176
    v_mfma_f32_16x16x32_bf16 v[252:255], v[108:111], v[76:79], 0
    ds_read_b64_tr_b16 v[108:109], v15 offset:49152
    ds_read_b64_tr_b16 v[110:111], v15 offset:50176
    v_mfma_f32_16x16x32_bf16 v[192:195], v[112:115], v[80:83], v[192:195]
    ds_read_b128 v[76:79], v8 offset:10240
    v_mfma_f32_16x16x32_bf16 v[196:199], v[116:119], v[80:83], v[196:199]
    v_mfma_f32_16x16x32_bf16 v[200:203], v[120:123], v[80:83], v[200:203]
    v_mfma_f32_16x16x32_bf16 v[204:207], v[124:127], v[80:83], v[204:207]
    ds_read_b128 v[80:83], v9 offset:0
    v_mfma_f32_16x16x32_bf16 v[208:211], v[112:115], v[84:87], v[208:211]
    v_mfma_f32_16x16x32_bf16 v[212:215], v[116:119], v[84:87], v[212:215]
    v_mfma_f32_16x16x32_bf16 v[216:219], v[120:123], v[84:87], v[216:219]
    v_mfma_f32_16x16x32_bf16 v[220:223], v[124:127], v[84:87], v[220:223]
    ds_read_b128 v[84:87], v9 offset:2048
    v_mfma_f32_16x16x32_bf16 v[224:227], v[112:115], v[88:91], v[224:227]
    v_mfma_f32_16x16x32_bf16 v[228:231], v[116:119], v[88:91], v[228:231]
    v_mfma_f32_16x16x32_bf16 v[232:235], v[120:123], v[88:91], v[232:235]
    v_mfma_f32_16x16x32_bf16 v[236:239], v[124:127], v[88:91], v[236:239]
    ds_read_b128 v[88:91], v9 offset:8192
    v_mfma_f32_16x16x32_bf16 v[240:243], v[112:115], v[92:95], v[240:243]
    ds_read_b64_tr_b16 v[112:113], v24 offset:49152
    ds_read_b64_tr_b16 v[114:115], v24 offset:50176
    v_mfma_f32_16x16x32_bf16 v[244:247], v[116:119], v[92:95], v[244:247]
    ds_read_b64_tr_b16 v[116:117], v25 offset:49152
    ds_read_b64_tr_b16 v[118:119], v25 offset:50176
    v_mfma_f32_16x16x32_bf16 v[248:251], v[120:123], v[92:95], v[248:251]
    ds_read_b64_tr_b16 v[120:121], v26 offset:49152
    ds_read_b64_tr_b16 v[122:123], v26 offset:50176
    v_mfma_f32_16x16x32_bf16 v[252:255], v[124:127], v[92:95], v[252:255]
    ds_read_b64_tr_b16 v[124:125], v27 offset:49152
    ds_read_b64_tr_b16 v[126:127], v27 offset:50176
    s_waitcnt lgkmcnt(15)
    v_mfma_f32_16x16x32_bf16 v[128:131], v[96:99], v[64:67], v[128:131]
    ds_read_b128 v[92:95], v9 offset:10240
    v_mfma_f32_16x16x32_bf16 v[132:135], v[100:103], v[64:67], v[132:135]
    s_waitcnt lgkmcnt(15)
    v_mfma_f32_16x16x32_bf16 v[136:139], v[104:107], v[64:67], v[136:139]
    s_waitcnt lgkmcnt(13)
    v_mfma_f32_16x16x32_bf16 v[140:143], v[108:111], v[64:67], v[140:143]
    v_mfma_f32_16x16x32_bf16 v[48:51], v[96:99], v[44:47], v[48:51]
    v_mfma_f32_16x16x32_bf16 v[52:55], v[100:103], v[44:47], v[52:55]
    v_mfma_f32_16x16x32_bf16 v[56:59], v[104:107], v[44:47], v[56:59]
    v_mfma_f32_16x16x32_bf16 v[60:63], v[108:111], v[44:47], v[60:63]
    s_waitcnt lgkmcnt(0)
    s_barrier
    ds_read_b128 v[64:67], v8 offset:16384
    v_mfma_f32_16x16x32_bf16 v[144:147], v[96:99], v[68:71], v[144:147]
    v_mfma_f32_16x16x32_bf16 v[148:151], v[100:103], v[68:71], v[148:151]
    v_mfma_f32_16x16x32_bf16 v[152:155], v[104:107], v[68:71], v[152:155]
    v_mfma_f32_16x16x32_bf16 v[156:159], v[108:111], v[68:71], v[156:159]
    ds_read_b128 v[68:71], v8 offset:18432
    v_mfma_f32_16x16x32_bf16 v[160:163], v[96:99], v[72:75], v[160:163]
    v_mfma_f32_16x16x32_bf16 v[164:167], v[100:103], v[72:75], v[164:167]
    v_mfma_f32_16x16x32_bf16 v[168:171], v[104:107], v[72:75], v[168:171]
    v_mfma_f32_16x16x32_bf16 v[172:175], v[108:111], v[72:75], v[172:175]
    ds_read_b128 v[72:75], v8 offset:24576
    v_mfma_f32_16x16x32_bf16 v[176:179], v[96:99], v[76:79], v[176:179]
    v_mfma_f32_16x16x32_bf16 v[180:183], v[100:103], v[76:79], v[180:183]
    v_mfma_f32_16x16x32_bf16 v[184:187], v[104:107], v[76:79], v[184:187]
    v_mfma_f32_16x16x32_bf16 v[188:191], v[108:111], v[76:79], v[188:191]
    ds_read_b128 v[76:79], v8 offset:26624
    v_mfma_f32_16x16x32_bf16 v[128:131], v[112:115], v[80:83], v[128:131]
    v_mfma_f32_16x16x32_bf16 v[132:135], v[116:119], v[80:83], v[132:135]
    v_mfma_f32_16x16x32_bf16 v[136:139], v[120:123], v[80:83], v[136:139]
    v_mfma_f32_16x16x32_bf16 v[140:143], v[124:127], v[80:83], v[140:143]
    ds_read_b128 v[80:83], v9 offset:16384
    v_mfma_f32_16x16x32_bf16 v[144:147], v[112:115], v[84:87], v[144:147]
    v_mfma_f32_16x16x32_bf16 v[148:151], v[116:119], v[84:87], v[148:151]
    v_mfma_f32_16x16x32_bf16 v[152:155], v[120:123], v[84:87], v[152:155]
    v_mfma_f32_16x16x32_bf16 v[156:159], v[124:127], v[84:87], v[156:159]
    ds_read_b128 v[84:87], v9 offset:18432
    v_mfma_f32_16x16x32_bf16 v[160:163], v[112:115], v[88:91], v[160:163]
    v_mfma_f32_16x16x32_bf16 v[164:167], v[116:119], v[88:91], v[164:167]
    v_mfma_f32_16x16x32_bf16 v[168:171], v[120:123], v[88:91], v[168:171]
    v_mfma_f32_16x16x32_bf16 v[172:175], v[124:127], v[88:91], v[172:175]
    ds_read_b128 v[88:91], v9 offset:24576
    v_mfma_f32_16x16x32_bf16 v[176:179], v[112:115], v[92:95], v[176:179]
    v_mfma_f32_16x16x32_bf16 v[180:183], v[116:119], v[92:95], v[180:183]
    v_mfma_f32_16x16x32_bf16 v[184:187], v[120:123], v[92:95], v[184:187]
    v_mfma_f32_16x16x32_bf16 v[188:191], v[124:127], v[92:95], v[188:191]
    ds_read_b128 v[92:95], v9 offset:26624
    s_waitcnt lgkmcnt(7)
    v_mfma_f32_16x16x32_bf16 v[192:195], v[96:99], v[64:67], v[192:195]
    v_mfma_f32_16x16x32_bf16 v[196:199], v[100:103], v[64:67], v[196:199]
    v_mfma_f32_16x16x32_bf16 v[200:203], v[104:107], v[64:67], v[200:203]
    v_mfma_f32_16x16x32_bf16 v[204:207], v[108:111], v[64:67], v[204:207]
    s_waitcnt lgkmcnt(6)
    v_mfma_f32_16x16x32_bf16 v[208:211], v[96:99], v[68:71], v[208:211]
    v_mfma_f32_16x16x32_bf16 v[212:215], v[100:103], v[68:71], v[212:215]
    v_mfma_f32_16x16x32_bf16 v[216:219], v[104:107], v[68:71], v[216:219]
    v_mfma_f32_16x16x32_bf16 v[220:223], v[108:111], v[68:71], v[220:223]
    s_waitcnt lgkmcnt(0)
    s_barrier
    ds_read_b128 v[64:67], v8 offset:49152
    ds_read_b128 v[68:71], v8 offset:51200
    v_mfma_f32_16x16x32_bf16 v[224:227], v[96:99], v[72:75], v[224:227]
    v_mfma_f32_16x16x32_bf16 v[228:231], v[100:103], v[72:75], v[228:231]
    v_mfma_f32_16x16x32_bf16 v[232:235], v[104:107], v[72:75], v[232:235]
    s_and_b32 s55, s55, 1023
    s_mul_i32 s85, s55, 7168
    v_mfma_f32_16x16x32_bf16 v[236:239], v[108:111], v[72:75], v[236:239]
    ds_read_b128 v[72:75], v8 offset:57344
    s_add_u32 s55, s55, 256
    buffer_load_dword v43, v28, s[20:23], s85 offen
    v_mfma_f32_16x16x32_bf16 v[240:243], v[96:99], v[76:79], v[240:243]
    v_add_u32 v12, 65536, v12
    v_add_u32 v13, 65536, v13
    v_add_u32 v14, 65536, v14
    v_add_u32 v15, 65536, v15
    ds_read_b64_tr_b16 v[96:97], v12 offset:32768
    v_mfma_f32_16x16x32_bf16 v[244:247], v[100:103], v[76:79], v[244:247]
    ds_read_b64_tr_b16 v[98:99], v12 offset:33792
    ds_read_b64_tr_b16 v[100:101], v13 offset:32768
    v_mfma_f32_16x16x32_bf16 v[248:251], v[104:107], v[76:79], v[248:251]
    ds_read_b64_tr_b16 v[102:103], v13 offset:33792
    ds_read_b64_tr_b16 v[104:105], v14 offset:32768
    v_mfma_f32_16x16x32_bf16 v[252:255], v[108:111], v[76:79], v[252:255]
    ds_read_b64_tr_b16 v[106:107], v14 offset:33792
    ds_read_b64_tr_b16 v[108:109], v15 offset:32768
    v_mfma_f32_16x16x32_bf16 v[192:195], v[112:115], v[80:83], v[192:195]
    ds_read_b64_tr_b16 v[110:111], v15 offset:33792
    ds_read_b128 v[76:79], v8 offset:59392
    v_mfma_f32_16x16x32_bf16 v[196:199], v[116:119], v[80:83], v[196:199]
    s_and_b32 s55, s55, 1023
    s_mul_i32 s85, s55, 7168
    v_mfma_f32_16x16x32_bf16 v[200:203], v[120:123], v[80:83], v[200:203]
    s_add_u32 s55, s55, 256
    buffer_load_dword v43, v28, s[20:23], s85 offen
    s_and_b32 s57, s57, 2047
    buffer_load_dword v43, v30, s[16:19], s57 offen
    v_mfma_f32_16x16x32_bf16 v[204:207], v[124:127], v[80:83], v[204:207]
    ds_read_b128 v[80:83], v9 offset:49152
    s_add_u32 s57, s57, 512
    v_mfma_f32_16x16x32_bf16 v[208:211], v[112:115], v[84:87], v[208:211]
    v_mfma_f32_16x16x32_bf16 v[212:215], v[116:119], v[84:87], v[212:215]
    v_mfma_f32_16x16x32_bf16 v[216:219], v[120:123], v[84:87], v[216:219]
    v_mfma_f32_16x16x32_bf16 v[220:223], v[124:127], v[84:87], v[220:223]
    ds_read_b128 v[84:87], v9 offset:51200
    v_mfma_f32_16x16x32_bf16 v[224:227], v[112:115], v[88:91], v[224:227]
    v_mfma_f32_16x16x32_bf16 v[228:231], v[116:119], v[88:91], v[228:231]
    v_mfma_f32_16x16x32_bf16 v[232:235], v[120:123], v[88:91], v[232:235]
    v_mfma_f32_16x16x32_bf16 v[236:239], v[124:127], v[88:91], v[236:239]
    ds_read_b128 v[88:91], v9 offset:57344
    v_mfma_f32_16x16x32_bf16 v[240:243], v[112:115], v[92:95], v[240:243]
    v_add_u32 v24, 65536, v24
    v_add_u32 v25, 65536, v25
    v_add_u32 v26, 65536, v26
    v_add_u32 v27, 65536, v27
    ds_read_b64_tr_b16 v[112:113], v24 offset:32768
    v_mfma_f32_16x16x32_bf16 v[244:247], v[116:119], v[92:95], v[244:247]
    ds_read_b64_tr_b16 v[114:115], v24 offset:33792
    ds_read_b64_tr_b16 v[116:117], v25 offset:32768
    v_mfma_f32_16x16x32_bf16 v[248:251], v[120:123], v[92:95], v[248:251]
    ds_read_b64_tr_b16 v[118:119], v25 offset:33792
    ds_read_b64_tr_b16 v[120:121], v26 offset:32768
    v_mfma_f32_16x16x32_bf16 v[252:255], v[124:127], v[92:95], v[252:255]
    ds_read_b64_tr_b16 v[122:123], v26 offset:33792
    ds_read_b64_tr_b16 v[124:125], v27 offset:32768
    s_mov_b32 s86, 2
L_ca_r1:
    s_waitcnt lgkmcnt(15)
    v_mfma_f32_16x16x32_bf16 v[128:131], v[96:99], v[64:67], v[128:131]
    ds_read_b64_tr_b16 v[126:127], v27 offset:33792
    ds_read_b128 v[92:95], v9 offset:59392
    v_mfma_f32_16x16x32_bf16 v[132:135], v[100:103], v[64:67], v[132:135]
    s_waitcnt lgkmcnt(15)
    v_mfma_f32_16x16x32_bf16 v[136:139], v[104:107], v[64:67], v[136:139]
    s_waitcnt lgkmcnt(13)
    v_mfma_f32_16x16x32_bf16 v[140:143], v[108:111], v[64:67], v[140:143]
    v_mfma_f32_16x16x32_bf16 v[48:51], v[96:99], v[44:47], v[48:51]
    v_mfma_f32_16x16x32_bf16 v[52:55], v[100:103], v[44:47], v[52:55]
    v_mfma_f32_16x16x32_bf16 v[56:59], v[104:107], v[44:47], v[56:59]
    v_mfma_f32_16x16x32_bf16 v[60:63], v[108:111], v[44:47], v[60:63]
    s_waitcnt lgkmcnt(0)
    s_barrier
    v_add_u32 v8, 16384, v8
    v_add_u32 v9, 16384, v9
    ds_read_b128 v[64:67], v8 offset:49152
    v_mfma_f32_16x16x32_bf16 v[144:147], v[96:99], v[68:71], v[144:147]
    v_mfma_f32_16x16x32_bf16 v[148:151], v[100:103], v[68:71], v[148:151]
    v_mfma_f32_16x16x32_bf16 v[152:155], v[104:107], v[68:71], v[152:155]
    v_mfma_f32_16x16x32_bf16 v[156:159], v[108:111], v[68:71], v[156:159]
    ds_read_b128 v[68:71], v8 offset:51200
    v_mfma_f32_16x16x32_bf16 v[160:163], v[96:99], v[72:75], v[160:163]
    v_mfma_f32_16x16x32_bf16 v[164:167], v[100:103], v[72:75], v[164:167]
    v_mfma_f32_16x16x32_bf16 v[168:171], v[104:107], v[72:75], v[168:171]
    v_mfma_f32_16x16x32_bf16 v[172:175], v[108:111], v[72:75], v[172:175]
    ds_read_b128 v[72:75], v8 offset:57344
    v_mfma_f32_16x16x32_bf16 v[176:179], v[96:99], v[76:79], v[176:179]
    v_mfma_f32_16x16x32_bf16 v[180:183], v[100:103], v[76:79], v[180:183]
    v_mfma_f32_16x16x32_bf16 v[184:187], v[104:107], v[76:79], v[184:187]
    v_mfma_f32_16x16x32_bf16 v[188:191], v[108:111], v[76:79], v[188:191]
    ds_read_b128 v[76:79], v8 offset:59392
    v_mfma_f32_16x16x32_bf16 v[128:131], v[112:115], v[80:83], v[128:131]
    v_mfma_f32_16x16x32_bf16 v[132:135], v[116:119], v[80:83], v[132:135]
    v_mfma_f32_16x16x32_bf16 v[136:139], v[120:123], v[80:83], v[136:139]
    v_mfma_f32_16x16x32_bf16 v[140:143], v[124:127], v[80:83], v[140:143]
    ds_read_b128 v[80:83], v9 offset:49152
    v_mfma_f32_16x16x32_bf16 v[144:147], v[112:115], v[84:87], v[144:147]
    v_mfma_f32_16x16x32_bf16 v[148:151], v[116:119], v[84:87], v[148:151]
    v_mfma_f32_16x16x32_bf16 v[152:155], v[120:123], v[84:87], v[152:155]
    v_mfma_f32_16x16x32_bf16 v[156:159], v[124:127], v[84:87], v[156:159]
    ds_read_b128 v[84:87], v9 offset:51200
    v_mfma_f32_16x16x32_bf16 v[160:163], v[112:115], v[88:91], v[160:163]
    v_mfma_f32_16x16x32_bf16 v[164:167], v[116:119], v[88:91], v[164:167]
    v_mfma_f32_16x16x32_bf16 v[168:171], v[120:123], v[88:91], v[168:171]
    v_mfma_f32_16x16x32_bf16 v[172:175], v[124:127], v[88:91], v[172:175]
    ds_read_b128 v[88:91], v9 offset:57344
    v_mfma_f32_16x16x32_bf16 v[176:179], v[112:115], v[92:95], v[176:179]
    v_mfma_f32_16x16x32_bf16 v[180:183], v[116:119], v[92:95], v[180:183]
    v_mfma_f32_16x16x32_bf16 v[184:187], v[120:123], v[92:95], v[184:187]
    v_mfma_f32_16x16x32_bf16 v[188:191], v[124:127], v[92:95], v[188:191]
    ds_read_b128 v[92:95], v9 offset:59392
    s_waitcnt lgkmcnt(7)
    v_mfma_f32_16x16x32_bf16 v[192:195], v[96:99], v[64:67], v[192:195]
    v_mfma_f32_16x16x32_bf16 v[196:199], v[100:103], v[64:67], v[196:199]
    v_mfma_f32_16x16x32_bf16 v[200:203], v[104:107], v[64:67], v[200:203]
    v_mfma_f32_16x16x32_bf16 v[204:207], v[108:111], v[64:67], v[204:207]
    s_waitcnt lgkmcnt(6)
    v_mfma_f32_16x16x32_bf16 v[208:211], v[96:99], v[68:71], v[208:211]
    v_mfma_f32_16x16x32_bf16 v[212:215], v[100:103], v[68:71], v[212:215]
    v_mfma_f32_16x16x32_bf16 v[216:219], v[104:107], v[68:71], v[216:219]
    v_mfma_f32_16x16x32_bf16 v[220:223], v[108:111], v[68:71], v[220:223]
    s_waitcnt lgkmcnt(0)
    s_barrier
    v_subrev_u32 v8, 81920, v8
    v_subrev_u32 v9, 81920, v9
    ds_read_b128 v[64:67], v8 offset:16384
    v_mfma_f32_16x16x32_bf16 v[224:227], v[96:99], v[72:75], v[224:227]
    ds_read_b128 v[68:71], v8 offset:18432
    v_mfma_f32_16x16x32_bf16 v[228:231], v[100:103], v[72:75], v[228:231]
    v_mfma_f32_16x16x32_bf16 v[232:235], v[104:107], v[72:75], v[232:235]
    v_mfma_f32_16x16x32_bf16 v[236:239], v[108:111], v[72:75], v[236:239]
    ds_read_b128 v[72:75], v8 offset:24576
    v_mfma_f32_16x16x32_bf16 v[240:243], v[96:99], v[76:79], v[240:243]
    v_subrev_u32 v12, 65536, v12
    v_subrev_u32 v13, 65536, v13
    v_subrev_u32 v14, 65536, v14
    v_subrev_u32 v15, 65536, v15
    ds_read_b64_tr_b16 v[96:97], v12 offset:0
    v_mfma_f32_16x16x32_bf16 v[244:247], v[100:103], v[76:79], v[244:247]
    ds_read_b64_tr_b16 v[98:99], v12 offset:1024
    ds_read_b64_tr_b16 v[100:101], v13 offset:0
    v_mfma_f32_16x16x32_bf16 v[248:251], v[104:107], v[76:79], v[248:251]
    ds_read_b64_tr_b16 v[102:103], v13 offset:1024
    ds_read_b64_tr_b16 v[104:105], v14 offset:0
    v_mfma_f32_16x16x32_bf16 v[252:255], v[108:111], v[76:79], v[252:255]
    ds_read_b64_tr_b16 v[106:107], v14 offset:1024
    ds_read_b64_tr_b16 v[108:109], v15 offset:0
    v_mfma_f32_16x16x32_bf16 v[192:195], v[112:115], v[80:83], v[192:195]
    ds_read_b64_tr_b16 v[110:111], v15 offset:1024
    ds_read_b128 v[76:79], v8 offset:26624
    v_mfma_f32_16x16x32_bf16 v[196:199], v[116:119], v[80:83], v[196:199]
    v_mfma_f32_16x16x32_bf16 v[200:203], v[120:123], v[80:83], v[200:203]
    v_mfma_f32_16x16x32_bf16 v[204:207], v[124:127], v[80:83], v[204:207]
    ds_read_b128 v[80:83], v9 offset:16384
    v_mfma_f32_16x16x32_bf16 v[208:211], v[112:115], v[84:87], v[208:211]
    v_mfma_f32_16x16x32_bf16 v[212:215], v[116:119], v[84:87], v[212:215]
    v_mfma_f32_16x16x32_bf16 v[216:219], v[120:123], v[84:87], v[216:219]
    v_mfma_f32_16x16x32_bf16 v[220:223], v[124:127], v[84:87], v[220:223]
    ds_read_b128 v[84:87], v9 offset:18432
    v_mfma_f32_16x16x32_bf16 v[224:227], v[112:115], v[88:91], v[224:227]
    v_mfma_f32_16x16x32_bf16 v[228:231], v[116:119], v[88:91], v[228:231]
    v_mfma_f32_16x16x32_bf16 v[232:235], v[120:123], v[88:91], v[232:235]
    v_mfma_f32_16x16x32_bf16 v[236:239], v[124:127], v[88:91], v[236:239]
    ds_read_b128 v[88:91], v9 offset:24576
    v_mfma_f32_16x16x32_bf16 v[240:243], v[112:115], v[92:95], v[240:243]
    v_subrev_u32 v24, 65536, v24
    v_subrev_u32 v25, 65536, v25
    v_subrev_u32 v26, 65536, v26
    v_subrev_u32 v27, 65536, v27
    ds_read_b64_tr_b16 v[112:113], v24 offset:0
    v_mfma_f32_16x16x32_bf16 v[244:247], v[116:119], v[92:95], v[244:247]
    ds_read_b64_tr_b16 v[114:115], v24 offset:1024
    ds_read_b64_tr_b16 v[116:117], v25 offset:0
    v_mfma_f32_16x16x32_bf16 v[248:251], v[120:123], v[92:95], v[248:251]
    ds_read_b64_tr_b16 v[118:119], v25 offset:1024
    ds_read_b64_tr_b16 v[120:121], v26 offset:0
    v_mfma_f32_16x16x32_bf16 v[252:255], v[124:127], v[92:95], v[252:255]
    ds_read_b64_tr_b16 v[122:123], v26 offset:1024
    ds_read_b64_tr_b16 v[124:125], v27 offset:0
    s_waitcnt lgkmcnt(15)
    v_mfma_f32_16x16x32_bf16 v[128:131], v[96:99], v[64:67], v[128:131]
    ds_read_b64_tr_b16 v[126:127], v27 offset:1024
    ds_read_b128 v[92:95], v9 offset:26624
    v_mfma_f32_16x16x32_bf16 v[132:135], v[100:103], v[64:67], v[132:135]
    s_waitcnt lgkmcnt(15)
    v_mfma_f32_16x16x32_bf16 v[136:139], v[104:107], v[64:67], v[136:139]
    s_waitcnt lgkmcnt(13)
    v_mfma_f32_16x16x32_bf16 v[140:143], v[108:111], v[64:67], v[140:143]
    v_mfma_f32_16x16x32_bf16 v[48:51], v[96:99], v[44:47], v[48:51]
    v_mfma_f32_16x16x32_bf16 v[52:55], v[100:103], v[44:47], v[52:55]
    v_mfma_f32_16x16x32_bf16 v[56:59], v[104:107], v[44:47], v[56:59]
    v_mfma_f32_16x16x32_bf16 v[60:63], v[108:111], v[44:47], v[60:63]
    s_waitcnt lgkmcnt(0)
    s_barrier
    ds_read_b128 v[64:67], v8 offset:32768
    v_mfma_f32_16x16x32_bf16 v[144:147], v[96:99], v[68:71], v[144:147]
    v_mfma_f32_16x16x32_bf16 v[148:151], v[100:103], v[68:71], v[148:151]
    v_mfma_f32_16x16x32_bf16 v[152:155], v[104:107], v[68:71], v[152:155]
    v_mfma_f32_16x16x32_bf16 v[156:159], v[108:111], v[68:71], v[156:159]
    ds_read_b128 v[68:71], v8 offset:34816
    v_mfma_f32_16x16x32_bf16 v[160:163], v[96:99], v[72:75], v[160:163]
    v_mfma_f32_16x16x32_bf16 v[164:167], v[100:103], v[72:75], v[164:167]
    v_mfma_f32_16x16x32_bf16 v[168:171], v[104:107], v[72:75], v[168:171]
    v_mfma_f32_16x16x32_bf16 v[172:175], v[108:111], v[72:75], v[172:175]
    ds_read_b128 v[72:75], v8 offset:40960
    v_mfma_f32_16x16x32_bf16 v[176:179], v[96:99], v[76:79], v[176:179]
    v_mfma_f32_16x16x32_bf16 v[180:183], v[100:103], v[76:79], v[180:183]
    v_mfma_f32_16x16x32_bf16 v[184:187], v[104:107], v[76:79], v[184:187]
    v_mfma_f32_16x16x32_bf16 v[188:191], v[108:111], v[76:79], v[188:191]
    ds_read_b128 v[76:79], v8 offset:43008
    v_mfma_f32_16x16x32_bf16 v[128:131], v[112:115], v[80:83], v[128:131]
    v_mfma_f32_16x16x32_bf16 v[132:135], v[116:119], v[80:83], v[132:135]
    v_mfma_f32_16x16x32_bf16 v[136:139], v[120:123], v[80:83], v[136:139]
    v_mfma_f32_16x16x32_bf16 v[140:143], v[124:127], v[80:83], v[140:143]
    ds_read_b128 v[80:83], v9 offset:32768
    v_mfma_f32_16x16x32_bf16 v[144:147], v[112:115], v[84:87], v[144:147]
    v_mfma_f32_16x16x32_bf16 v[148:151], v[116:119], v[84:87], v[148:151]
    v_mfma_f32_16x16x32_bf16 v[152:155], v[120:123], v[84:87], v[152:155]
    v_mfma_f32_16x16x32_bf16 v[156:159], v[124:127], v[84:87], v[156:159]
    ds_read_b128 v[84:87], v9 offset:34816
    v_mfma_f32_16x16x32_bf16 v[160:163], v[112:115], v[88:91], v[160:163]
    v_mfma_f32_16x16x32_bf16 v[164:167], v[116:119], v[88:91], v[164:167]
    v_mfma_f32_16x16x32_bf16 v[168:171], v[120:123], v[88:91], v[168:171]
    v_mfma_f32_16x16x32_bf16 v[172:175], v[124:127], v[88:91], v[172:175]
    ds_read_b128 v[88:91], v9 offset:40960
    v_mfma_f32_16x16x32_bf16 v[176:179], v[112:115], v[92:95], v[176:179]
    v_mfma_f32_16x16x32_bf16 v[180:183], v[116:119], v[92:95], v[180:183]
    v_mfma_f32_16x16x32_bf16 v[184:187], v[120:123], v[92:95], v[184:187]
    v_mfma_f32_16x16x32_bf16 v[188:191], v[124:127], v[92:95], v[188:191]
    ds_read_b128 v[92:95], v9 offset:43008
    s_waitcnt lgkmcnt(7)
    v_mfma_f32_16x16x32_bf16 v[192:195], v[96:99], v[64:67], v[192:195]
    v_mfma_f32_16x16x32_bf16 v[196:199], v[100:103], v[64:67], v[196:199]
    v_mfma_f32_16x16x32_bf16 v[200:203], v[104:107], v[64:67], v[200:203]
    v_mfma_f32_16x16x32_bf16 v[204:207], v[108:111], v[64:67], v[204:207]
    s_waitcnt lgkmcnt(6)
    v_mfma_f32_16x16x32_bf16 v[208:211], v[96:99], v[68:71], v[208:211]
    v_mfma_f32_16x16x32_bf16 v[212:215], v[100:103], v[68:71], v[212:215]
    v_mfma_f32_16x16x32_bf16 v[216:219], v[104:107], v[68:71], v[216:219]
    v_mfma_f32_16x16x32_bf16 v[220:223], v[108:111], v[68:71], v[220:223]
    s_waitcnt lgkmcnt(0)
    s_barrier
    v_add_u32 v8, 65536, v8
    v_add_u32 v9, 65536, v9
    ds_read_b128 v[64:67], v8 offset:0
    v_mfma_f32_16x16x32_bf16 v[224:227], v[96:99], v[72:75], v[224:227]
    ds_read_b128 v[68:71], v8 offset:2048
    v_mfma_f32_16x16x32_bf16 v[228:231], v[100:103], v[72:75], v[228:231]
    v_mfma_f32_16x16x32_bf16 v[232:235], v[104:107], v[72:75], v[232:235]
    v_mfma_f32_16x16x32_bf16 v[236:239], v[108:111], v[72:75], v[236:239]
    ds_read_b128 v[72:75], v8 offset:8192
    v_mfma_f32_16x16x32_bf16 v[240:243], v[96:99], v[76:79], v[240:243]
    ds_read_b64_tr_b16 v[96:97], v12 offset:49152
    ds_read_b64_tr_b16 v[98:99], v12 offset:50176
    v_mfma_f32_16x16x32_bf16 v[244:247], v[100:103], v[76:79], v[244:247]
    ds_read_b64_tr_b16 v[100:101], v13 offset:49152
    ds_read_b64_tr_b16 v[102:103], v13 offset:50176
    v_mfma_f32_16x16x32_bf16 v[248:251], v[104:107], v[76:79], v[248:251]
    ds_read_b64_tr_b16 v[104:105], v14 offset:49152
    ds_read_b64_tr_b16 v[106:107], v14 offset:50176
    v_mfma_f32_16x16x32_bf16 v[252:255], v[108:111], v[76:79], v[252:255]
    ds_read_b64_tr_b16 v[108:109], v15 offset:49152
    ds_read_b64_tr_b16 v[110:111], v15 offset:50176
    v_mfma_f32_16x16x32_bf16 v[192:195], v[112:115], v[80:83], v[192:195]
    ds_read_b128 v[76:79], v8 offset:10240
    v_mfma_f32_16x16x32_bf16 v[196:199], v[116:119], v[80:83], v[196:199]
    v_mfma_f32_16x16x32_bf16 v[200:203], v[120:123], v[80:83], v[200:203]
    v_mfma_f32_16x16x32_bf16 v[204:207], v[124:127], v[80:83], v[204:207]
    ds_read_b128 v[80:83], v9 offset:0
    v_mfma_f32_16x16x32_bf16 v[208:211], v[112:115], v[84:87], v[208:211]
    v_mfma_f32_16x16x32_bf16 v[212:215], v[116:119], v[84:87], v[212:215]
    v_mfma_f32_16x16x32_bf16 v[216:219], v[120:123], v[84:87], v[216:219]
    v_mfma_f32_16x16x32_bf16 v[220:223], v[124:127], v[84:87], v[220:223]
    ds_read_b128 v[84:87], v9 offset:2048
    v_mfma_f32_16x16x32_bf16 v[224:227], v[112:115], v[88:91], v[224:227]
    v_mfma_f32_16x16x32_bf16 v[228:231], v[116:119], v[88:91], v[228:231]
    v_mfma_f32_16x16x32_bf16 v[232:235], v[120:123], v[88:91], v[232:235]
    v_mfma_f32_16x16x32_bf16 v[236:239], v[124:127], v[88:91], v[236:239]
    ds_read_b128 v[88:91], v9 offset:8192
    v_mfma_f32_16x16x32_bf16 v[240:243], v[112:115], v[92:95], v[240:243]
    ds_read_b64_tr_b16 v[112:113], v24 offset:49152
    ds_read_b64_tr_b16 v[114:115], v24 offset:50176
    v_mfma_f32_16x16x32_bf16 v[244:247], v[116:119], v[92:95], v[244:247]
    ds_read_b64_tr_b16 v[116:117], v25 offset:49152
    ds_read_b64_tr_b16 v[118:119], v25 offset:50176
    v_mfma_f32_16x16x32_bf16 v[248:251], v[120:123], v[92:95], v[248:251]
    ds_read_b64_tr_b16 v[120:121], v26 offset:49152
    ds_read_b64_tr_b16 v[122:123], v26 offset:50176
    v_mfma_f32_16x16x32_bf16 v[252:255], v[124:127], v[92:95], v[252:255]
    ds_read_b64_tr_b16 v[124:125], v27 offset:49152
    ds_read_b64_tr_b16 v[126:127], v27 offset:50176
    s_waitcnt lgkmcnt(15)
    v_mfma_f32_16x16x32_bf16 v[128:131], v[96:99], v[64:67], v[128:131]
    ds_read_b128 v[92:95], v9 offset:10240
    v_mfma_f32_16x16x32_bf16 v[132:135], v[100:103], v[64:67], v[132:135]
    s_waitcnt lgkmcnt(15)
    v_mfma_f32_16x16x32_bf16 v[136:139], v[104:107], v[64:67], v[136:139]
    s_waitcnt lgkmcnt(13)
    v_mfma_f32_16x16x32_bf16 v[140:143], v[108:111], v[64:67], v[140:143]
    v_mfma_f32_16x16x32_bf16 v[48:51], v[96:99], v[44:47], v[48:51]
    v_mfma_f32_16x16x32_bf16 v[52:55], v[100:103], v[44:47], v[52:55]
    v_mfma_f32_16x16x32_bf16 v[56:59], v[104:107], v[44:47], v[56:59]
    v_mfma_f32_16x16x32_bf16 v[60:63], v[108:111], v[44:47], v[60:63]
    s_waitcnt lgkmcnt(0)
    s_barrier
    ds_read_b128 v[64:67], v8 offset:16384
    v_mfma_f32_16x16x32_bf16 v[144:147], v[96:99], v[68:71], v[144:147]
    v_mfma_f32_16x16x32_bf16 v[148:151], v[100:103], v[68:71], v[148:151]
    v_mfma_f32_16x16x32_bf16 v[152:155], v[104:107], v[68:71], v[152:155]
    v_mfma_f32_16x16x32_bf16 v[156:159], v[108:111], v[68:71], v[156:159]
    ds_read_b128 v[68:71], v8 offset:18432
    v_mfma_f32_16x16x32_bf16 v[160:163], v[96:99], v[72:75], v[160:163]
    v_mfma_f32_16x16x32_bf16 v[164:167], v[100:103], v[72:75], v[164:167]
    v_mfma_f32_16x16x32_bf16 v[168:171], v[104:107], v[72:75], v[168:171]
    v_mfma_f32_16x16x32_bf16 v[172:175], v[108:111], v[72:75], v[172:175]
    ds_read_b128 v[72:75], v8 offset:24576
    v_mfma_f32_16x16x32_bf16 v[176:179], v[96:99], v[76:79], v[176:179]
    v_mfma_f32_16x16x32_bf16 v[180:183], v[100:103], v[76:79], v[180:183]
    v_mfma_f32_16x16x32_bf16 v[184:187], v[104:107], v[76:79], v[184:187]
    v_mfma_f32_16x16x32_bf16 v[188:191], v[108:111], v[76:79], v[188:191]
    ds_read_b128 v[76:79], v8 offset:26624
    v_mfma_f32_16x16x32_bf16 v[128:131], v[112:115], v[80:83], v[128:131]
    v_mfma_f32_16x16x32_bf16 v[132:135], v[116:119], v[80:83], v[132:135]
    v_mfma_f32_16x16x32_bf16 v[136:139], v[120:123], v[80:83], v[136:139]
    v_mfma_f32_16x16x32_bf16 v[140:143], v[124:127], v[80:83], v[140:143]
    ds_read_b128 v[80:83], v9 offset:16384
    v_mfma_f32_16x16x32_bf16 v[144:147], v[112:115], v[84:87], v[144:147]
    v_mfma_f32_16x16x32_bf16 v[148:151], v[116:119], v[84:87], v[148:151]
    v_mfma_f32_16x16x32_bf16 v[152:155], v[120:123], v[84:87], v[152:155]
    v_mfma_f32_16x16x32_bf16 v[156:159], v[124:127], v[84:87], v[156:159]
    ds_read_b128 v[84:87], v9 offset:18432
    v_mfma_f32_16x16x32_bf16 v[160:163], v[112:115], v[88:91], v[160:163]
    v_mfma_f32_16x16x32_bf16 v[164:167], v[116:119], v[88:91], v[164:167]
    v_mfma_f32_16x16x32_bf16 v[168:171], v[120:123], v[88:91], v[168:171]
    v_mfma_f32_16x16x32_bf16 v[172:175], v[124:127], v[88:91], v[172:175]
    ds_read_b128 v[88:91], v9 offset:24576
    v_mfma_f32_16x16x32_bf16 v[176:179], v[112:115], v[92:95], v[176:179]
    v_mfma_f32_16x16x32_bf16 v[180:183], v[116:119], v[92:95], v[180:183]
    v_mfma_f32_16x16x32_bf16 v[184:187], v[120:123], v[92:95], v[184:187]
    v_mfma_f32_16x16x32_bf16 v[188:191], v[124:127], v[92:95], v[188:191]
    ds_read_b128 v[92:95], v9 offset:26624
    s_waitcnt lgkmcnt(7)
    v_mfma_f32_16x16x32_bf16 v[192:195], v[96:99], v[64:67], v[192:195]
    v_mfma_f32_16x16x32_bf16 v[196:199], v[100:103], v[64:67], v[196:199]
    v_mfma_f32_16x16x32_bf16 v[200:203], v[104:107], v[64:67], v[200:203]
    v_mfma_f32_16x16x32_bf16 v[204:207], v[108:111], v[64:67], v[204:207]
    s_waitcnt lgkmcnt(6)
    v_mfma_f32_16x16x32_bf16 v[208:211], v[96:99], v[68:71], v[208:211]
    v_mfma_f32_16x16x32_bf16 v[212:215], v[100:103], v[68:71], v[212:215]
    v_mfma_f32_16x16x32_bf16 v[216:219], v[104:107], v[68:71], v[216:219]
    v_mfma_f32_16x16x32_bf16 v[220:223], v[108:111], v[68:71], v[220:223]
    s_waitcnt lgkmcnt(0)
    s_barrier
    ds_read_b128 v[64:67], v8 offset:49152
    ds_read_b128 v[68:71], v8 offset:51200
    v_mfma_f32_16x16x32_bf16 v[224:227], v[96:99], v[72:75], v[224:227]
    v_mfma_f32_16x16x32_bf16 v[228:231], v[100:103], v[72:75], v[228:231]
    v_mfma_f32_16x16x32_bf16 v[232:235], v[104:107], v[72:75], v[232:235]
    v_mfma_f32_16x16x32_bf16 v[236:239], v[108:111], v[72:75], v[236:239]
    ds_read_b128 v[72:75], v8 offset:57344
    v_mfma_f32_16x16x32_bf16 v[240:243], v[96:99], v[76:79], v[240:243]
    v_add_u32 v12, 65536, v12
    v_add_u32 v13, 65536, v13
    v_add_u32 v14, 65536, v14
    v_add_u32 v15, 65536, v15
    ds_read_b64_tr_b16 v[96:97], v12 offset:32768
    v_mfma_f32_16x16x32_bf16 v[244:247], v[100:103], v[76:79], v[244:247]
    ds_read_b64_tr_b16 v[98:99], v12 offset:33792
    ds_read_b64_tr_b16 v[100:101], v13 offset:32768
    v_mfma_f32_16x16x32_bf16 v[248:251], v[104:107], v[76:79], v[248:251]
    ds_read_b64_tr_b16 v[102:103], v13 offset:33792
    ds_read_b64_tr_b16 v[104:105], v14 offset:32768
    v_mfma_f32_16x16x32_bf16 v[252:255], v[108:111], v[76:79], v[252:255]
    ds_read_b64_tr_b16 v[106:107], v14 offset:33792
    ds_read_b64_tr_b16 v[108:109], v15 offset:32768
    v_mfma_f32_16x16x32_bf16 v[192:195], v[112:115], v[80:83], v[192:195]
    ds_read_b64_tr_b16 v[110:111], v15 offset:33792
    ds_read_b128 v[76:79], v8 offset:59392
    v_mfma_f32_16x16x32_bf16 v[196:199], v[116:119], v[80:83], v[196:199]
    v_mfma_f32_16x16x32_bf16 v[200:203], v[120:123], v[80:83], v[200:203]
    v_mfma_f32_16x16x32_bf16 v[204:207], v[124:127], v[80:83], v[204:207]
    ds_read_b128 v[80:83], v9 offset:49152
    v_mfma_f32_16x16x32_bf16 v[208:211], v[112:115], v[84:87], v[208:211]
    v_mfma_f32_16x16x32_bf16 v[212:215], v[116:119], v[84:87], v[212:215]
    v_mfma_f32_16x16x32_bf16 v[216:219], v[120:123], v[84:87], v[216:219]
    v_mfma_f32_16x16x32_bf16 v[220:223], v[124:127], v[84:87], v[220:223]
    ds_read_b128 v[84:87], v9 offset:51200
    v_mfma_f32_16x16x32_bf16 v[224:227], v[112:115], v[88:91], v[224:227]
    v_mfma_f32_16x16x32_bf16 v[228:231], v[116:119], v[88:91], v[228:231]
    v_mfma_f32_16x16x32_bf16 v[232:235], v[120:123], v[88:91], v[232:235]
    v_mfma_f32_16x16x32_bf16 v[236:239], v[124:127], v[88:91], v[236:239]
    ds_read_b128 v[88:91], v9 offset:57344
    v_mfma_f32_16x16x32_bf16 v[240:243], v[112:115], v[92:95], v[240:243]
    v_add_u32 v24, 65536, v24
    v_add_u32 v25, 65536, v25
    v_add_u32 v26, 65536, v26
    v_add_u32 v27, 65536, v27
    ds_read_b64_tr_b16 v[112:113], v24 offset:32768
    v_mfma_f32_16x16x32_bf16 v[244:247], v[116:119], v[92:95], v[244:247]
    ds_read_b64_tr_b16 v[114:115], v24 offset:33792
    ds_read_b64_tr_b16 v[116:117], v25 offset:32768
    v_mfma_f32_16x16x32_bf16 v[248:251], v[120:123], v[92:95], v[248:251]
    ds_read_b64_tr_b16 v[118:119], v25 offset:33792
    ds_read_b64_tr_b16 v[120:121], v26 offset:32768
    v_mfma_f32_16x16x32_bf16 v[252:255], v[124:127], v[92:95], v[252:255]
    ds_read_b64_tr_b16 v[122:123], v26 offset:33792
    ds_read_b64_tr_b16 v[124:125], v27 offset:32768
    s_sub_u32 s86, s86, 1
    s_cbranch_scc0 L_ca_r1
    s_waitcnt lgkmcnt(15)
    v_mfma_f32_16x16x32_bf16 v[128:131], v[96:99], v[64:67], v[128:131]
    ds_read_b64_tr_b16 v[126:127], v27 offset:33792
    ds_read_b128 v[92:95], v9 offset:59392
    v_mfma_f32_16x16x32_bf16 v[132:135], v[100:103], v[64:67], v[132:135]
    s_waitcnt lgkmcnt(15)
    v_mfma_f32_16x16x32_bf16 v[136:139], v[104:107], v[64:67], v[136:139]
    s_waitcnt lgkmcnt(13)
    v_mfma_f32_16x16x32_bf16 v[140:143], v[108:111], v[64:67], v[140:143]
    v_mfma_f32_16x16x32_bf16 v[48:51], v[96:99], v[44:47], v[48:51]
    v_mfma_f32_16x16x32_bf16 v[52:55], v[100:103], v[44:47], v[52:55]
    v_mfma_f32_16x16x32_bf16 v[56:59], v[104:107], v[44:47], v[56:59]
    v_mfma_f32_16x16x32_bf16 v[60:63], v[108:111], v[44:47], v[60:63]
    s_waitcnt lgkmcnt(0)
    s_barrier
    v_add_u32 v8, 16384, v8
    v_add_u32 v9, 16384, v9
    ds_read_b128 v[64:67], v8 offset:49152
    v_mfma_f32_16x16x32_bf16 v[144:147], v[96:99], v[68:71], v[144:147]
    v_mfma_f32_16x16x32_bf16 v[148:151], v[100:103], v[68:71], v[148:151]
    v_mfma_f32_16x16x32_bf16 v[152:155], v[104:107], v[68:71], v[152:155]
    v_mfma_f32_16x16x32_bf16 v[156:159], v[108:111], v[68:71], v[156:159]
    ds_read_b128 v[68:71], v8 offset:51200
    v_mfma_f32_16x16x32_bf16 v[160:163], v[96:99], v[72:75], v[160:163]
    v_mfma_f32_16x16x32_bf16 v[164:167], v[100:103], v[72:75], v[164:167]
    v_mfma_f32_16x16x32_bf16 v[168:171], v[104:107], v[72:75], v[168:171]
    v_mfma_f32_16x16x32_bf16 v[172:175], v[108:111], v[72:75], v[172:175]
    ds_read_b128 v[72:75], v8 offset:57344
    v_mfma_f32_16x16x32_bf16 v[176:179], v[96:99], v[76:79], v[176:179]
    v_mfma_f32_16x16x32_bf16 v[180:183], v[100:103], v[76:79], v[180:183]
    v_mfma_f32_16x16x32_bf16 v[184:187], v[104:107], v[76:79], v[184:187]
    v_mfma_f32_16x16x32_bf16 v[188:191], v[108:111], v[76:79], v[188:191]
    ds_read_b128 v[76:79], v8 offset:59392
    v_mfma_f32_16x16x32_bf16 v[128:131], v[112:115], v[80:83], v[128:131]
    v_mfma_f32_16x16x32_bf16 v[132:135], v[116:119], v[80:83], v[132:135]
    v_mfma_f32_16x16x32_bf16 v[136:139], v[120:123], v[80:83], v[136:139]
    v_mfma_f32_16x16x32_bf16 v[140:143], v[124:127], v[80:83], v[140:143]
    ds_read_b128 v[80:83], v9 offset:49152
    v_mfma_f32_16x16x32_bf16 v[144:147], v[112:115], v[84:87], v[144:147]
    v_mfma_f32_16x16x32_bf16 v[148:151], v[116:119], v[84:87], v[148:151]
    v_mfma_f32_16x16x32_bf16 v[152:155], v[120:123], v[84:87], v[152:155]
    v_mfma_f32_16x16x32_bf16 v[156:159], v[124:127], v[84:87], v[156:159]
    ds_read_b128 v[84:87], v9 offset:51200
    v_mfma_f32_16x16x32_bf16 v[160:163], v[112:115], v[88:91], v[160:163]
    v_mfma_f32_16x16x32_bf16 v[164:167], v[116:119], v[88:91], v[164:167]
    v_mfma_f32_16x16x32_bf16 v[168:171], v[120:123], v[88:91], v[168:171]
    v_mfma_f32_16x16x32_bf16 v[172:175], v[124:127], v[88:91], v[172:175]
    ds_read_b128 v[88:91], v9 offset:57344
    v_mfma_f32_16x16x32_bf16 v[176:179], v[112:115], v[92:95], v[176:179]
    v_mfma_f32_16x16x32_bf16 v[180:183], v[116:119], v[92:95], v[180:183]
    v_mfma_f32_16x16x32_bf16 v[184:187], v[120:123], v[92:95], v[184:187]
    v_mfma_f32_16x16x32_bf16 v[188:191], v[124:127], v[92:95], v[188:191]
    ds_read_b128 v[92:95], v9 offset:59392
    s_waitcnt lgkmcnt(7)
    v_mfma_f32_16x16x32_bf16 v[192:195], v[96:99], v[64:67], v[192:195]
    v_mfma_f32_16x16x32_bf16 v[196:199], v[100:103], v[64:67], v[196:199]
    v_mfma_f32_16x16x32_bf16 v[200:203], v[104:107], v[64:67], v[200:203]
    v_mfma_f32_16x16x32_bf16 v[204:207], v[108:111], v[64:67], v[204:207]
    s_waitcnt lgkmcnt(6)
    v_mfma_f32_16x16x32_bf16 v[208:211], v[96:99], v[68:71], v[208:211]
    v_mfma_f32_16x16x32_bf16 v[212:215], v[100:103], v[68:71], v[212:215]
    v_mfma_f32_16x16x32_bf16 v[216:219], v[104:107], v[68:71], v[216:219]
    v_mfma_f32_16x16x32_bf16 v[220:223], v[108:111], v[68:71], v[220:223]
    s_waitcnt lgkmcnt(0)
    s_barrier
    v_subrev_u32 v8, 81920, v8
    v_subrev_u32 v9, 81920, v9
    ds_read_b128 v[64:67], v8 offset:16384
    v_mfma_f32_16x16x32_bf16 v[224:227], v[96:99], v[72:75], v[224:227]
    ds_read_b128 v[68:71], v8 offset:18432
    v_mfma_f32_16x16x32_bf16 v[228:231], v[100:103], v[72:75], v[228:231]
    v_mfma_f32_16x16x32_bf16 v[232:235], v[104:107], v[72:75], v[232:235]
    v_mfma_f32_16x16x32_bf16 v[236:239], v[108:111], v[72:75], v[236:239]
    ds_read_b128 v[72:75], v8 offset:24576
    v_mfma_f32_16x16x32_bf16 v[240:243], v[96:99], v[76:79], v[240:243]
    v_subrev_u32 v12, 65536, v12
    v_subrev_u32 v13, 65536, v13
    v_subrev_u32 v14, 65536, v14
    v_subrev_u32 v15, 65536, v15
    ds_read_b64_tr_b16 v[96:97], v12 offset:0
    v_mfma_f32_16x16x32_bf16 v[244:247], v[100:103], v[76:79], v[244:247]
    ds_read_b64_tr_b16 v[98:99], v12 offset:1024
    ds_read_b64_tr_b16 v[100:101], v13 offset:0
    v_mfma_f32_16x16x32_bf16 v[248:251], v[104:107], v[76:79], v[248:251]
    ds_read_b64_tr_b16 v[102:103], v13 offset:1024
    ds_read_b64_tr_b16 v[104:105], v14 offset:0
    v_mfma_f32_16x16x32_bf16 v[252:255], v[108:111], v[76:79], v[252:255]
    ds_read_b64_tr_b16 v[106:107], v14 offset:1024
    ds_read_b64_tr_b16 v[108:109], v15 offset:0
    v_mfma_f32_16x16x32_bf16 v[192:195], v[112:115], v[80:83], v[192:195]
    ds_read_b64_tr_b16 v[110:111], v15 offset:1024
    ds_read_b128 v[76:79], v8 offset:26624
    v_mfma_f32_16x16x32_bf16 v[196:199], v[116:119], v[80:83], v[196:199]
    v_mfma_f32_16x16x32_bf16 v[200:203], v[120:123], v[80:83], v[200:203]
    v_mfma_f32_16x16x32_bf16 v[204:207], v[124:127], v[80:83], v[204:207]
    ds_read_b128 v[80:83], v9 offset:16384
    v_mfma_f32_16x16x32_bf16 v[208:211], v[112:115], v[84:87], v[208:211]
    v_mfma_f32_16x16x32_bf16 v[212:215], v[116:119], v[84:87], v[212:215]
    v_mfma_f32_16x16x32_bf16 v[216:219], v[120:123], v[84:87], v[216:219]
    v_mfma_f32_16x16x32_bf16 v[220:223], v[124:127], v[84:87], v[220:223]
    ds_read_b128 v[84:87], v9 offset:18432
    v_mfma_f32_16x16x32_bf16 v[224:227], v[112:115], v[88:91], v[224:227]
    v_mfma_f32_16x16x32_bf16 v[228:231], v[116:119], v[88:91], v[228:231]
    v_mfma_f32_16x16x32_bf16 v[232:235], v[120:123], v[88:91], v[232:235]
    v_mfma_f32_16x16x32_bf16 v[236:239], v[124:127], v[88:91], v[236:239]
    ds_read_b128 v[88:91], v9 offset:24576
    v_mfma_f32_16x16x32_bf16 v[240:243], v[112:115], v[92:95], v[240:243]
    v_subrev_u32 v24, 65536, v24
    v_subrev_u32 v25, 65536, v25
    v_subrev_u32 v26, 65536, v26
    v_subrev_u32 v27, 65536, v27
    ds_read_b64_tr_b16 v[112:113], v24 offset:0
    v_mfma_f32_16x16x32_bf16 v[244:247], v[116:119], v[92:95], v[244:247]
    ds_read_b64_tr_b16 v[114:115], v24 offset:1024
    ds_read_b64_tr_b16 v[116:117], v25 offset:0
    v_mfma_f32_16x16x32_bf16 v[248:251], v[120:123], v[92:95], v[248:251]
    ds_read_b64_tr_b16 v[118:119], v25 offset:1024
    ds_read_b64_tr_b16 v[120:121], v26 offset:0
    v_mfma_f32_16x16x32_bf16 v[252:255], v[124:127], v[92:95], v[252:255]
    ds_read_b64_tr_b16 v[122:123], v26 offset:1024
    ds_read_b64_tr_b16 v[124:125], v27 offset:0
    s_waitcnt lgkmcnt(15)
    v_mfma_f32_16x16x32_bf16 v[128:131], v[96:99], v[64:67], v[128:131]
    ds_read_b64_tr_b16 v[126:127], v27 offset:1024
    ds_read_b128 v[92:95], v9 offset:26624
    v_mfma_f32_16x16x32_bf16 v[132:135], v[100:103], v[64:67], v[132:135]
    s_waitcnt lgkmcnt(15)
    v_mfma_f32_16x16x32_bf16 v[136:139], v[104:107], v[64:67], v[136:139]
    s_waitcnt lgkmcnt(13)
    v_mfma_f32_16x16x32_bf16 v[140:143], v[108:111], v[64:67], v[140:143]
    v_mfma_f32_16x16x32_bf16 v[48:51], v[96:99], v[44:47], v[48:51]
    v_mfma_f32_16x16x32_bf16 v[52:55], v[100:103], v[44:47], v[52:55]
    v_mfma_f32_16x16x32_bf16 v[56:59], v[104:107], v[44:47], v[56:59]
    v_mfma_f32_16x16x32_bf16 v[60:63], v[108:111], v[44:47], v[60:63]
    s_waitcnt lgkmcnt(0)
    s_barrier
    ds_read_b128 v[64:67], v8 offset:49152
    v_mfma_f32_16x16x32_bf16 v[144:147], v[96:99], v[68:71], v[144:147]
    v_mfma_f32_16x16x32_bf16 v[148:151], v[100:103], v[68:71], v[148:151]
    v_mfma_f32_16x16x32_bf16 v[152:155], v[104:107], v[68:71], v[152:155]
    v_mfma_f32_16x16x32_bf16 v[156:159], v[108:111], v[68:71], v[156:159]
    ds_read_b128 v[68:71], v8 offset:51200
    v_mfma_f32_16x16x32_bf16 v[160:163], v[96:99], v[72:75], v[160:163]
    v_mfma_f32_16x16x32_bf16 v[164:167], v[100:103], v[72:75], v[164:167]
    v_mfma_f32_16x16x32_bf16 v[168:171], v[104:107], v[72:75], v[168:171]
    v_mfma_f32_16x16x32_bf16 v[172:175], v[108:111], v[72:75], v[172:175]
    ds_read_b128 v[72:75], v8 offset:57344
    v_mfma_f32_16x16x32_bf16 v[176:179], v[96:99], v[76:79], v[176:179]
    ds_read_b64_tr_b16 v[96:97], v12 offset:32768
    ds_read_b64_tr_b16 v[98:99], v12 offset:33792
    v_mfma_f32_16x16x32_bf16 v[180:183], v[100:103], v[76:79], v[180:183]
    ds_read_b64_tr_b16 v[100:101], v13 offset:32768
    ds_read_b64_tr_b16 v[102:103], v13 offset:33792
    v_mfma_f32_16x16x32_bf16 v[184:187], v[104:107], v[76:79], v[184:187]
    ds_read_b64_tr_b16 v[104:105], v14 offset:32768
    ds_read_b64_tr_b16 v[106:107], v14 offset:33792
    v_mfma_f32_16x16x32_bf16 v[188:191], v[108:111], v[76:79], v[188:191]
    ds_read_b64_tr_b16 v[108:109], v15 offset:32768
    ds_read_b64_tr_b16 v[110:111], v15 offset:33792
    v_mfma_f32_16x16x32_bf16 v[128:131], v[112:115], v[80:83], v[128:131]
    ds_read_b128 v[76:79], v8 offset:59392
    v_mfma_f32_16x16x32_bf16 v[132:135], v[116:119], v[80:83], v[132:135]
    v_mfma_f32_16x16x32_bf16 v[136:139], v[120:123], v[80:83], v[136:139]
    v_mfma_f32_16x16x32_bf16 v[140:143], v[124:127], v[80:83], v[140:143]
    ds_read_b128 v[80:83], v9 offset:49152
    v_mfma_f32_16x16x32_bf16 v[144:147], v[112:115], v[84:87], v[144:147]
    v_mfma_f32_16x16x32_bf16 v[148:151], v[116:119], v[84:87], v[148:151]
    v_mfma_f32_16x16x32_bf16 v[152:155], v[120:123], v[84:87], v[152:155]
    v_mfma_f32_16x16x32_bf16 v[156:159], v[124:127], v[84:87], v[156:159]
    ds_read_b128 v[84:87], v9 offset:51200
    v_mfma_f32_16x16x32_bf16 v[160:163], v[112:115], v[88:91], v[160:163]
    v_mfma_f32_16x16x32_bf16 v[164:167], v[116:119], v[88:91], v[164:167]
    v_mfma_f32_16x16x32_bf16 v[168:171], v[120:123], v[88:91], v[168:171]
    v_mfma_f32_16x16x32_bf16 v[172:175], v[124:127], v[88:91], v[172:175]
    ds_read_b128 v[88:91], v9 offset:57344
    v_mfma_f32_16x16x32_bf16 v[176:179], v[112:115], v[92:95], v[176:179]
    ds_read_b64_tr_b16 v[112:113], v24 offset:32768
    ds_read_b64_tr_b16 v[114:115], v24 offset:33792
    v_mfma_f32_16x16x32_bf16 v[180:183], v[116:119], v[92:95], v[180:183]
    ds_read_b64_tr_b16 v[116:117], v25 offset:32768
    ds_read_b64_tr_b16 v[118:119], v25 offset:33792
    v_mfma_f32_16x16x32_bf16 v[184:187], v[120:123], v[92:95], v[184:187]
    ds_read_b64_tr_b16 v[120:121], v26 offset:32768
    ds_read_b64_tr_b16 v[122:123], v26 offset:33792
    v_mfma_f32_16x16x32_bf16 v[188:191], v[124:127], v[92:95], v[188:191]
    ds_read_b64_tr_b16 v[124:125], v27 offset:32768
    ds_read_b64_tr_b16 v[126:127], v27 offset:33792
    s_waitcnt lgkmcnt(15)
    v_mfma_f32_16x16x32_bf16 v[128:131], v[96:99], v[64:67], v[128:131]
    ds_read_b128 v[92:95], v9 offset:59392
    v_mfma_f32_16x16x32_bf16 v[132:135], v[100:103], v[64:67], v[132:135]
    s_waitcnt lgkmcnt(15)
    v_mfma_f32_16x16x32_bf16 v[136:139], v[104:107], v[64:67], v[136:139]
    s_waitcnt lgkmcnt(13)
    v_mfma_f32_16x16x32_bf16 v[140:143], v[108:111], v[64:67], v[140:143]
    v_mfma_f32_16x16x32_bf16 v[48:51], v[96:99], v[44:47], v[48:51]
    v_mfma_f32_16x16x32_bf16 v[52:55], v[100:103], v[44:47], v[52:55]
    v_mfma_f32_16x16x32_bf16 v[56:59], v[104:107], v[44:47], v[56:59]
    v_mfma_f32_16x16x32_bf16 v[60:63], v[108:111], v[44:47], v[60:63]
    s_waitcnt lgkmcnt(0)
    s_barrier
    v_add_u32 v8, 65536, v8
    v_add_u32 v9, 65536, v9
    ds_read_b128 v[64:67], v8 offset:16384
    v_mfma_f32_16x16x32_bf16 v[144:147], v[96:99], v[68:71], v[144:147]
    v_mfma_f32_16x16x32_bf16 v[148:151], v[100:103], v[68:71], v[148:151]
    v_mfma_f32_16x16x32_bf16 v[152:155], v[104:107], v[68:71], v[152:155]
    v_mfma_f32_16x16x32_bf16 v[156:159], v[108:111], v[68:71], v[156:159]
    ds_read_b128 v[68:71], v8 offset:18432
    v_mfma_f32_16x16x32_bf16 v[160:163], v[96:99], v[72:75], v[160:163]
    ds_write_b128 v19, v[48:51] offset:0
    ds_write_b128 v19, v[52:55] offset:512
    v_mfma_f32_16x16x32_bf16 v[164:167], v[100:103], v[72:75], v[164:167]
    ds_write_b128 v19, v[56:59] offset:1024
    ds_write_b128 v19, v[60:63] offset:1536
    v_mfma_f32_16x16x32_bf16 v[168:171], v[104:107], v[72:75], v[168:171]
    v_mfma_f32_16x16x32_bf16 v[172:175], v[108:111], v[72:75], v[172:175]
    ds_read_b128 v[72:75], v8 offset:24576
    v_mfma_f32_16x16x32_bf16 v[176:179], v[96:99], v[76:79], v[176:179]
    v_add_u32 v12, 65536, v12
    v_add_u32 v13, 65536, v13
    v_add_u32 v14, 65536, v14
    v_add_u32 v15, 65536, v15
    ds_read_b64_tr_b16 v[96:97], v12 offset:0
    v_mfma_f32_16x16x32_bf16 v[180:183], v[100:103], v[76:79], v[180:183]
    ds_read_b64_tr_b16 v[98:99], v12 offset:1024
    ds_read_b64_tr_b16 v[100:101], v13 offset:0
    v_mfma_f32_16x16x32_bf16 v[184:187], v[104:107], v[76:79], v[184:187]
    ds_read_b64_tr_b16 v[102:103], v13 offset:1024
    ds_read_b64_tr_b16 v[104:105], v14 offset:0
    v_mfma_f32_16x16x32_bf16 v[188:191], v[108:111], v[76:79], v[188:191]
    ds_read_b64_tr_b16 v[106:107], v14 offset:1024
    ds_read_b64_tr_b16 v[108:109], v15 offset:0
    v_mfma_f32_16x16x32_bf16 v[128:131], v[112:115], v[80:83], v[128:131]
    ds_read_b64_tr_b16 v[110:111], v15 offset:1024
    ds_read_b128 v[76:79], v8 offset:26624
    v_mfma_f32_16x16x32_bf16 v[132:135], v[116:119], v[80:83], v[132:135]
    v_mfma_f32_16x16x32_bf16 v[136:139], v[120:123], v[80:83], v[136:139]
    v_mfma_f32_16x16x32_bf16 v[140:143], v[124:127], v[80:83], v[140:143]
    ds_read_b128 v[80:83], v9 offset:16384
    v_mfma_f32_16x16x32_bf16 v[144:147], v[112:115], v[84:87], v[144:147]
    v_mfma_f32_16x16x32_bf16 v[148:151], v[116:119], v[84:87], v[148:151]
    v_mfma_f32_16x16x32_bf16 v[152:155], v[120:123], v[84:87], v[152:155]
    v_mfma_f32_16x16x32_bf16 v[156:159], v[124:127], v[84:87], v[156:159]
    ds_read_b128 v[84:87], v9 offset:18432
    v_mfma_f32_16x16x32_bf16 v[160:163], v[112:115], v[88:91], v[160:163]
    v_mfma_f32_16x16x32_bf16 v[164:167], v[116:119], v[88:91], v[164:167]
    v_mfma_f32_16x16x32_bf16 v[168:171], v[120:123], v[88:91], v[168:171]
    v_mfma_f32_16x16x32_bf16 v[172:175], v[124:127], v[88:91], v[172:175]
    ds_read_b128 v[88:91], v9 offset:24576
    v_mfma_f32_16x16x32_bf16 v[176:179], v[112:115], v[92:95], v[176:179]
    v_add_u32 v24, 65536, v24
    v_add_u32 v25, 65536, v25
    v_add_u32 v26, 65536, v26
    v_add_u32 v27, 65536, v27
    ds_read_b64_tr_b16 v[112:113], v24 offset:0
    v_mfma_f32_16x16x32_bf16 v[180:183], v[116:119], v[92:95], v[180:183]
    ds_read_b64_tr_b16 v[114:115], v24 offset:1024
    ds_read_b64_tr_b16 v[116:117], v25 offset:0
    v_mfma_f32_16x16x32_bf16 v[184:187], v[120:123], v[92:95], v[184:187]
    ds_read_b64_tr_b16 v[118:119], v25 offset:1024
    ds_read_b64_tr_b16 v[120:121], v26 offset:0
    v_mfma_f32_16x16x32_bf16 v[188:191], v[124:127], v[92:95], v[188:191]
    ds_read_b64_tr_b16 v[122:123], v26 offset:1024
    ds_read_b64_tr_b16 v[124:125], v27 offset:0
    s_waitcnt lgkmcnt(15)
    v_mfma_f32_16x16x32_bf16 v[128:131], v[96:99], v[64:67], v[128:131]
    ds_read_b64_tr_b16 v[126:127], v27 offset:1024
    ds_read_b128 v[92:95], v9 offset:26624
    v_mfma_f32_16x16x32_bf16 v[132:135], v[100:103], v[64:67], v[132:135]
    s_waitcnt lgkmcnt(15)
    v_mfma_f32_16x16x32_bf16 v[136:139], v[104:107], v[64:67], v[136:139]
    s_waitcnt lgkmcnt(13)
    v_mfma_f32_16x16x32_bf16 v[140:143], v[108:111], v[64:67], v[140:143]
    v_mfma_f32_16x16x32_bf16 v[48:51], v[96:99], v[44:47], v[48:51]
    v_mfma_f32_16x16x32_bf16 v[52:55], v[100:103], v[44:47], v[52:55]
    v_mfma_f32_16x16x32_bf16 v[56:59], v[104:107], v[44:47], v[56:59]
    v_mfma_f32_16x16x32_bf16 v[60:63], v[108:111], v[44:47], v[60:63]
    s_waitcnt lgkmcnt(0)
    s_barrier
    ds_read_b128 v[64:67], v8 offset:49152
    ds_read_b128 v[32:35], v16 offset:0
    v_mfma_f32_16x16x32_bf16 v[144:147], v[96:99], v[68:71], v[144:147]
    ds_read_b128 v[36:39], v16 offset:512
    v_mfma_f32_16x16x32_bf16 v[148:151], v[100:103], v[68:71], v[148:151]
    v_mfma_f32_16x16x32_bf16 v[152:155], v[104:107], v[68:71], v[152:155]
    v_mfma_f32_16x16x32_bf16 v[156:159], v[108:111], v[68:71], v[156:159]
    ds_read_b128 v[68:71], v8 offset:51200
    v_mfma_f32_16x16x32_bf16 v[160:163], v[96:99], v[72:75], v[160:163]
    v_mfma_f32_16x16x32_bf16 v[164:167], v[100:103], v[72:75], v[164:167]
    v_mfma_f32_16x16x32_bf16 v[168:171], v[104:107], v[72:75], v[168:171]
    v_mfma_f32_16x16x32_bf16 v[172:175], v[108:111], v[72:75], v[172:175]
    ds_read_b128 v[72:75], v8 offset:57344
    s_waitcnt lgkmcnt(2)
    v_add_f32 v48, v48, v32
    v_mfma_f32_16x16x32_bf16 v[176:179], v[96:99], v[76:79], v[176:179]
    ds_read_b64_tr_b16 v[96:97], v12 offset:32768
    ds_read_b64_tr_b16 v[98:99], v12 offset:33792
    v_mfma_f32_16x16x32_bf16 v[180:183], v[100:103], v[76:79], v[180:183]
    ds_read_b64_tr_b16 v[100:101], v13 offset:32768
    ds_read_b64_tr_b16 v[102:103], v13 offset:33792
    v_mfma_f32_16x16x32_bf16 v[184:187], v[104:107], v[76:79], v[184:187]
    ds_read_b64_tr_b16 v[104:105], v14 offset:32768
    ds_read_b64_tr_b16 v[106:107], v14 offset:33792
    v_add_f32 v49, v49, v33
    v_add_f32 v50, v50, v34
    v_add_f32 v51, v51, v35
    v_add_f32 v52, v52, v36
    v_add_f32 v53, v53, v37
    v_add_f32 v54, v54, v38
    v_add_f32 v55, v55, v39
    v_mfma_f32_16x16x32_bf16 v[188:191], v[108:111], v[76:79], v[188:191]
    ds_read_b64_tr_b16 v[108:109], v15 offset:32768
    ds_read_b64_tr_b16 v[110:111], v15 offset:33792
    v_mfma_f32_16x16x32_bf16 v[128:131], v[112:115], v[80:83], v[128:131]
    ds_read_b128 v[76:79], v8 offset:59392
    ds_read_b128 v[32:35], v16 offset:1024
    v_mfma_f32_16x16x32_bf16 v[132:135], v[116:119], v[80:83], v[132:135]
    ds_read_b128 v[36:39], v16 offset:1536
    v_mfma_f32_16x16x32_bf16 v[136:139], v[120:123], v[80:83], v[136:139]
    v_mfma_f32_16x16x32_bf16 v[140:143], v[124:127], v[80:83], v[140:143]
    ds_read_b128 v[80:83], v9 offset:49152
    v_mfma_f32_16x16x32_bf16 v[48:51], v[112:115], v[44:47], v[48:51]
    v_mfma_f32_16x16x32_bf16 v[52:55], v[116:119], v[44:47], v[52:55]
    v_mfma_f32_16x16x32_bf16 v[56:59], v[120:123], v[44:47], v[56:59]
    v_mfma_f32_16x16x32_bf16 v[60:63], v[124:127], v[44:47], v[60:63]
    s_waitcnt lgkmcnt(1)
    s_nop 5
    v_add_f32 v56, v56, v32
    v_add_f32 v57, v57, v33
    v_mfma_f32_16x16x32_bf16 v[144:147], v[112:115], v[84:87], v[144:147]
    v_add_f32 v58, v58, v34
    v_add_f32 v59, v59, v35
    v_mfma_f32_16x16x32_bf16 v[148:151], v[116:119], v[84:87], v[148:151]
    v_add_f32 v60, v60, v36
    v_add_f32 v61, v61, v37
    v_mfma_f32_16x16x32_bf16 v[152:155], v[120:123], v[84:87], v[152:155]
    v_add_f32 v62, v62, v38
    v_add_f32 v63, v63, v39
    v_mfma_f32_16x16x32_bf16 v[156:159], v[124:127], v[84:87], v[156:159]
    ds_read_b128 v[84:87], v9 offset:51200
    v_mfma_f32_16x16x32_bf16 v[160:163], v[112:115], v[88:91], v[160:163]
    v_mfma_f32_16x16x32_bf16 v[164:167], v[116:119], v[88:91], v[164:167]
    v_mfma_f32_16x16x32_bf16 v[168:171], v[120:123], v[88:91], v[168:171]
    v_mfma_f32_16x16x32_bf16 v[172:175], v[124:127], v[88:91], v[172:175]
    ds_read_b128 v[88:91], v9 offset:57344
    v_mfma_f32_16x16x32_bf16 v[176:179], v[112:115], v[92:95], v[176:179]
    ds_read_b64_tr_b16 v[112:113], v24 offset:32768
    ds_read_b64_tr_b16 v[114:115], v24 offset:33792
    v_mfma_f32_16x16x32_bf16 v[180:183], v[116:119], v[92:95], v[180:183]
    ds_read_b64_tr_b16 v[116:117], v25 offset:32768
    ds_read_b64_tr_b16 v[118:119], v25 offset:33792
    v_mfma_f32_16x16x32_bf16 v[184:187], v[120:123], v[92:95], v[184:187]
    ds_read_b64_tr_b16 v[120:121], v26 offset:32768
    ds_read_b64_tr_b16 v[122:123], v26 offset:33792
    v_mfma_f32_16x16x32_bf16 v[188:191], v[124:127], v[92:95], v[188:191]
    ds_read_b64_tr_b16 v[124:125], v27 offset:32768
    ds_read_b64_tr_b16 v[126:127], v27 offset:33792
    v_mfma_f32_16x16x32_bf16 v[128:131], v[96:99], v[64:67], v[128:131]
    ds_read_b128 v[92:95], v9 offset:59392
    ds_read_b128 v[32:35], v18 offset:0
    v_mfma_f32_16x16x32_bf16 v[132:135], v[100:103], v[64:67], v[132:135]
    ds_read_b128 v[36:39], v18 offset:1024
    v_mfma_f32_16x16x32_bf16 v[136:139], v[104:107], v[64:67], v[136:139]
    v_mfma_f32_16x16x32_bf16 v[140:143], v[108:111], v[64:67], v[140:143]
    v_mfma_f32_16x16x32_bf16 v[48:51], v[96:99], v[44:47], v[48:51]
    v_mfma_f32_16x16x32_bf16 v[52:55], v[100:103], v[44:47], v[52:55]
    v_mfma_f32_16x16x32_bf16 v[56:59], v[104:107], v[44:47], v[56:59]
    v_mfma_f32_16x16x32_bf16 v[60:63], v[108:111], v[44:47], v[60:63]
    s_waitcnt lgkmcnt(2)
    s_barrier
    v_add_u32 v8, 16384, v8
    v_add_u32 v9, 16384, v9
    ds_read_b128 v[64:67], v8 offset:49152
    v_mfma_f32_16x16x32_bf16 v[144:147], v[96:99], v[68:71], v[144:147]
    v_mfma_f32_16x16x32_bf16 v[148:151], v[100:103], v[68:71], v[148:151]
    v_mfma_f32_16x16x32_bf16 v[152:155], v[104:107], v[68:71], v[152:155]
    v_mfma_f32_16x16x32_bf16 v[156:159], v[108:111], v[68:71], v[156:159]
    ds_read_b128 v[68:71], v8 offset:51200
    v_mfma_f32_16x16x32_bf16 v[160:163], v[96:99], v[72:75], v[160:163]
    v_mfma_f32_16x16x32_bf16 v[164:167], v[100:103], v[72:75], v[164:167]
    v_mfma_f32_16x16x32_bf16 v[168:171], v[104:107], v[72:75], v[168:171]
    v_mfma_f32_16x16x32_bf16 v[172:175], v[108:111], v[72:75], v[172:175]
    ds_read_b128 v[72:75], v8 offset:57344
    v_mfma_f32_16x16x32_bf16 v[176:179], v[96:99], v[76:79], v[176:179]
    v_subrev_u32 v12, 65536, v12
    v_subrev_u32 v13, 65536, v13
    v_subrev_u32 v14, 65536, v14
    v_subrev_u32 v15, 65536, v15
    ds_read_b64_tr_b16 v[96:97], v12 offset:0
    v_mfma_f32_16x16x32_bf16 v[180:183], v[100:103], v[76:79], v[180:183]
    ds_read_b64_tr_b16 v[98:99], v12 offset:1024
    ds_read_b64_tr_b16 v[100:101], v13 offset:0
    v_mfma_f32_16x16x32_bf16 v[184:187], v[104:107], v[76:79], v[184:187]
    ds_read_b64_tr_b16 v[102:103], v13 offset:1024
    ds_read_b64_tr_b16 v[104:105], v14 offset:0
    v_mfma_f32_16x16x32_bf16 v[188:191], v[108:111], v[76:79], v[188:191]
    ds_read_b64_tr_b16 v[106:107], v14 offset:1024
    ds_read_b64_tr_b16 v[108:109], v15 offset:0
    v_mfma_f32_16x16x32_bf16 v[128:131], v[112:115], v[80:83], v[128:131]
    ds_read_b64_tr_b16 v[110:111], v15 offset:1024
    ds_read_b128 v[76:79], v8 offset:59392
    v_mfma_f32_16x16x32_bf16 v[132:135], v[116:119], v[80:83], v[132:135]
    v_mfma_f32_16x16x32_bf16 v[136:139], v[120:123], v[80:83], v[136:139]
    v_mfma_f32_16x16x32_bf16 v[140:143], v[124:127], v[80:83], v[140:143]
    ds_read_b128 v[80:83], v9 offset:49152
    v_mfma_f32_16x16x32_bf16 v[48:51], v[112:115], v[44:47], v[48:51]
    v_mfma_f32_16x16x32_bf16 v[52:55], v[116:119], v[44:47], v[52:55]
    v_mfma_f32_16x16x32_bf16 v[56:59], v[120:123], v[44:47], v[56:59]
    v_mfma_f32_16x16x32_bf16 v[60:63], v[124:127], v[44:47], v[60:63]
    v_mfma_f32_16x16x32_bf16 v[144:147], v[112:115], v[84:87], v[144:147]
    v_mfma_f32_16x16x32_bf16 v[148:151], v[116:119], v[84:87], v[148:151]
    v_mfma_f32_16x16x32_bf16 v[152:155], v[120:123], v[84:87], v[152:155]
    v_mfma_f32_16x16x32_bf16 v[156:159], v[124:127], v[84:87], v[156:159]
    ds_read_b128 v[84:87], v9 offset:51200
    s_waitcnt lgkmcnt(14)
    v_and_b32 v32, 0xffff0000, v32
    v_mfma_f32_16x16x32_bf16 v[160:163], v[112:115], v[88:91], v[160:163]
    v_pk_fma_f32 v[128:129], v[48:49], v[32:33], v[128:129] op_sel_hi:[1,0,1] neg_lo:[0,1,0] neg_hi:[0,1,0]
    v_pk_fma_f32 v[130:131], v[50:51], v[32:33], v[130:131] op_sel_hi:[1,0,1] neg_lo:[0,1,0] neg_hi:[0,1,0]
    v_mfma_f32_16x16x32_bf16 v[164:167], v[116:119], v[88:91], v[164:167]
    v_pk_fma_f32 v[132:133], v[52:53], v[32:33], v[132:133] op_sel_hi:[1,0,1] neg_lo:[0,1,0] neg_hi:[0,1,0]
    v_pk_fma_f32 v[134:135], v[54:55], v[32:33], v[134:135] op_sel_hi:[1,0,1] neg_lo:[0,1,0] neg_hi:[0,1,0]
    v_mfma_f32_16x16x32_bf16 v[168:171], v[120:123], v[88:91], v[168:171]
    v_pk_fma_f32 v[136:137], v[56:57], v[32:33], v[136:137] op_sel_hi:[1,0,1] neg_lo:[0,1,0] neg_hi:[0,1,0]
    v_pk_fma_f32 v[138:139], v[58:59], v[32:33], v[138:139] op_sel_hi:[1,0,1] neg_lo:[0,1,0] neg_hi:[0,1,0]
    v_mfma_f32_16x16x32_bf16 v[172:175], v[124:127], v[88:91], v[172:175]
    ds_read_b128 v[88:91], v9 offset:57344
    v_pk_fma_f32 v[140:141], v[60:61], v[32:33], v[140:141] op_sel_hi:[1,0,1] neg_lo:[0,1,0] neg_hi:[0,1,0]
    v_mfma_f32_16x16x32_bf16 v[176:179], v[112:115], v[92:95], v[176:179]
    v_subrev_u32 v24, 65536, v24
    v_subrev_u32 v25, 65536, v25
    v_subrev_u32 v26, 65536, v26
    v_subrev_u32 v27, 65536, v27
    ds_read_b64_tr_b16 v[112:113], v24 offset:0
    v_mfma_f32_16x16x32_bf16 v[180:183], v[116:119], v[92:95], v[180:183]
    ds_read_b64_tr_b16 v[114:115], v24 offset:1024
    ds_read_b64_tr_b16 v[116:117], v25 offset:0
    v_mfma_f32_16x16x32_bf16 v[184:187], v[120:123], v[92:95], v[184:187]
    ds_read_b64_tr_b16 v[118:119], v25 offset:1024
    ds_read_b64_tr_b16 v[120:121], v26 offset:0
    v_mfma_f32_16x16x32_bf16 v[188:191], v[124:127], v[92:95], v[188:191]
    ds_read_b64_tr_b16 v[122:123], v26 offset:1024
    ds_read_b64_tr_b16 v[124:125], v27 offset:0
    s_waitcnt lgkmcnt(15)
    v_mfma_f32_16x16x32_bf16 v[192:195], v[96:99], v[64:67], v[192:195]
    ds_read_b64_tr_b16 v[126:127], v27 offset:1024
    ds_read_b128 v[92:95], v9 offset:59392
    v_mfma_f32_16x16x32_bf16 v[196:199], v[100:103], v[64:67], v[196:199]
    v_pk_fma_f32 v[142:143], v[62:63], v[32:33], v[142:143] op_sel_hi:[1,0,1] neg_lo:[0,1,0] neg_hi:[0,1,0]
    v_pk_mul_f32 v[128:129], v[128:129], v[36:37] op_sel_hi:[1,0]
    s_waitcnt lgkmcnt(15)
    v_mfma_f32_16x16x32_bf16 v[200:203], v[104:107], v[64:67], v[200:203]
    v_pk_mul_f32 v[130:131], v[130:131], v[36:37] op_sel_hi:[1,0]
    v_pk_mul_f32 v[132:133], v[132:133], v[36:37] op_sel_hi:[1,0]
    s_waitcnt lgkmcnt(13)
    v_mfma_f32_16x16x32_bf16 v[204:207], v[108:111], v[64:67], v[204:207]
    v_pk_mul_f32 v[134:135], v[134:135], v[36:37] op_sel_hi:[1,0]
    v_pk_mul_f32 v[136:137], v[136:137], v[36:37] op_sel_hi:[1,0]
    v_mfma_f32_16x16x32_bf16 v[208:211], v[96:99], v[68:71], v[208:211]
    v_pk_mul_f32 v[138:139], v[138:139], v[36:37] op_sel_hi:[1,0]
    v_pk_mul_f32 v[140:141], v[140:141], v[36:37] op_sel_hi:[1,0]
    v_mfma_f32_16x16x32_bf16 v[212:215], v[100:103], v[68:71], v[212:215]
    v_pk_mul_f32 v[142:143], v[142:143], v[36:37] op_sel_hi:[1,0]
    s_add_u32 s38, s42, 0
    v_cvt_pk_bf16_f32 v128, v128, v129
    v_mfma_f32_16x16x32_bf16 v[216:219], v[104:107], v[68:71], v[216:219]
    v_cvt_pk_bf16_f32 v129, v130, v131
    v_cvt_pk_bf16_f32 v130, v132, v133
    v_mfma_f32_16x16x32_bf16 v[220:223], v[108:111], v[68:71], v[220:223]
    s_waitcnt lgkmcnt(0)
    s_barrier
    v_subrev_u32 v8, 81920, v8
    v_subrev_u32 v9, 81920, v9
    ds_read_b128 v[64:67], v8 offset:16384
    v_mfma_f32_16x16x32_bf16 v[224:227], v[96:99], v[72:75], v[224:227]
    ds_read_b128 v[68:71], v8 offset:18432
    v_cvt_pk_bf16_f32 v131, v134, v135
    v_mfma_f32_16x16x32_bf16 v[228:231], v[100:103], v[72:75], v[228:231]
    v_pk_max_i16 v128, v128, 0
    v_pk_max_i16 v129, v129, 0
    v_mfma_f32_16x16x32_bf16 v[232:235], v[104:107], v[72:75], v[232:235]
    v_pk_max_i16 v130, v130, 0
    v_pk_max_i16 v131, v131, 0
    v_mfma_f32_16x16x32_bf16 v[236:239], v[108:111], v[72:75], v[236:239]
    ds_read_b128 v[72:75], v8 offset:24576
    buffer_store_dwordx4 v[128:131], v20, s[24:27], s38 offen offset:0 sc1
    v_mfma_f32_16x16x32_bf16 v[240:243], v[96:99], v[76:79], v[240:243]
    ds_read_b64_tr_b16 v[96:97], v12 offset:32768
    ds_read_b64_tr_b16 v[98:99], v12 offset:33792
    v_mfma_f32_16x16x32_bf16 v[244:247], v[100:103], v[76:79], v[244:247]
    ds_read_b64_tr_b16 v[100:101], v13 offset:32768
    ds_read_b64_tr_b16 v[102:103], v13 offset:33792
    v_mfma_f32_16x16x32_bf16 v[248:251], v[104:107], v[76:79], v[248:251]
    ds_read_b64_tr_b16 v[104:105], v14 offset:32768
    ds_read_b64_tr_b16 v[106:107], v14 offset:33792
    v_mfma_f32_16x16x32_bf16 v[252:255], v[108:111], v[76:79], v[252:255]
    ds_read_b64_tr_b16 v[108:109], v15 offset:32768
    ds_read_b64_tr_b16 v[110:111], v15 offset:33792
    v_mfma_f32_16x16x32_bf16 v[192:195], v[112:115], v[80:83], v[192:195]
    ds_read_b128 v[76:79], v8 offset:26624
    s_add_u32 s39, s42, 16384
    v_cvt_pk_bf16_f32 v136, v136, v137
    v_mfma_f32_16x16x32_bf16 v[196:199], v[116:119], v[80:83], v[196:199]
    v_cvt_pk_bf16_f32 v137, v138, v139
    v_cvt_pk_bf16_f32 v138, v140, v141
    v_mfma_f32_16x16x32_bf16 v[200:203], v[120:123], v[80:83], v[200:203]
    v_cvt_pk_bf16_f32 v139, v142, v143
    v_pk_max_i16 v136, v136, 0
    v_mfma_f32_16x16x32_bf16 v[204:207], v[124:127], v[80:83], v[204:207]
    ds_read_b128 v[80:83], v9 offset:16384
    v_pk_max_i16 v137, v137, 0
    v_mfma_f32_16x16x32_bf16 v[208:211], v[112:115], v[84:87], v[208:211]
    v_pk_max_i16 v138, v138, 0
    v_pk_max_i16 v139, v139, 0
    v_mfma_f32_16x16x32_bf16 v[212:215], v[116:119], v[84:87], v[212:215]
    buffer_store_dwordx4 v[136:139], v20, s[24:27], s39 offen offset:0 sc1
    v_and_b32 v33, 0xffff0000, v33
    v_mfma_f32_16x16x32_bf16 v[216:219], v[120:123], v[84:87], v[216:219]
    v_pk_fma_f32 v[144:145], v[48:49], v[32:33], v[144:145] op_sel:[0,1,0] op_sel_hi:[1,1,1] neg_lo:[0,1,0] neg_hi:[0,1,0]
    v_pk_fma_f32 v[146:147], v[50:51], v[32:33], v[146:147] op_sel:[0,1,0] op_sel_hi:[1,1,1] neg_lo:[0,1,0] neg_hi:[0,1,0]
    v_mfma_f32_16x16x32_bf16 v[220:223], v[124:127], v[84:87], v[220:223]
    ds_read_b128 v[84:87], v9 offset:18432
    v_pk_fma_f32 v[148:149], v[52:53], v[32:33], v[148:149] op_sel:[0,1,0] op_sel_hi:[1,1,1] neg_lo:[0,1,0] neg_hi:[0,1,0]
    v_mfma_f32_16x16x32_bf16 v[224:227], v[112:115], v[88:91], v[224:227]
    v_pk_fma_f32 v[150:151], v[54:55], v[32:33], v[150:151] op_sel:[0,1,0] op_sel_hi:[1,1,1] neg_lo:[0,1,0] neg_hi:[0,1,0]
    v_pk_fma_f32 v[152:153], v[56:57], v[32:33], v[152:153] op_sel:[0,1,0] op_sel_hi:[1,1,1] neg_lo:[0,1,0] neg_hi:[0,1,0]
    v_mfma_f32_16x16x32_bf16 v[228:231], v[116:119], v[88:91], v[228:231]
    v_pk_fma_f32 v[154:155], v[58:59], v[32:33], v[154:155] op_sel:[0,1,0] op_sel_hi:[1,1,1] neg_lo:[0,1,0] neg_hi:[0,1,0]
    v_pk_fma_f32 v[156:157], v[60:61], v[32:33], v[156:157] op_sel:[0,1,0] op_sel_hi:[1,1,1] neg_lo:[0,1,0] neg_hi:[0,1,0]
    v_mfma_f32_16x16x32_bf16 v[232:235], v[120:123], v[88:91], v[232:235]
    v_pk_fma_f32 v[158:159], v[62:63], v[32:33], v[158:159] op_sel:[0,1,0] op_sel_hi:[1,1,1] neg_lo:[0,1,0] neg_hi:[0,1,0]
    v_pk_mul_f32 v[144:145], v[144:145], v[36:37] op_sel:[0,1] op_sel_hi:[1,1]
    v_mfma_f32_16x16x32_bf16 v[236:239], v[124:127], v[88:91], v[236:239]
    ds_read_b128 v[88:91], v9 offset:24576
    v_pk_mul_f32 v[146:147], v[146:147], v[36:37] op_sel:[0,1] op_sel_hi:[1,1]
    v_mfma_f32_16x16x32_bf16 v[240:243], v[112:115], v[92:95], v[240:243]
    ds_read_b64_tr_b16 v[112:113], v24 offset:32768
    ds_read_b64_tr_b16 v[114:115], v24 offset:33792
    v_mfma_f32_16x16x32_bf16 v[244:247], v[116:119], v[92:95], v[244:247]
    ds_read_b64_tr_b16 v[116:117], v25 offset:32768
    ds_read_b64_tr_b16 v[118:119], v25 offset:33792
    v_mfma_f32_16x16x32_bf16 v[248:251], v[120:123], v[92:95], v[248:251]
    ds_read_b64_tr_b16 v[120:121], v26 offset:32768
    ds_read_b64_tr_b16 v[122:123], v26 offset:33792
    v_mfma_f32_16x16x32_bf16 v[252:255], v[124:127], v[92:95], v[252:255]
    ds_read_b64_tr_b16 v[124:125], v27 offset:32768
    ds_read_b64_tr_b16 v[126:127], v27 offset:33792
    s_waitcnt lgkmcnt(15)
    v_mfma_f32_16x16x32_bf16 v[192:195], v[96:99], v[64:67], v[192:195]
    ds_read_b128 v[92:95], v9 offset:26624
    v_pk_mul_f32 v[148:149], v[148:149], v[36:37] op_sel:[0,1] op_sel_hi:[1,1]
    v_mfma_f32_16x16x32_bf16 v[196:199], v[100:103], v[64:67], v[196:199]
    v_pk_mul_f32 v[150:151], v[150:151], v[36:37] op_sel:[0,1] op_sel_hi:[1,1]
    v_pk_mul_f32 v[152:153], v[152:153], v[36:37] op_sel:[0,1] op_sel_hi:[1,1]
    s_waitcnt lgkmcnt(15)
    v_mfma_f32_16x16x32_bf16 v[200:203], v[104:107], v[64:67], v[200:203]
    v_pk_mul_f32 v[154:155], v[154:155], v[36:37] op_sel:[0,1] op_sel_hi:[1,1]
    v_pk_mul_f32 v[156:157], v[156:157], v[36:37] op_sel:[0,1] op_sel_hi:[1,1]
    s_waitcnt lgkmcnt(13)
    v_mfma_f32_16x16x32_bf16 v[204:207], v[108:111], v[64:67], v[204:207]
    v_pk_mul_f32 v[158:159], v[158:159], v[36:37] op_sel:[0,1] op_sel_hi:[1,1]
    s_add_u32 s38, s42, 0
    v_cvt_pk_bf16_f32 v144, v144, v145
    v_mfma_f32_16x16x32_bf16 v[208:211], v[96:99], v[68:71], v[208:211]
    v_cvt_pk_bf16_f32 v145, v146, v147
    v_cvt_pk_bf16_f32 v146, v148, v149
    v_mfma_f32_16x16x32_bf16 v[212:215], v[100:103], v[68:71], v[212:215]
    v_cvt_pk_bf16_f32 v147, v150, v151
    v_pk_max_i16 v144, v144, 0
    v_mfma_f32_16x16x32_bf16 v[216:219], v[104:107], v[68:71], v[216:219]
    v_pk_max_i16 v145, v145, 0
    v_pk_max_i16 v146, v146, 0
    v_mfma_f32_16x16x32_bf16 v[220:223], v[108:111], v[68:71], v[220:223]
    s_waitcnt lgkmcnt(0)
    s_barrier
    ds_read_b128 v[64:67], v8 offset:49152
    ds_read_b128 v[68:71], v8 offset:51200
    v_mfma_f32_16x16x32_bf16 v[224:227], v[96:99], v[72:75], v[224:227]
    v_pk_max_i16 v147, v147, 0
    buffer_store_dwordx4 v[144:147], v20, s[24:27], s38 offen offset:2048 sc1
    v_mfma_f32_16x16x32_bf16 v[228:231], v[100:103], v[72:75], v[228:231]
    s_add_u32 s39, s42, 16384
    v_cvt_pk_bf16_f32 v152, v152, v153
    v_cvt_pk_bf16_f32 v153, v154, v155
    v_mfma_f32_16x16x32_bf16 v[232:235], v[104:107], v[72:75], v[232:235]
    v_cvt_pk_bf16_f32 v154, v156, v157
    v_cvt_pk_bf16_f32 v155, v158, v159
    v_mfma_f32_16x16x32_bf16 v[236:239], v[108:111], v[72:75], v[236:239]
    ds_read_b128 v[72:75], v8 offset:57344
    v_pk_max_i16 v152, v152, 0
    v_mfma_f32_16x16x32_bf16 v[240:243], v[96:99], v[76:79], v[240:243]
    v_add_u32 v12, 65536, v12
    v_add_u32 v13, 65536, v13
    v_add_u32 v14, 65536, v14
    v_add_u32 v15, 65536, v15
    ds_read_b64_tr_b16 v[96:97], v12 offset:0
    v_mfma_f32_16x16x32_bf16 v[244:247], v[100:103], v[76:79], v[244:247]
    ds_read_b64_tr_b16 v[98:99], v12 offset:1024
    ds_read_b64_tr_b16 v[100:101], v13 offset:0
    v_mfma_f32_16x16x32_bf16 v[248:251], v[104:107], v[76:79], v[248:251]
    ds_read_b64_tr_b16 v[102:103], v13 offset:1024
    ds_read_b64_tr_b16 v[104:105], v14 offset:0
    v_mfma_f32_16x16x32_bf16 v[252:255], v[108:111], v[76:79], v[252:255]
    ds_read_b64_tr_b16 v[106:107], v14 offset:1024
    ds_read_b64_tr_b16 v[108:109], v15 offset:0
    v_mfma_f32_16x16x32_bf16 v[192:195], v[112:115], v[80:83], v[192:195]
    ds_read_b64_tr_b16 v[110:111], v15 offset:1024
    ds_read_b128 v[76:79], v8 offset:59392
    v_mfma_f32_16x16x32_bf16 v[196:199], v[116:119], v[80:83], v[196:199]
    v_pk_max_i16 v153, v153, 0
    v_pk_max_i16 v154, v154, 0
    v_mfma_f32_16x16x32_bf16 v[200:203], v[120:123], v[80:83], v[200:203]
    v_pk_max_i16 v155, v155, 0
    buffer_store_dwordx4 v[152:155], v20, s[24:27], s39 offen offset:2048 sc1
    v_mfma_f32_16x16x32_bf16 v[204:207], v[124:127], v[80:83], v[204:207]
    ds_read_b128 v[80:83], v9 offset:49152
    v_and_b32 v34, 0xffff0000, v34
    v_mfma_f32_16x16x32_bf16 v[208:211], v[112:115], v[84:87], v[208:211]
    v_pk_fma_f32 v[160:161], v[48:49], v[34:35], v[160:161] op_sel_hi:[1,0,1] neg_lo:[0,1,0] neg_hi:[0,1,0]
    v_pk_fma_f32 v[162:163], v[50:51], v[34:35], v[162:163] op_sel_hi:[1,0,1] neg_lo:[0,1,0] neg_hi:[0,1,0]
    v_mfma_f32_16x16x32_bf16 v[212:215], v[116:119], v[84:87], v[212:215]
    v_pk_fma_f32 v[164:165], v[52:53], v[34:35], v[164:165] op_sel_hi:[1,0,1] neg_lo:[0,1,0] neg_hi:[0,1,0]
    v_pk_fma_f32 v[166:167], v[54:55], v[34:35], v[166:167] op_sel_hi:[1,0,1] neg_lo:[0,1,0] neg_hi:[0,1,0]
    v_mfma_f32_16x16x32_bf16 v[216:219], v[120:123], v[84:87], v[216:219]
    v_pk_fma_f32 v[168:169], v[56:57], v[34:35], v[168:169] op_sel_hi:[1,0,1] neg_lo:[0,1,0] neg_hi:[0,1,0]
    v_pk_fma_f32 v[170:171], v[58:59], v[34:35], v[170:171] op_sel_hi:[1,0,1] neg_lo:[0,1,0] neg_hi:[0,1,0]
    v_mfma_f32_16x16x32_bf16 v[220:223], v[124:127], v[84:87], v[220:223]
    ds_read_b128 v[84:87], v9 offset:51200
    v_pk_fma_f32 v[172:173], v[60:61], v[34:35], v[172:173] op_sel_hi:[1,0,1] neg_lo:[0,1,0] neg_hi:[0,1,0]
    v_mfma_f32_16x16x32_bf16 v[224:227], v[112:115], v[88:91], v[224:227]
    v_pk_fma_f32 v[174:175], v[62:63], v[34:35], v[174:175] op_sel_hi:[1,0,1] neg_lo:[0,1,0] neg_hi:[0,1,0]
    v_pk_mul_f32 v[160:161], v[160:161], v[38:39] op_sel_hi:[1,0]
    v_mfma_f32_16x16x32_bf16 v[228:231], v[116:119], v[88:91], v[228:231]
    v_pk_mul_f32 v[162:163], v[162:163], v[38:39] op_sel_hi:[1,0]
    v_pk_mul_f32 v[164:165], v[164:165], v[38:39] op_sel_hi:[1,0]
    v_mfma_f32_16x16x32_bf16 v[232:235], v[120:123], v[88:91], v[232:235]
    v_pk_mul_f32 v[166:167], v[166:167], v[38:39] op_sel_hi:[1,0]
    v_pk_mul_f32 v[168:169], v[168:169], v[38:39] op_sel_hi:[1,0]
    v_mfma_f32_16x16x32_bf16 v[236:239], v[124:127], v[88:91], v[236:239]
    ds_read_b128 v[88:91], v9 offset:57344
    v_pk_mul_f32 v[170:171], v[170:171], v[38:39] op_sel_hi:[1,0]
    v_mfma_f32_16x16x32_bf16 v[240:243], v[112:115], v[92:95], v[240:243]
    v_add_u32 v24, 65536, v24
    v_add_u32 v25, 65536, v25
    v_add_u32 v26, 65536, v26
    v_add_u32 v27, 65536, v27
    ds_read_b64_tr_b16 v[112:113], v24 offset:0
    v_mfma_f32_16x16x32_bf16 v[244:247], v[116:119], v[92:95], v[244:247]
    ds_read_b64_tr_b16 v[114:115], v24 offset:1024
    ds_read_b64_tr_b16 v[116:117], v25 offset:0
    v_mfma_f32_16x16x32_bf16 v[248:251], v[120:123], v[92:95], v[248:251]
    ds_read_b64_tr_b16 v[118:119], v25 offset:1024
    ds_read_b64_tr_b16 v[120:121], v26 offset:0
    v_mfma_f32_16x16x32_bf16 v[252:255], v[124:127], v[92:95], v[252:255]
    ds_read_b64_tr_b16 v[122:123], v26 offset:1024
    ds_read_b64_tr_b16 v[124:125], v27 offset:0
    s_waitcnt lgkmcnt(15)
    v_mfma_f32_16x16x32_bf16 v[192:195], v[96:99], v[64:67], v[192:195]
    ds_read_b64_tr_b16 v[126:127], v27 offset:1024
    ds_read_b128 v[92:95], v9 offset:59392
    v_mfma_f32_16x16x32_bf16 v[196:199], v[100:103], v[64:67], v[196:199]
    v_pk_mul_f32 v[172:173], v[172:173], v[38:39] op_sel_hi:[1,0]
    v_pk_mul_f32 v[174:175], v[174:175], v[38:39] op_sel_hi:[1,0]
    s_waitcnt lgkmcnt(15)
    v_mfma_f32_16x16x32_bf16 v[200:203], v[104:107], v[64:67], v[200:203]
    s_add_u32 s38, s42, 8192
    v_cvt_pk_bf16_f32 v160, v160, v161
    v_cvt_pk_bf16_f32 v161, v162, v163
    s_waitcnt lgkmcnt(13)
    v_mfma_f32_16x16x32_bf16 v[204:207], v[108:111], v[64:67], v[204:207]
    v_cvt_pk_bf16_f32 v162, v164, v165
    v_cvt_pk_bf16_f32 v163, v166, v167
    v_mfma_f32_16x16x32_bf16 v[208:211], v[96:99], v[68:71], v[208:211]
    v_pk_max_i16 v160, v160, 0
    v_pk_max_i16 v161, v161, 0
    v_mfma_f32_16x16x32_bf16 v[212:215], v[100:103], v[68:71], v[212:215]
    v_pk_max_i16 v162, v162, 0
    v_pk_max_i16 v163, v163, 0
    v_mfma_f32_16x16x32_bf16 v[216:219], v[104:107], v[68:71], v[216:219]
    buffer_store_dwordx4 v[160:163], v20, s[24:27], s38 offen offset:0 sc1
    s_add_u32 s39, s42, 24576
    v_cvt_pk_bf16_f32 v168, v168, v169
    v_mfma_f32_16x16x32_bf16 v[220:223], v[108:111], v[68:71], v[220:223]
    s_waitcnt lgkmcnt(0)
    s_barrier
    v_add_u32 v8, 65536, v8
    v_add_u32 v9, 65536, v9
    ds_read_b128 v[64:67], v8 offset:16384
    v_mfma_f32_16x16x32_bf16 v[224:227], v[96:99], v[72:75], v[224:227]
    ds_read_b128 v[68:71], v8 offset:18432
    v_cvt_pk_bf16_f32 v169, v170, v171
    v_mfma_f32_16x16x32_bf16 v[228:231], v[100:103], v[72:75], v[228:231]
    v_cvt_pk_bf16_f32 v170, v172, v173
    v_cvt_pk_bf16_f32 v171, v174, v175
    v_mfma_f32_16x16x32_bf16 v[232:235], v[104:107], v[72:75], v[232:235]
    v_pk_max_i16 v168, v168, 0
    v_pk_max_i16 v169, v169, 0
    v_mfma_f32_16x16x32_bf16 v[236:239], v[108:111], v[72:75], v[236:239]
    ds_read_b128 v[72:75], v8 offset:24576
    v_pk_max_i16 v170, v170, 0
    v_mfma_f32_16x16x32_bf16 v[240:243], v[96:99], v[76:79], v[240:243]
    ds_read_b64_tr_b16 v[96:97], v12 offset:32768
    ds_read_b64_tr_b16 v[98:99], v12 offset:33792
    v_mfma_f32_16x16x32_bf16 v[244:247], v[100:103], v[76:79], v[244:247]
    ds_read_b64_tr_b16 v[100:101], v13 offset:32768
    ds_read_b64_tr_b16 v[102:103], v13 offset:33792
    v_mfma_f32_16x16x32_bf16 v[248:251], v[104:107], v[76:79], v[248:251]
    ds_read_b64_tr_b16 v[104:105], v14 offset:32768
    ds_read_b64_tr_b16 v[106:107], v14 offset:33792
    v_mfma_f32_16x16x32_bf16 v[252:255], v[108:111], v[76:79], v[252:255]
    ds_read_b64_tr_b16 v[108:109], v15 offset:32768
    ds_read_b64_tr_b16 v[110:111], v15 offset:33792
    v_mfma_f32_16x16x32_bf16 v[192:195], v[112:115], v[80:83], v[192:195]
    ds_read_b128 v[76:79], v8 offset:26624
    v_pk_max_i16 v171, v171, 0
    v_mfma_f32_16x16x32_bf16 v[196:199], v[116:119], v[80:83], v[196:199]
    buffer_store_dwordx4 v[168:171], v20, s[24:27], s39 offen offset:0 sc1
    v_and_b32 v35, 0xffff0000, v35
    v_mfma_f32_16x16x32_bf16 v[200:203], v[120:123], v[80:83], v[200:203]
    v_pk_fma_f32 v[176:177], v[48:49], v[34:35], v[176:177] op_sel:[0,1,0] op_sel_hi:[1,1,1] neg_lo:[0,1,0] neg_hi:[0,1,0]
    v_pk_fma_f32 v[178:179], v[50:51], v[34:35], v[178:179] op_sel:[0,1,0] op_sel_hi:[1,1,1] neg_lo:[0,1,0] neg_hi:[0,1,0]
    v_mfma_f32_16x16x32_bf16 v[204:207], v[124:127], v[80:83], v[204:207]
    ds_read_b128 v[80:83], v9 offset:16384
    v_pk_fma_f32 v[180:181], v[52:53], v[34:35], v[180:181] op_sel:[0,1,0] op_sel_hi:[1,1,1] neg_lo:[0,1,0] neg_hi:[0,1,0]
    v_mfma_f32_16x16x32_bf16 v[208:211], v[112:115], v[84:87], v[208:211]
    v_pk_fma_f32 v[182:183], v[54:55], v[34:35], v[182:183] op_sel:[0,1,0] op_sel_hi:[1,1,1] neg_lo:[0,1,0] neg_hi:[0,1,0]
    v_pk_fma_f32 v[184:185], v[56:57], v[34:35], v[184:185] op_sel:[0,1,0] op_sel_hi:[1,1,1] neg_lo:[0,1,0] neg_hi:[0,1,0]
    v_mfma_f32_16x16x32_bf16 v[212:215], v[116:119], v[84:87], v[212:215]
    v_pk_fma_f32 v[186:187], v[58:59], v[34:35], v[186:187] op_sel:[0,1,0] op_sel_hi:[1,1,1] neg_lo:[0,1,0] neg_hi:[0,1,0]
    v_pk_fma_f32 v[188:189], v[60:61], v[34:35], v[188:189] op_sel:[0,1,0] op_sel_hi:[1,1,1] neg_lo:[0,1,0] neg_hi:[0,1,0]
    v_mfma_f32_16x16x32_bf16 v[216:219], v[120:123], v[84:87], v[216:219]
    v_pk_fma_f32 v[190:191], v[62:63], v[34:35], v[190:191] op_sel:[0,1,0] op_sel_hi:[1,1,1] neg_lo:[0,1,0] neg_hi:[0,1,0]
    v_pk_mul_f32 v[176:177], v[176:177], v[38:39] op_sel:[0,1] op_sel_hi:[1,1]
    v_mfma_f32_16x16x32_bf16 v[220:223], v[124:127], v[84:87], v[220:223]
    ds_read_b128 v[84:87], v9 offset:18432
    v_pk_mul_f32 v[178:179], v[178:179], v[38:39] op_sel:[0,1] op_sel_hi:[1,1]
    v_mfma_f32_16x16x32_bf16 v[224:227], v[112:115], v[88:91], v[224:227]
    v_pk_mul_f32 v[180:181], v[180:181], v[38:39] op_sel:[0,1] op_sel_hi:[1,1]
    v_pk_mul_f32 v[182:183], v[182:183], v[38:39] op_sel:[0,1] op_sel_hi:[1,1]
    v_mfma_f32_16x16x32_bf16 v[228:231], v[116:119], v[88:91], v[228:231]
    v_pk_mul_f32 v[184:185], v[184:185], v[38:39] op_sel:[0,1] op_sel_hi:[1,1]
    v_pk_mul_f32 v[186:187], v[186:187], v[38:39] op_sel:[0,1] op_sel_hi:[1,1]
    v_mfma_f32_16x16x32_bf16 v[232:235], v[120:123], v[88:91], v[232:235]
    v_pk_mul_f32 v[188:189], v[188:189], v[38:39] op_sel:[0,1] op_sel_hi:[1,1]
    v_pk_mul_f32 v[190:191], v[190:191], v[38:39] op_sel:[0,1] op_sel_hi:[1,1]
    v_mfma_f32_16x16x32_bf16 v[236:239], v[124:127], v[88:91], v[236:239]
    ds_read_b128 v[88:91], v9 offset:24576
    s_add_u32 s38, s42, 8192
    v_cvt_pk_bf16_f32 v176, v176, v177
    v_mfma_f32_16x16x32_bf16 v[240:243], v[112:115], v[92:95], v[240:243]
    ds_read_b64_tr_b16 v[112:113], v24 offset:32768
    ds_read_b64_tr_b16 v[114:115], v24 offset:33792
    v_mfma_f32_16x16x32_bf16 v[244:247], v[116:119], v[92:95], v[244:247]
    ds_read_b64_tr_b16 v[116:117], v25 offset:32768
    ds_read_b64_tr_b16 v[118:119], v25 offset:33792
    v_mfma_f32_16x16x32_bf16 v[248:251], v[120:123], v[92:95], v[248:251]
    ds_read_b64_tr_b16 v[120:121], v26 offset:32768
    ds_read_b64_tr_b16 v[122:123], v26 offset:33792
    v_mfma_f32_16x16x32_bf16 v[252:255], v[124:127], v[92:95], v[252:255]
    ds_read_b64_tr_b16 v[124:125], v27 offset:32768
    ds_read_b64_tr_b16 v[126:127], v27 offset:33792
    v_cvt_pk_bf16_f32 v177, v178, v179
    v_cvt_pk_bf16_f32 v178, v180, v181
    v_cvt_pk_bf16_f32 v179, v182, v183
    v_pk_max_i16 v176, v176, 0
    v_pk_max_i16 v177, v177, 0
    v_pk_max_i16 v178, v178, 0
    v_pk_max_i16 v179, v179, 0
    buffer_store_dwordx4 v[176:179], v20, s[24:27], s38 offen offset:2048 sc1
    s_add_u32 s39, s42, 24576
    v_cvt_pk_bf16_f32 v184, v184, v185
    v_cvt_pk_bf16_f32 v185, v186, v187
    v_cvt_pk_bf16_f32 v186, v188, v189
    v_cvt_pk_bf16_f32 v187, v190, v191
    v_pk_max_i16 v184, v184, 0
    v_pk_max_i16 v185, v185, 0
    v_pk_max_i16 v186, v186, 0
    v_pk_max_i16 v187, v187, 0
    buffer_store_dwordx4 v[184:187], v20, s[24:27], s39 offen offset:2048 sc1
    s_waitcnt lgkmcnt(15)
    v_mfma_f32_16x16x32_bf16 v[192:195], v[96:99], v[64:67], v[192:195]
    ds_read_b128 v[92:95], v9 offset:26624
    ds_read_b128 v[32:35], v18 offset:16
    v_mfma_f32_16x16x32_bf16 v[196:199], v[100:103], v[64:67], v[196:199]
    ds_read_b128 v[36:39], v18 offset:1040
    s_waitcnt lgkmcnt(15)
    v_mfma_f32_16x16x32_bf16 v[200:203], v[104:107], v[64:67], v[200:203]
    v_mfma_f32_16x16x32_bf16 v[204:207], v[108:111], v[64:67], v[204:207]
    v_mfma_f32_16x16x32_bf16 v[208:211], v[96:99], v[68:71], v[208:211]
    v_mfma_f32_16x16x32_bf16 v[212:215], v[100:103], v[68:71], v[212:215]
    v_mfma_f32_16x16x32_bf16 v[216:219], v[104:107], v[68:71], v[216:219]
    v_mfma_f32_16x16x32_bf16 v[220:223], v[108:111], v[68:71], v[220:223]
    s_waitcnt lgkmcnt(2)
    v_xor_b32 v12, s53, v12
    v_xor_b32 v13, s53, v13
    v_xor_b32 v14, s53, v14
    v_xor_b32 v15, s53, v15
    v_xor_b32 v8, s54, v8
    v_xor_b32 v9, s54, v9
    s_barrier
    v_subrev_u32 v8, 65536, v8
    v_subrev_u32 v9, 65536, v9
    ds_read_b128 v[64:67], v8 offset:0
    v_mfma_f32_16x16x32_bf16 v[224:227], v[96:99], v[72:75], v[224:227]
    ds_read_b128 v[68:71], v8 offset:2048
    v_mfma_f32_16x16x32_bf16 v[228:231], v[100:103], v[72:75], v[228:231]
    v_mfma_f32_16x16x32_bf16 v[232:235], v[104:107], v[72:75], v[232:235]
    v_mfma_f32_16x16x32_bf16 v[236:239], v[108:111], v[72:75], v[236:239]
    ds_read_b128 v[72:75], v8 offset:8192
    v_mfma_f32_16x16x32_bf16 v[240:243], v[96:99], v[76:79], v[240:243]
    v_add_u32 v11, 65536, v11
    ds_read_b128 v[96:99], v11 offset:49152
    v_mfma_f32_16x16x32_bf16 v[244:247], v[100:103], v[76:79], v[244:247]
    ds_read_b128 v[100:103], v11 offset:51200
    v_mfma_f32_16x16x32_bf16 v[248:251], v[104:107], v[76:79], v[248:251]
    ds_read_b128 v[104:107], v11 offset:57344
    v_mfma_f32_16x16x32_bf16 v[252:255], v[108:111], v[76:79], v[252:255]
    ds_read_b128 v[108:111], v11 offset:59392
    ds_read_b128 v[76:79], v8 offset:10240
    v_mfma_f32_16x16x32_bf16 v[192:195], v[112:115], v[80:83], v[192:195]
    v_mfma_f32_16x16x32_bf16 v[196:199], v[116:119], v[80:83], v[196:199]
    v_mfma_f32_16x16x32_bf16 v[200:203], v[120:123], v[80:83], v[200:203]
    v_mfma_f32_16x16x32_bf16 v[204:207], v[124:127], v[80:83], v[204:207]
    ds_read_b128 v[80:83], v9 offset:0
    v_mfma_f32_16x16x32_bf16 v[208:211], v[112:115], v[84:87], v[208:211]
    v_mfma_f32_16x16x32_bf16 v[212:215], v[116:119], v[84:87], v[212:215]
    v_mfma_f32_16x16x32_bf16 v[216:219], v[120:123], v[84:87], v[216:219]
    s_waitcnt lgkmcnt(9)
    v_and_b32 v32, 0xffff0000, v32
    v_pk_fma_f32 v[192:193], v[48:49], v[32:33], v[192:193] op_sel_hi:[1,0,1] neg_lo:[0,1,0] neg_hi:[0,1,0]
    v_mfma_f32_16x16x32_bf16 v[220:223], v[124:127], v[84:87], v[220:223]
    ds_read_b128 v[84:87], v9 offset:2048
    v_pk_fma_f32 v[194:195], v[50:51], v[32:33], v[194:195] op_sel_hi:[1,0,1] neg_lo:[0,1,0] neg_hi:[0,1,0]
    v_mfma_f32_16x16x32_bf16 v[224:227], v[112:115], v[88:91], v[224:227]
    v_pk_fma_f32 v[196:197], v[52:53], v[32:33], v[196:197] op_sel_hi:[1,0,1] neg_lo:[0,1,0] neg_hi:[0,1,0]
    v_pk_fma_f32 v[198:199], v[54:55], v[32:33], v[198:199] op_sel_hi:[1,0,1] neg_lo:[0,1,0] neg_hi:[0,1,0]
    v_mfma_f32_16x16x32_bf16 v[228:231], v[116:119], v[88:91], v[228:231]
    v_pk_fma_f32 v[200:201], v[56:57], v[32:33], v[200:201] op_sel_hi:[1,0,1] neg_lo:[0,1,0] neg_hi:[0,1,0]
    v_pk_fma_f32 v[202:203], v[58:59], v[32:33], v[202:203] op_sel_hi:[1,0,1] neg_lo:[0,1,0] neg_hi:[0,1,0]
    v_mfma_f32_16x16x32_bf16 v[232:235], v[120:123], v[88:91], v[232:235]
    v_pk_fma_f32 v[204:205], v[60:61], v[32:33], v[204:205] op_sel_hi:[1,0,1] neg_lo:[0,1,0] neg_hi:[0,1,0]
    v_pk_fma_f32 v[206:207], v[62:63], v[32:33], v[206:207] op_sel_hi:[1,0,1] neg_lo:[0,1,0] neg_hi:[0,1,0]
    v_mfma_f32_16x16x32_bf16 v[236:239], v[124:127], v[88:91], v[236:239]
    ds_read_b128 v[88:91], v9 offset:8192
    v_pk_mul_f32 v[192:193], v[192:193], v[36:37] op_sel_hi:[1,0]
    v_mfma_f32_16x16x32_bf16 v[240:243], v[112:115], v[92:95], v[240:243]
    ds_read_b128 v[112:115], v11 offset:50176
    v_pk_mul_f32 v[194:195], v[194:195], v[36:37] op_sel_hi:[1,0]
    v_mfma_f32_16x16x32_bf16 v[244:247], v[116:119], v[92:95], v[244:247]
    ds_read_b128 v[116:119], v11 offset:52224
    v_pk_mul_f32 v[196:197], v[196:197], v[36:37] op_sel_hi:[1,0]
    v_mfma_f32_16x16x32_bf16 v[248:251], v[120:123], v[92:95], v[248:251]
    ds_read_b128 v[120:123], v11 offset:58368
    v_pk_mul_f32 v[198:199], v[198:199], v[36:37] op_sel_hi:[1,0]
    v_mfma_f32_16x16x32_bf16 v[252:255], v[124:127], v[92:95], v[252:255]
    ds_read_b128 v[124:127], v11 offset:60416
    ds_read_b128 v[92:95], v9 offset:10240
    s_waitcnt lgkmcnt(12)
    v_mfma_f32_16x16x32_bf16 v[128:131], v[96:99], v[64:67], 0
    v_pk_mul_f32 v[200:201], v[200:201], v[36:37] op_sel_hi:[1,0]
    v_pk_mul_f32 v[202:203], v[202:203], v[36:37] op_sel_hi:[1,0]
    s_waitcnt lgkmcnt(11)
    v_mfma_f32_16x16x32_bf16 v[132:135], v[100:103], v[64:67], 0
    v_pk_mul_f32 v[204:205], v[204:205], v[36:37] op_sel_hi:[1,0]
    v_pk_mul_f32 v[206:207], v[206:207], v[36:37] op_sel_hi:[1,0]
    s_waitcnt lgkmcnt(10)
    v_mfma_f32_16x16x32_bf16 v[136:139], v[104:107], v[64:67], 0
    s_add_u32 s38, s42, 917504
    v_cvt_pk_bf16_f32 v192, v192, v193
    v_cvt_pk_bf16_f32 v193, v194, v195
    s_waitcnt lgkmcnt(9)
    v_mfma_f32_16x16x32_bf16 v[140:143], v[108:111], v[64:67], 0
    v_cvt_pk_bf16_f32 v194, v196, v197
    v_cvt_pk_bf16_f32 v195, v198, v199
    v_mfma_f32_16x16x32_bf16 v[144:147], v[96:99], v[68:71], 0
    v_pk_max_i16 v192, v192, 0
    v_pk_max_i16 v193, v193, 0
    v_mfma_f32_16x16x32_bf16 v[148:151], v[100:103], v[68:71], 0
    v_pk_max_i16 v194, v194, 0
    v_pk_max_i16 v195, v195, 0
    v_mfma_f32_16x16x32_bf16 v[152:155], v[104:107], v[68:71], 0
    buffer_store_dwordx4 v[192:195], v20, s[24:27], s38 offen offset:0 sc1
    s_add_u32 s39, s42, 933888
    v_cvt_pk_bf16_f32 v200, v200, v201
    v_mfma_f32_16x16x32_bf16 v[156:159], v[108:111], v[68:71], 0
    s_waitcnt lgkmcnt(0)
    s_waitcnt vmcnt(0)
    s_barrier
    ds_read_b128 v[64:67], v8 offset:32768
    ds_read_b128 v[68:71], v8 offset:34816
    v_mfma_f32_16x16x32_bf16 v[160:163], v[96:99], v[72:75], 0
    v_cvt_pk_bf16_f32 v201, v202, v203
    v_cvt_pk_bf16_f32 v202, v204, v205
    v_mfma_f32_16x16x32_bf16 v[164:167], v[100:103], v[72:75], 0
    v_cvt_pk_bf16_f32 v203, v206, v207
    v_pk_max_i16 v200, v200, 0
    v_mfma_f32_16x16x32_bf16 v[168:171], v[104:107], v[72:75], 0
    v_pk_max_i16 v201, v201, 0
    v_pk_max_i16 v202, v202, 0
    v_mfma_f32_16x16x32_bf16 v[172:175], v[108:111], v[72:75], 0
    ds_read_b128 v[72:75], v8 offset:40960
    v_pk_max_i16 v203, v203, 0
    v_mfma_f32_16x16x32_bf16 v[176:179], v[96:99], v[76:79], 0
    v_add_u32 v11, 16384, v11
    ds_read_b128 v[96:99], v11 offset:49152
    v_mfma_f32_16x16x32_bf16 v[180:183], v[100:103], v[76:79], 0
    ds_read_b128 v[100:103], v11 offset:51200
    buffer_store_dwordx4 v[200:203], v20, s[24:27], s39 offen offset:0 sc1
    v_mfma_f32_16x16x32_bf16 v[184:187], v[104:107], v[76:79], 0
    ds_read_b128 v[104:107], v11 offset:57344
    v_and_b32 v33, 0xffff0000, v33
    v_mfma_f32_16x16x32_bf16 v[188:191], v[108:111], v[76:79], 0
    ds_read_b128 v[108:111], v11 offset:59392
    ds_read_b128 v[76:79], v8 offset:43008
    v_mfma_f32_16x16x32_bf16 v[128:131], v[112:115], v[80:83], v[128:131]
    v_pk_fma_f32 v[208:209], v[48:49], v[32:33], v[208:209] op_sel:[0,1,0] op_sel_hi:[1,1,1] neg_lo:[0,1,0] neg_hi:[0,1,0]
    v_pk_fma_f32 v[210:211], v[50:51], v[32:33], v[210:211] op_sel:[0,1,0] op_sel_hi:[1,1,1] neg_lo:[0,1,0] neg_hi:[0,1,0]
    v_mfma_f32_16x16x32_bf16 v[132:135], v[116:119], v[80:83], v[132:135]
    v_pk_fma_f32 v[212:213], v[52:53], v[32:33], v[212:213] op_sel:[0,1,0] op_sel_hi:[1,1,1] neg_lo:[0,1,0] neg_hi:[0,1,0]
    v_pk_fma_f32 v[214:215], v[54:55], v[32:33], v[214:215] op_sel:[0,1,0] op_sel_hi:[1,1,1] neg_lo:[0,1,0] neg_hi:[0,1,0]
    v_mfma_f32_16x16x32_bf16 v[136:139], v[120:123], v[80:83], v[136:139]
    v_pk_fma_f32 v[216:217], v[56:57], v[32:33], v[216:217] op_sel:[0,1,0] op_sel_hi:[1,1,1] neg_lo:[0,1,0] neg_hi:[0,1,0]
    v_pk_fma_f32 v[218:219], v[58:59], v[32:33], v[218:219] op_sel:[0,1,0] op_sel_hi:[1,1,1] neg_lo:[0,1,0] neg_hi:[0,1,0]
    v_mfma_f32_16x16x32_bf16 v[140:143], v[124:127], v[80:83], v[140:143]
    ds_read_b128 v[80:83], v9 offset:32768
    v_pk_fma_f32 v[220:221], v[60:61], v[32:33], v[220:221] op_sel:[0,1,0] op_sel_hi:[1,1,1] neg_lo:[0,1,0] neg_hi:[0,1,0]
    v_mfma_f32_16x16x32_bf16 v[144:147], v[112:115], v[84:87], v[144:147]
    v_pk_fma_f32 v[222:223], v[62:63], v[32:33], v[222:223] op_sel:[0,1,0] op_sel_hi:[1,1,1] neg_lo:[0,1,0] neg_hi:[0,1,0]
    v_pk_mul_f32 v[208:209], v[208:209], v[36:37] op_sel:[0,1] op_sel_hi:[1,1]
    v_mfma_f32_16x16x32_bf16 v[148:151], v[116:119], v[84:87], v[148:151]
    v_pk_mul_f32 v[210:211], v[210:211], v[36:37] op_sel:[0,1] op_sel_hi:[1,1]
    v_pk_mul_f32 v[212:213], v[212:213], v[36:37] op_sel:[0,1] op_sel_hi:[1,1]
    v_mfma_f32_16x16x32_bf16 v[152:155], v[120:123], v[84:87], v[152:155]
    v_pk_mul_f32 v[214:215], v[214:215], v[36:37] op_sel:[0,1] op_sel_hi:[1,1]
    v_pk_mul_f32 v[216:217], v[216:217], v[36:37] op_sel:[0,1] op_sel_hi:[1,1]
    v_mfma_f32_16x16x32_bf16 v[156:159], v[124:127], v[84:87], v[156:159]
    ds_read_b128 v[84:87], v9 offset:34816
    v_pk_mul_f32 v[218:219], v[218:219], v[36:37] op_sel:[0,1] op_sel_hi:[1,1]
    v_mfma_f32_16x16x32_bf16 v[160:163], v[112:115], v[88:91], v[160:163]
    v_pk_mul_f32 v[220:221], v[220:221], v[36:37] op_sel:[0,1] op_sel_hi:[1,1]
    v_pk_mul_f32 v[222:223], v[222:223], v[36:37] op_sel:[0,1] op_sel_hi:[1,1]
    v_mfma_f32_16x16x32_bf16 v[164:167], v[116:119], v[88:91], v[164:167]
    s_add_u32 s38, s42, 917504
    v_cvt_pk_bf16_f32 v208, v208, v209
    v_cvt_pk_bf16_f32 v209, v210, v211
    v_mfma_f32_16x16x32_bf16 v[168:171], v[120:123], v[88:91], v[168:171]
    v_cvt_pk_bf16_f32 v210, v212, v213
    v_cvt_pk_bf16_f32 v211, v214, v215
    v_mfma_f32_16x16x32_bf16 v[172:175], v[124:127], v[88:91], v[172:175]
    ds_read_b128 v[88:91], v9 offset:40960
    v_pk_max_i16 v208, v208, 0
    v_mfma_f32_16x16x32_bf16 v[176:179], v[112:115], v[92:95], v[176:179]
    ds_read_b128 v[112:115], v11 offset:50176
    v_pk_max_i16 v209, v209, 0
    v_mfma_f32_16x16x32_bf16 v[180:183], v[116:119], v[92:95], v[180:183]
    ds_read_b128 v[116:119], v11 offset:52224
    v_pk_max_i16 v210, v210, 0
    v_mfma_f32_16x16x32_bf16 v[184:187], v[120:123], v[92:95], v[184:187]
    ds_read_b128 v[120:123], v11 offset:58368
    v_pk_max_i16 v211, v211, 0
    v_mfma_f32_16x16x32_bf16 v[188:191], v[124:127], v[92:95], v[188:191]
    ds_read_b128 v[124:127], v11 offset:60416
    ds_read_b128 v[92:95], v9 offset:43008
    s_waitcnt lgkmcnt(12)
    v_mfma_f32_16x16x32_bf16 v[128:131], v[96:99], v[64:67], v[128:131]
    buffer_store_dwordx4 v[208:211], v20, s[24:27], s38 offen offset:2048 sc1
    s_add_u32 s39, s42, 933888
    v_cvt_pk_bf16_f32 v216, v216, v217
    s_waitcnt lgkmcnt(11)
    v_mfma_f32_16x16x32_bf16 v[132:135], v[100:103], v[64:67], v[132:135]
    v_cvt_pk_bf16_f32 v217, v218, v219
    v_cvt_pk_bf16_f32 v218, v220, v221
    s_waitcnt lgkmcnt(10)
    v_mfma_f32_16x16x32_bf16 v[136:139], v[104:107], v[64:67], v[136:139]
    v_cvt_pk_bf16_f32 v219, v222, v223
    v_pk_max_i16 v216, v216, 0
    s_waitcnt lgkmcnt(9)
    v_mfma_f32_16x16x32_bf16 v[140:143], v[108:111], v[64:67], v[140:143]
    v_pk_max_i16 v217, v217, 0
    v_pk_max_i16 v218, v218, 0
    v_mfma_f32_16x16x32_bf16 v[144:147], v[96:99], v[68:71], v[144:147]
    v_pk_max_i16 v219, v219, 0
    buffer_store_dwordx4 v[216:219], v20, s[24:27], s39 offen offset:2048 sc1
    v_mfma_f32_16x16x32_bf16 v[148:151], v[100:103], v[68:71], v[148:151]
    v_and_b32 v34, 0xffff0000, v34
    v_pk_fma_f32 v[224:225], v[48:49], v[34:35], v[224:225] op_sel_hi:[1,0,1] neg_lo:[0,1,0] neg_hi:[0,1,0]
    v_mfma_f32_16x16x32_bf16 v[152:155], v[104:107], v[68:71], v[152:155]
    v_pk_fma_f32 v[226:227], v[50:51], v[34:35], v[226:227] op_sel_hi:[1,0,1] neg_lo:[0,1,0] neg_hi:[0,1,0]
    v_pk_fma_f32 v[228:229], v[52:53], v[34:35], v[228:229] op_sel_hi:[1,0,1] neg_lo:[0,1,0] neg_hi:[0,1,0]
    v_mfma_f32_16x16x32_bf16 v[156:159], v[108:111], v[68:71], v[156:159]
    s_waitcnt lgkmcnt(0)
    s_barrier
    v_add_u32 v10, 65536, v10
    ds_read_b128 v[64:67], v10 offset:0
    v_mfma_f32_16x16x32_bf16 v[160:163], v[96:99], v[72:75], v[160:163]
    ds_read_b128 v[68:71], v10 offset:2048
    v_pk_fma_f32 v[230:231], v[54:55], v[34:35], v[230:231] op_sel_hi:[1,0,1] neg_lo:[0,1,0] neg_hi:[0,1,0]
    v_mfma_f32_16x16x32_bf16 v[164:167], v[100:103], v[72:75], v[164:167]
    v_pk_fma_f32 v[232:233], v[56:57], v[34:35], v[232:233] op_sel_hi:[1,0,1] neg_lo:[0,1,0] neg_hi:[0,1,0]
    v_pk_fma_f32 v[234:235], v[58:59], v[34:35], v[234:235] op_sel_hi:[1,0,1] neg_lo:[0,1,0] neg_hi:[0,1,0]
    v_mfma_f32_16x16x32_bf16 v[168:171], v[104:107], v[72:75], v[168:171]
    v_pk_fma_f32 v[236:237], v[60:61], v[34:35], v[236:237] op_sel_hi:[1,0,1] neg_lo:[0,1,0] neg_hi:[0,1,0]
    v_pk_fma_f32 v[238:239], v[62:63], v[34:35], v[238:239] op_sel_hi:[1,0,1] neg_lo:[0,1,0] neg_hi:[0,1,0]
    v_mfma_f32_16x16x32_bf16 v[172:175], v[108:111], v[72:75], v[172:175]
    ds_read_b128 v[72:75], v10 offset:8192
    v_pk_mul_f32 v[224:225], v[224:225], v[38:39] op_sel_hi:[1,0]
    v_mfma_f32_16x16x32_bf16 v[176:179], v[96:99], v[76:79], v[176:179]
    v_subrev_u32 v12, 65536, v12
    v_subrev_u32 v13, 65536, v13
    v_subrev_u32 v14, 65536, v14
    v_subrev_u32 v15, 65536, v15
    ds_read_b64_tr_b16 v[96:97], v12 offset:16384
    v_mfma_f32_16x16x32_bf16 v[180:183], v[100:103], v[76:79], v[180:183]
    ds_read_b64_tr_b16 v[98:99], v12 offset:17408
    ds_read_b64_tr_b16 v[100:101], v13 offset:16384
    v_mfma_f32_16x16x32_bf16 v[184:187], v[104:107], v[76:79], v[184:187]
    ds_read_b64_tr_b16 v[102:103], v13 offset:17408
    ds_read_b64_tr_b16 v[104:105], v14 offset:16384
    v_mfma_f32_16x16x32_bf16 v[188:191], v[108:111], v[76:79], v[188:191]
    ds_read_b64_tr_b16 v[106:107], v14 offset:17408
    ds_read_b64_tr_b16 v[108:109], v15 offset:16384
    v_mfma_f32_16x16x32_bf16 v[128:131], v[112:115], v[80:83], v[128:131]
    ds_read_b64_tr_b16 v[110:111], v15 offset:17408
    ds_read_b128 v[76:79], v10 offset:10240
    v_mfma_f32_16x16x32_bf16 v[132:135], v[116:119], v[80:83], v[132:135]
    v_pk_mul_f32 v[226:227], v[226:227], v[38:39] op_sel_hi:[1,0]
    v_pk_mul_f32 v[228:229], v[228:229], v[38:39] op_sel_hi:[1,0]
    v_mfma_f32_16x16x32_bf16 v[136:139], v[120:123], v[80:83], v[136:139]
    v_pk_mul_f32 v[230:231], v[230:231], v[38:39] op_sel_hi:[1,0]
    v_pk_mul_f32 v[232:233], v[232:233], v[38:39] op_sel_hi:[1,0]
    v_mfma_f32_16x16x32_bf16 v[140:143], v[124:127], v[80:83], v[140:143]
    ds_read_b128 v[80:83], v10 offset:1024
    v_pk_mul_f32 v[234:235], v[234:235], v[38:39] op_sel_hi:[1,0]
    v_mfma_f32_16x16x32_bf16 v[144:147], v[112:115], v[84:87], v[144:147]
    v_pk_mul_f32 v[236:237], v[236:237], v[38:39] op_sel_hi:[1,0]
    v_pk_mul_f32 v[238:239], v[238:239], v[38:39] op_sel_hi:[1,0]
    v_mfma_f32_16x16x32_bf16 v[148:151], v[116:119], v[84:87], v[148:151]
    s_add_u32 s38, s42, 925696
    v_cvt_pk_bf16_f32 v224, v224, v225
    v_cvt_pk_bf16_f32 v225, v226, v227
    v_mfma_f32_16x16x32_bf16 v[152:155], v[120:123], v[84:87], v[152:155]
    v_cvt_pk_bf16_f32 v226, v228, v229
    v_cvt_pk_bf16_f32 v227, v230, v231
    v_mfma_f32_16x16x32_bf16 v[156:159], v[124:127], v[84:87], v[156:159]
    ds_read_b128 v[84:87], v10 offset:3072
    v_pk_max_i16 v224, v224, 0
    v_mfma_f32_16x16x32_bf16 v[160:163], v[112:115], v[88:91], v[160:163]
    v_pk_max_i16 v225, v225, 0
    v_pk_max_i16 v226, v226, 0
    v_mfma_f32_16x16x32_bf16 v[164:167], v[116:119], v[88:91], v[164:167]
    v_pk_max_i16 v227, v227, 0
    buffer_store_dwordx4 v[224:227], v20, s[24:27], s38 offen offset:0 sc1
    v_mfma_f32_16x16x32_bf16 v[168:171], v[120:123], v[88:91], v[168:171]
    s_add_u32 s39, s42, 942080
    v_cvt_pk_bf16_f32 v232, v232, v233
    v_cvt_pk_bf16_f32 v233, v234, v235
    v_mfma_f32_16x16x32_bf16 v[172:175], v[124:127], v[88:91], v[172:175]
    ds_read_b128 v[88:91], v10 offset:9216
    v_cvt_pk_bf16_f32 v234, v236, v237
    v_mfma_f32_16x16x32_bf16 v[176:179], v[112:115], v[92:95], v[176:179]
    ds_read_b64_tr_b16 v[112:113], v12 offset:24576
    ds_read_b64_tr_b16 v[114:115], v12 offset:25600
    v_mfma_f32_16x16x32_bf16 v[180:183], v[116:119], v[92:95], v[180:183]
    ds_read_b64_tr_b16 v[116:117], v13 offset:24576
    ds_read_b64_tr_b16 v[118:119], v13 offset:25600
    v_mfma_f32_16x16x32_bf16 v[184:187], v[120:123], v[92:95], v[184:187]
    ds_read_b64_tr_b16 v[120:121], v14 offset:24576
    ds_read_b64_tr_b16 v[122:123], v14 offset:25600
    v_mfma_f32_16x16x32_bf16 v[188:191], v[124:127], v[92:95], v[188:191]
    ds_read_b64_tr_b16 v[124:125], v15 offset:24576
    ds_read_b64_tr_b16 v[126:127], v15 offset:25600
    s_waitcnt lgkmcnt(15)
    v_mfma_f32_16x16x32_bf16 v[128:131], v[96:99], v[64:67], v[128:131]
    ds_read_b128 v[92:95], v10 offset:11264
    v_cvt_pk_bf16_f32 v235, v238, v239
    v_mfma_f32_16x16x32_bf16 v[132:135], v[100:103], v[64:67], v[132:135]
    v_pk_max_i16 v232, v232, 0
    v_pk_max_i16 v233, v233, 0
    s_waitcnt lgkmcnt(15)
    v_mfma_f32_16x16x32_bf16 v[136:139], v[104:107], v[64:67], v[136:139]
    v_pk_max_i16 v234, v234, 0
    v_pk_max_i16 v235, v235, 0
    s_waitcnt lgkmcnt(13)
    v_mfma_f32_16x16x32_bf16 v[140:143], v[108:111], v[64:67], v[140:143]
    buffer_store_dwordx4 v[232:235], v20, s[24:27], s39 offen offset:0 sc1
    v_and_b32 v35, 0xffff0000, v35
    v_mfma_f32_16x16x32_bf16 v[144:147], v[96:99], v[68:71], v[144:147]
    v_pk_fma_f32 v[240:241], v[48:49], v[34:35], v[240:241] op_sel:[0,1,0] op_sel_hi:[1,1,1] neg_lo:[0,1,0] neg_hi:[0,1,0]
    v_pk_fma_f32 v[242:243], v[50:51], v[34:35], v[242:243] op_sel:[0,1,0] op_sel_hi:[1,1,1] neg_lo:[0,1,0] neg_hi:[0,1,0]
    v_mfma_f32_16x16x32_bf16 v[148:151], v[100:103], v[68:71], v[148:151]
    v_pk_fma_f32 v[244:245], v[52:53], v[34:35], v[244:245] op_sel:[0,1,0] op_sel_hi:[1,1,1] neg_lo:[0,1,0] neg_hi:[0,1,0]
    v_pk_fma_f32 v[246:247], v[54:55], v[34:35], v[246:247] op_sel:[0,1,0] op_sel_hi:[1,1,1] neg_lo:[0,1,0] neg_hi:[0,1,0]
    v_mfma_f32_16x16x32_bf16 v[152:155], v[104:107], v[68:71], v[152:155]
    v_pk_fma_f32 v[248:249], v[56:57], v[34:35], v[248:249] op_sel:[0,1,0] op_sel_hi:[1,1,1] neg_lo:[0,1,0] neg_hi:[0,1,0]
    v_pk_fma_f32 v[250:251], v[58:59], v[34:35], v[250:251] op_sel:[0,1,0] op_sel_hi:[1,1,1] neg_lo:[0,1,0] neg_hi:[0,1,0]
    v_mfma_f32_16x16x32_bf16 v[156:159], v[108:111], v[68:71], v[156:159]
    s_waitcnt lgkmcnt(0)
    s_barrier
    ds_read_b128 v[64:67], v10 offset:32768
    ds_read_b128 v[68:71], v10 offset:34816
    v_mfma_f32_16x16x32_bf16 v[160:163], v[96:99], v[72:75], v[160:163]
    v_pk_fma_f32 v[252:253], v[60:61], v[34:35], v[252:253] op_sel:[0,1,0] op_sel_hi:[1,1,1] neg_lo:[0,1,0] neg_hi:[0,1,0]
    v_pk_fma_f32 v[254:255], v[62:63], v[34:35], v[254:255] op_sel:[0,1,0] op_sel_hi:[1,1,1] neg_lo:[0,1,0] neg_hi:[0,1,0]
    v_mfma_f32_16x16x32_bf16 v[164:167], v[100:103], v[72:75], v[164:167]
    v_pk_mul_f32 v[240:241], v[240:241], v[38:39] op_sel:[0,1] op_sel_hi:[1,1]
    v_pk_mul_f32 v[242:243], v[242:243], v[38:39] op_sel:[0,1] op_sel_hi:[1,1]
    v_mfma_f32_16x16x32_bf16 v[168:171], v[104:107], v[72:75], v[168:171]
    v_pk_mul_f32 v[244:245], v[244:245], v[38:39] op_sel:[0,1] op_sel_hi:[1,1]
    v_pk_mul_f32 v[246:247], v[246:247], v[38:39] op_sel:[0,1] op_sel_hi:[1,1]
    v_mfma_f32_16x16x32_bf16 v[172:175], v[108:111], v[72:75], v[172:175]
    ds_read_b128 v[72:75], v10 offset:40960
    v_pk_mul_f32 v[248:249], v[248:249], v[38:39] op_sel:[0,1] op_sel_hi:[1,1]
    v_mfma_f32_16x16x32_bf16 v[176:179], v[96:99], v[76:79], v[176:179]
    ds_read_b64_tr_b16 v[96:97], v12 offset:49152
    ds_read_b64_tr_b16 v[98:99], v12 offset:50176
    v_mfma_f32_16x16x32_bf16 v[180:183], v[100:103], v[76:79], v[180:183]
    ds_read_b64_tr_b16 v[100:101], v13 offset:49152
    ds_read_b64_tr_b16 v[102:103], v13 offset:50176
    v_mfma_f32_16x16x32_bf16 v[184:187], v[104:107], v[76:79], v[184:187]
    ds_read_b64_tr_b16 v[104:105], v14 offset:49152
    ds_read_b64_tr_b16 v[106:107], v14 offset:50176
    v_mfma_f32_16x16x32_bf16 v[188:191], v[108:111], v[76:79], v[188:191]
    ds_read_b64_tr_b16 v[108:109], v15 offset:49152
    ds_read_b64_tr_b16 v[110:111], v15 offset:50176
    v_mfma_f32_16x16x32_bf16 v[128:131], v[112:115], v[80:83], v[128:131]
    ds_read_b128 v[76:79], v10 offset:43008
    v_pk_mul_f32 v[250:251], v[250:251], v[38:39] op_sel:[0,1] op_sel_hi:[1,1]
    v_mfma_f32_16x16x32_bf16 v[132:135], v[116:119], v[80:83], v[132:135]
    v_pk_mul_f32 v[252:253], v[252:253], v[38:39] op_sel:[0,1] op_sel_hi:[1,1]
    v_pk_mul_f32 v[254:255], v[254:255], v[38:39] op_sel:[0,1] op_sel_hi:[1,1]
    v_mfma_f32_16x16x32_bf16 v[136:139], v[120:123], v[80:83], v[136:139]
    s_add_u32 s38, s42, 925696
    v_cvt_pk_bf16_f32 v240, v240, v241
    v_cvt_pk_bf16_f32 v241, v242, v243
    v_mfma_f32_16x16x32_bf16 v[140:143], v[124:127], v[80:83], v[140:143]
    ds_read_b128 v[80:83], v10 offset:33792
    v_cvt_pk_bf16_f32 v242, v244, v245
    v_mfma_f32_16x16x32_bf16 v[144:147], v[112:115], v[84:87], v[144:147]
    v_cvt_pk_bf16_f32 v243, v246, v247
    v_pk_max_i16 v240, v240, 0
    v_mfma_f32_16x16x32_bf16 v[148:151], v[116:119], v[84:87], v[148:151]
    v_pk_max_i16 v241, v241, 0
    v_pk_max_i16 v242, v242, 0
    v_mfma_f32_16x16x32_bf16 v[152:155], v[120:123], v[84:87], v[152:155]
    v_pk_max_i16 v243, v243, 0
    buffer_store_dwordx4 v[240:243], v20, s[24:27], s38 offen offset:2048 sc1
    v_mfma_f32_16x16x32_bf16 v[156:159], v[124:127], v[84:87], v[156:159]
    ds_read_b128 v[84:87], v10 offset:35840
    s_add_u32 s39, s42, 942080
    v_cvt_pk_bf16_f32 v248, v248, v249
    v_mfma_f32_16x16x32_bf16 v[160:163], v[112:115], v[88:91], v[160:163]
    v_cvt_pk_bf16_f32 v249, v250, v251
    v_cvt_pk_bf16_f32 v250, v252, v253
    v_mfma_f32_16x16x32_bf16 v[164:167], v[116:119], v[88:91], v[164:167]
    v_cvt_pk_bf16_f32 v251, v254, v255
    v_pk_max_i16 v248, v248, 0
    v_mfma_f32_16x16x32_bf16 v[168:171], v[120:123], v[88:91], v[168:171]
    v_pk_max_i16 v249, v249, 0
    v_pk_max_i16 v250, v250, 0
    v_mfma_f32_16x16x32_bf16 v[172:175], v[124:127], v[88:91], v[172:175]
    ds_read_b128 v[88:91], v10 offset:41984
    v_pk_max_i16 v251, v251, 0
    v_mfma_f32_16x16x32_bf16 v[176:179], v[112:115], v[92:95], v[176:179]
    ds_read_b64_tr_b16 v[112:113], v12 offset:57344
    ds_read_b64_tr_b16 v[114:115], v12 offset:58368
    v_mfma_f32_16x16x32_bf16 v[180:183], v[116:119], v[92:95], v[180:183]
    ds_read_b64_tr_b16 v[116:117], v13 offset:57344
    ds_read_b64_tr_b16 v[118:119], v13 offset:58368
    v_mfma_f32_16x16x32_bf16 v[184:187], v[120:123], v[92:95], v[184:187]
    ds_read_b64_tr_b16 v[120:121], v14 offset:57344
    ds_read_b64_tr_b16 v[122:123], v14 offset:58368
    v_mfma_f32_16x16x32_bf16 v[188:191], v[124:127], v[92:95], v[188:191]
    ds_read_b64_tr_b16 v[124:125], v15 offset:57344
    ds_read_b64_tr_b16 v[126:127], v15 offset:58368
    s_waitcnt lgkmcnt(15)
    v_mfma_f32_16x16x32_bf16 v[128:131], v[96:99], v[64:67], v[128:131]
    ds_read_b128 v[92:95], v10 offset:44032
    buffer_store_dwordx4 v[248:251], v20, s[24:27], s39 offen offset:2048 sc1
    v_mfma_f32_16x16x32_bf16 v[132:135], v[100:103], v[64:67], v[132:135]
    s_waitcnt lgkmcnt(15)
    v_mfma_f32_16x16x32_bf16 v[136:139], v[104:107], v[64:67], v[136:139]
    s_waitcnt lgkmcnt(13)
    v_mfma_f32_16x16x32_bf16 v[140:143], v[108:111], v[64:67], v[140:143]
    v_mfma_f32_16x16x32_bf16 v[144:147], v[96:99], v[68:71], v[144:147]
    v_mfma_f32_16x16x32_bf16 v[148:151], v[100:103], v[68:71], v[148:151]
    v_mfma_f32_16x16x32_bf16 v[152:155], v[104:107], v[68:71], v[152:155]
    v_mfma_f32_16x16x32_bf16 v[156:159], v[108:111], v[68:71], v[156:159]
    s_waitcnt lgkmcnt(0)
    s_barrier
    ds_read_b128 v[64:67], v8 offset:0
    ds_read_b128 v[68:71], v8 offset:2048
    v_mfma_f32_16x16x32_bf16 v[160:163], v[96:99], v[72:75], v[160:163]
    v_mfma_f32_16x16x32_bf16 v[164:167], v[100:103], v[72:75], v[164:167]
    v_mfma_f32_16x16x32_bf16 v[168:171], v[104:107], v[72:75], v[168:171]
    v_mfma_f32_16x16x32_bf16 v[172:175], v[108:111], v[72:75], v[172:175]
    ds_read_b128 v[72:75], v8 offset:8192
    v_mfma_f32_16x16x32_bf16 v[176:179], v[96:99], v[76:79], v[176:179]
    ds_read_b128 v[96:99], v11 offset:32768
    v_mfma_f32_16x16x32_bf16 v[180:183], v[100:103], v[76:79], v[180:183]
    ds_read_b128 v[100:103], v11 offset:34816
    v_mfma_f32_16x16x32_bf16 v[184:187], v[104:107], v[76:79], v[184:187]
    ds_read_b128 v[104:107], v11 offset:40960
    v_mfma_f32_16x16x32_bf16 v[188:191], v[108:111], v[76:79], v[188:191]
    ds_read_b128 v[108:111], v11 offset:43008
    ds_read_b128 v[76:79], v8 offset:10240
    v_mfma_f32_16x16x32_bf16 v[128:131], v[112:115], v[80:83], v[128:131]
    v_mfma_f32_16x16x32_bf16 v[132:135], v[116:119], v[80:83], v[132:135]
    v_mfma_f32_16x16x32_bf16 v[136:139], v[120:123], v[80:83], v[136:139]
    v_mfma_f32_16x16x32_bf16 v[140:143], v[124:127], v[80:83], v[140:143]
    ds_read_b128 v[80:83], v9 offset:0
    v_mfma_f32_16x16x32_bf16 v[144:147], v[112:115], v[84:87], v[144:147]
    v_mfma_f32_16x16x32_bf16 v[148:151], v[116:119], v[84:87], v[148:151]
    v_mfma_f32_16x16x32_bf16 v[152:155], v[120:123], v[84:87], v[152:155]
    v_mfma_f32_16x16x32_bf16 v[156:159], v[124:127], v[84:87], v[156:159]
    ds_read_b128 v[84:87], v9 offset:2048
    v_mfma_f32_16x16x32_bf16 v[160:163], v[112:115], v[88:91], v[160:163]
    v_mfma_f32_16x16x32_bf16 v[164:167], v[116:119], v[88:91], v[164:167]
    v_mfma_f32_16x16x32_bf16 v[168:171], v[120:123], v[88:91], v[168:171]
    v_mfma_f32_16x16x32_bf16 v[172:175], v[124:127], v[88:91], v[172:175]
    ds_read_b128 v[88:91], v9 offset:8192
    v_mfma_f32_16x16x32_bf16 v[176:179], v[112:115], v[92:95], v[176:179]
    s_waitcnt lgkmcnt(10)
    v_xor_b32 v64, v22, v64
    ds_read_b128 v[112:115], v11 offset:33792
    v_mfma_f32_16x16x32_bf16 v[180:183], v[116:119], v[92:95], v[180:183]
    v_xor_b32 v65, v22, v65
    ds_read_b128 v[116:119], v11 offset:35840
    v_mfma_f32_16x16x32_bf16 v[184:187], v[120:123], v[92:95], v[184:187]
    v_xor_b32 v66, v22, v66
    ds_read_b128 v[120:123], v11 offset:41984
    v_mfma_f32_16x16x32_bf16 v[188:191], v[124:127], v[92:95], v[188:191]
    v_xor_b32 v67, v22, v67
    ds_read_b128 v[124:127], v11 offset:44032
    s_waitcnt lgkmcnt(11)
    v_mfma_f32_16x16x32_bf16 v[192:195], v[96:99], v[64:67], 0
    ds_read_b128 v[92:95], v9 offset:10240
    s_waitcnt lgkmcnt(11)
    v_mfma_f32_16x16x32_bf16 v[196:199], v[100:103], v[64:67], 0
    s_waitcnt lgkmcnt(10)
    v_mfma_f32_16x16x32_bf16 v[200:203], v[104:107], v[64:67], 0
    s_waitcnt lgkmcnt(9)
    v_mfma_f32_16x16x32_bf16 v[204:207], v[108:111], v[64:67], 0
    v_mfma_f32_16x16x32_bf16 v[208:211], v[96:99], v[68:71], 0
    v_xor_b32 v72, v23, v72
    v_mfma_f32_16x16x32_bf16 v[212:215], v[100:103], v[68:71], 0
    v_xor_b32 v73, v23, v73
    v_mfma_f32_16x16x32_bf16 v[216:219], v[104:107], v[68:71], 0
    v_xor_b32 v74, v23, v74
    v_mfma_f32_16x16x32_bf16 v[220:223], v[108:111], v[68:71], 0
    v_xor_b32 v75, v23, v75
    s_waitcnt lgkmcnt(0)
    s_barrier
    ds_read_b128 v[64:67], v8 offset:32768
    v_mfma_f32_16x16x32_bf16 v[224:227], v[96:99], v[72:75], 0
    ds_read_b128 v[68:71], v8 offset:34816
    v_mfma_f32_16x16x32_bf16 v[228:231], v[100:103], v[72:75], 0
    v_mfma_f32_16x16x32_bf16 v[232:235], v[104:107], v[72:75], 0
    v_mfma_f32_16x16x32_bf16 v[236:239], v[108:111], v[72:75], 0
    ds_read_b128 v[72:75], v8 offset:40960
    v_mfma_f32_16x16x32_bf16 v[240:243], v[96:99], v[76:79], 0
    v_xor_b32 v80, v22, v80
    ds_read_b128 v[96:99], v11 offset:49152
    v_mfma_f32_16x16x32_bf16 v[244:247], v[100:103], v[76:79], 0
    v_xor_b32 v81, v22, v81
    ds_read_b128 v[100:103], v11 offset:51200
    v_mfma_f32_16x16x32_bf16 v[248:251], v[104:107], v[76:79], 0
    v_xor_b32 v82, v22, v82
    ds_read_b128 v[104:107], v11 offset:57344
    v_mfma_f32_16x16x32_bf16 v[252:255], v[108:111], v[76:79], 0
    v_xor_b32 v83, v22, v83
    ds_read_b128 v[108:111], v11 offset:59392
    s_nop 0
    v_mfma_f32_16x16x32_bf16 v[192:195], v[112:115], v[80:83], v[192:195]
    ds_read_b128 v[76:79], v8 offset:43008
    v_mfma_f32_16x16x32_bf16 v[196:199], v[116:119], v[80:83], v[196:199]
    v_mfma_f32_16x16x32_bf16 v[200:203], v[120:123], v[80:83], v[200:203]
    v_mfma_f32_16x16x32_bf16 v[204:207], v[124:127], v[80:83], v[204:207]
    ds_read_b128 v[80:83], v9 offset:32768
    v_mfma_f32_16x16x32_bf16 v[208:211], v[112:115], v[84:87], v[208:211]
    v_xor_b32 v88, v23, v88
    v_mfma_f32_16x16x32_bf16 v[212:215], v[116:119], v[84:87], v[212:215]
    v_xor_b32 v89, v23, v89
    v_mfma_f32_16x16x32_bf16 v[216:219], v[120:123], v[84:87], v[216:219]
    v_xor_b32 v90, v23, v90
    v_mfma_f32_16x16x32_bf16 v[220:223], v[124:127], v[84:87], v[220:223]
    v_xor_b32 v91, v23, v91
    ds_read_b128 v[84:87], v9 offset:34816
    s_nop 0
    v_mfma_f32_16x16x32_bf16 v[224:227], v[112:115], v[88:91], v[224:227]
    v_mfma_f32_16x16x32_bf16 v[228:231], v[116:119], v[88:91], v[228:231]
    v_mfma_f32_16x16x32_bf16 v[232:235], v[120:123], v[88:91], v[232:235]
    v_mfma_f32_16x16x32_bf16 v[236:239], v[124:127], v[88:91], v[236:239]
    ds_read_b128 v[88:91], v9 offset:40960
    v_mfma_f32_16x16x32_bf16 v[240:243], v[112:115], v[92:95], v[240:243]
    s_waitcnt lgkmcnt(10)
    v_xor_b32 v64, v22, v64
    ds_read_b128 v[112:115], v11 offset:50176
    v_mfma_f32_16x16x32_bf16 v[244:247], v[116:119], v[92:95], v[244:247]
    v_xor_b32 v65, v22, v65
    ds_read_b128 v[116:119], v11 offset:52224
    v_mfma_f32_16x16x32_bf16 v[248:251], v[120:123], v[92:95], v[248:251]
    v_xor_b32 v66, v22, v66
    ds_read_b128 v[120:123], v11 offset:58368
    v_mfma_f32_16x16x32_bf16 v[252:255], v[124:127], v[92:95], v[252:255]
    v_xor_b32 v67, v22, v67
    ds_read_b128 v[124:127], v11 offset:60416
    s_waitcnt lgkmcnt(11)
    v_mfma_f32_16x16x32_bf16 v[192:195], v[96:99], v[64:67], v[192:195]
    ds_read_b128 v[92:95], v9 offset:43008
    s_waitcnt lgkmcnt(11)
    v_mfma_f32_16x16x32_bf16 v[196:199], v[100:103], v[64:67], v[196:199]
    s_waitcnt lgkmcnt(10)
    v_mfma_f32_16x16x32_bf16 v[200:203], v[104:107], v[64:67], v[200:203]
    s_waitcnt lgkmcnt(9)
    v_mfma_f32_16x16x32_bf16 v[204:207], v[108:111], v[64:67], v[204:207]
    v_mfma_f32_16x16x32_bf16 v[208:211], v[96:99], v[68:71], v[208:211]
    v_xor_b32 v72, v23, v72
    v_mfma_f32_16x16x32_bf16 v[212:215], v[100:103], v[68:71], v[212:215]
    v_xor_b32 v73, v23, v73
    v_mfma_f32_16x16x32_bf16 v[216:219], v[104:107], v[68:71], v[216:219]
    v_xor_b32 v74, v23, v74
    v_mfma_f32_16x16x32_bf16 v[220:223], v[108:111], v[68:71], v[220:223]
    v_xor_b32 v75, v23, v75
    s_waitcnt lgkmcnt(0)
    s_waitcnt vmcnt(0)
    s_barrier
    v_add_u32 v8, 65536, v8
    v_add_u32 v9, 65536, v9
    ds_read_b128 v[64:67], v8 offset:0
    v_mfma_f32_16x16x32_bf16 v[224:227], v[96:99], v[72:75], v[224:227]
    ds_read_b128 v[68:71], v8 offset:2048
    v_mfma_f32_16x16x32_bf16 v[228:231], v[100:103], v[72:75], v[228:231]
    v_mfma_f32_16x16x32_bf16 v[232:235], v[104:107], v[72:75], v[232:235]
    v_mfma_f32_16x16x32_bf16 v[236:239], v[108:111], v[72:75], v[236:239]
    ds_read_b128 v[72:75], v8 offset:8192
    v_mfma_f32_16x16x32_bf16 v[240:243], v[96:99], v[76:79], v[240:243]
    v_xor_b32 v80, v22, v80
    ds_read_b128 v[96:99], v11 offset:0
    v_mfma_f32_16x16x32_bf16 v[244:247], v[100:103], v[76:79], v[244:247]
    v_xor_b32 v81, v22, v81
    ds_read_b128 v[100:103], v11 offset:2048
    v_mfma_f32_16x16x32_bf16 v[248:251], v[104:107], v[76:79], v[248:251]
    v_xor_b32 v82, v22, v82
    ds_read_b128 v[104:107], v11 offset:8192
    v_mfma_f32_16x16x32_bf16 v[252:255], v[108:111], v[76:79], v[252:255]
    v_xor_b32 v83, v22, v83
    ds_read_b128 v[108:111], v11 offset:10240
    s_nop 0
    v_mfma_f32_16x16x32_bf16 v[192:195], v[112:115], v[80:83], v[192:195]
    ds_read_b128 v[76:79], v8 offset:10240
    v_mfma_f32_16x16x32_bf16 v[196:199], v[116:119], v[80:83], v[196:199]
    v_mfma_f32_16x16x32_bf16 v[200:203], v[120:123], v[80:83], v[200:203]
    v_mfma_f32_16x16x32_bf16 v[204:207], v[124:127], v[80:83], v[204:207]
    ds_read_b128 v[80:83], v9 offset:0
    v_mfma_f32_16x16x32_bf16 v[208:211], v[112:115], v[84:87], v[208:211]
    v_xor_b32 v88, v23, v88
    v_mfma_f32_16x16x32_bf16 v[212:215], v[116:119], v[84:87], v[212:215]
    v_xor_b32 v89, v23, v89
    v_mfma_f32_16x16x32_bf16 v[216:219], v[120:123], v[84:87], v[216:219]
    v_xor_b32 v90, v23, v90
    v_mfma_f32_16x16x32_bf16 v[220:223], v[124:127], v[84:87], v[220:223]
    v_xor_b32 v91, v23, v91
    ds_read_b128 v[84:87], v9 offset:2048
    s_nop 0
    v_mfma_f32_16x16x32_bf16 v[224:227], v[112:115], v[88:91], v[224:227]
    v_mfma_f32_16x16x32_bf16 v[228:231], v[116:119], v[88:91], v[228:231]
    v_mfma_f32_16x16x32_bf16 v[232:235], v[120:123], v[88:91], v[232:235]
    v_mfma_f32_16x16x32_bf16 v[236:239], v[124:127], v[88:91], v[236:239]
    ds_read_b128 v[88:91], v9 offset:8192
    v_mfma_f32_16x16x32_bf16 v[240:243], v[112:115], v[92:95], v[240:243]
    ds_read_b128 v[112:115], v11 offset:1024
    v_mfma_f32_16x16x32_bf16 v[244:247], v[116:119], v[92:95], v[244:247]
    ds_read_b128 v[116:119], v11 offset:3072
    v_mfma_f32_16x16x32_bf16 v[248:251], v[120:123], v[92:95], v[248:251]
    ds_read_b128 v[120:123], v11 offset:9216
    v_mfma_f32_16x16x32_bf16 v[252:255], v[124:127], v[92:95], v[252:255]
    ds_read_b128 v[124:127], v11 offset:11264
    ds_read_b128 v[92:95], v9 offset:10240
L_c_join:
    s_waitcnt lgkmcnt(12)
    v_mfma_f32_16x16x32_bf16 v[128:131], v[96:99], v[64:67], v[128:131]
    s_waitcnt lgkmcnt(11)
    v_mfma_f32_16x16x32_bf16 v[132:135], v[100:103], v[64:67], v[132:135]
    s_waitcnt lgkmcnt(10)
    v_mfma_f32_16x16x32_bf16 v[136:139], v[104:107], v[64:67], v[136:139]
    s_waitcnt lgkmcnt(9)
    v_mfma_f32_16x16x32_bf16 v[140:143], v[108:111], v[64:67], v[140:143]
    v_mfma_f32_16x16x32_bf16 v[144:147], v[96:99], v[68:71], v[144:147]
    v_mfma_f32_16x16x32_bf16 v[148:151], v[100:103], v[68:71], v[148:151]
    v_mfma_f32_16x16x32_bf16 v[152:155], v[104:107], v[68:71], v[152:155]
    v_mfma_f32_16x16x32_bf16 v[156:159], v[108:111], v[68:71], v[156:159]
    s_waitcnt lgkmcnt(0)
    s_barrier
    v_mfma_f32_16x16x32_bf16 v[160:163], v[96:99], v[72:75], v[160:163]
    v_mfma_f32_16x16x32_bf16 v[164:167], v[100:103], v[72:75], v[164:167]
    v_mfma_f32_16x16x32_bf16 v[168:171], v[104:107], v[72:75], v[168:171]
    v_mfma_f32_16x16x32_bf16 v[172:175], v[108:111], v[72:75], v[172:175]
    v_mfma_f32_16x16x32_bf16 v[176:179], v[96:99], v[76:79], v[176:179]
    v_mfma_f32_16x16x32_bf16 v[180:183], v[100:103], v[76:79], v[180:183]
    v_mfma_f32_16x16x32_bf16 v[184:187], v[104:107], v[76:79], v[184:187]
    v_mfma_f32_16x16x32_bf16 v[188:191], v[108:111], v[76:79], v[188:191]
    v_mfma_f32_16x16x32_bf16 v[128:131], v[112:115], v[80:83], v[128:131]
    v_mfma_f32_16x16x32_bf16 v[132:135], v[116:119], v[80:83], v[132:135]
    v_mfma_f32_16x16x32_bf16 v[136:139], v[120:123], v[80:83], v[136:139]
    v_mfma_f32_16x16x32_bf16 v[140:143], v[124:127], v[80:83], v[140:143]
    v_mfma_f32_16x16x32_bf16 v[144:147], v[112:115], v[84:87], v[144:147]
    v_mfma_f32_16x16x32_bf16 v[148:151], v[116:119], v[84:87], v[148:151]
    v_mfma_f32_16x16x32_bf16 v[152:155], v[120:123], v[84:87], v[152:155]
    v_mfma_f32_16x16x32_bf16 v[156:159], v[124:127], v[84:87], v[156:159]
    v_mfma_f32_16x16x32_bf16 v[160:163], v[112:115], v[88:91], v[160:163]
    v_mfma_f32_16x16x32_bf16 v[164:167], v[116:119], v[88:91], v[164:167]
    v_mfma_f32_16x16x32_bf16 v[168:171], v[120:123], v[88:91], v[168:171]
    v_mfma_f32_16x16x32_bf16 v[172:175], v[124:127], v[88:91], v[172:175]
    v_mfma_f32_16x16x32_bf16 v[176:179], v[112:115], v[92:95], v[176:179]
    v_xor_b32 v64, 0x80008000, v64
    v_mfma_f32_16x16x32_bf16 v[180:183], v[116:119], v[92:95], v[180:183]
    v_xor_b32 v65, 0x80008000, v65
    v_mfma_f32_16x16x32_bf16 v[184:187], v[120:123], v[92:95], v[184:187]
    v_xor_b32 v66, 0x80008000, v66
    v_mfma_f32_16x16x32_bf16 v[188:191], v[124:127], v[92:95], v[188:191]
    v_xor_b32 v67, 0x80008000, v67
    s_nop 1
    v_mfma_f32_16x16x32_bf16 v[192:195], v[96:99], v[64:67], v[192:195]
    v_xor_b32 v68, 0x80008000, v68
    v_mfma_f32_16x16x32_bf16 v[196:199], v[100:103], v[64:67], v[196:199]
    v_xor_b32 v69, 0x80008000, v69
    v_mfma_f32_16x16x32_bf16 v[200:203], v[104:107], v[64:67], v[200:203]
    v_xor_b32 v70, 0x80008000, v70
    v_mfma_f32_16x16x32_bf16 v[204:207], v[108:111], v[64:67], v[204:207]
    v_xor_b32 v71, 0x80008000, v71
    s_nop 1
    v_mfma_f32_16x16x32_bf16 v[208:211], v[96:99], v[68:71], v[208:211]
    v_xor_b32 v72, 0x80008000, v72
    v_mfma_f32_16x16x32_bf16 v[212:215], v[100:103], v[68:71], v[212:215]
    v_xor_b32 v73, 0x80008000, v73
    v_mfma_f32_16x16x32_bf16 v[216:219], v[104:107], v[68:71], v[216:219]
    v_xor_b32 v74, 0x80008000, v74
    v_mfma_f32_16x16x32_bf16 v[220:223], v[108:111], v[68:71], v[220:223]
    v_xor_b32 v75, 0x80008000, v75
    s_barrier
    ds_read_b128 v[64:67], v8 offset:49152
    v_mfma_f32_16x16x32_bf16 v[224:227], v[96:99], v[72:75], v[224:227]
    v_xor_b32 v76, 0x80008000, v76
    ds_read_b128 v[68:71], v8 offset:51200
    v_mfma_f32_16x16x32_bf16 v[228:231], v[100:103], v[72:75], v[228:231]
    v_xor_b32 v77, 0x80008000, v77
    v_mfma_f32_16x16x32_bf16 v[232:235], v[104:107], v[72:75], v[232:235]
    v_xor_b32 v78, 0x80008000, v78
    v_mfma_f32_16x16x32_bf16 v[236:239], v[108:111], v[72:75], v[236:239]
    v_xor_b32 v79, 0x80008000, v79
    ds_read_b128 v[72:75], v8 offset:57344
    s_nop 0
    v_mfma_f32_16x16x32_bf16 v[240:243], v[96:99], v[76:79], v[240:243]
    v_xor_b32 v80, 0x80008000, v80
    ds_read_b128 v[96:99], v11 offset:16384
    v_mfma_f32_16x16x32_bf16 v[244:247], v[100:103], v[76:79], v[244:247]
    v_xor_b32 v81, 0x80008000, v81
    ds_read_b128 v[100:103], v11 offset:18432
    v_mfma_f32_16x16x32_bf16 v[248:251], v[104:107], v[76:79], v[248:251]
    v_xor_b32 v82, 0x80008000, v82
    ds_read_b128 v[104:107], v11 offset:24576
    v_mfma_f32_16x16x32_bf16 v[252:255], v[108:111], v[76:79], v[252:255]
    v_xor_b32 v83, 0x80008000, v83
    ds_read_b128 v[108:111], v11 offset:26624
    s_nop 0
    v_mfma_f32_16x16x32_bf16 v[192:195], v[112:115], v[80:83], v[192:195]
    v_xor_b32 v84, 0x80008000, v84
    ds_read_b128 v[76:79], v8 offset:59392
    v_mfma_f32_16x16x32_bf16 v[196:199], v[116:119], v[80:83], v[196:199]
    v_xor_b32 v85, 0x80008000, v85
    v_mfma_f32_16x16x32_bf16 v[200:203], v[120:123], v[80:83], v[200:203]
    v_xor_b32 v86, 0x80008000, v86
    v_mfma_f32_16x16x32_bf16 v[204:207], v[124:127], v[80:83], v[204:207]
    v_xor_b32 v87, 0x80008000, v87
    ds_read_b128 v[80:83], v9 offset:49152
    s_nop 0
    v_mfma_f32_16x16x32_bf16 v[208:211], v[112:115], v[84:87], v[208:211]
    v_xor_b32 v88, 0x80008000, v88
    v_mfma_f32_16x16x32_bf16 v[212:215], v[116:119], v[84:87], v[212:215]
    v_xor_b32 v89, 0x80008000, v89
    v_mfma_f32_16x16x32_bf16 v[216:219], v[120:123], v[84:87], v[216:219]
    v_xor_b32 v90, 0x80008000, v90
    v_mfma_f32_16x16x32_bf16 v[220:223], v[124:127], v[84:87], v[220:223]
    v_xor_b32 v91, 0x80008000, v91
    ds_read_b128 v[84:87], v9 offset:51200
    s_nop 0
    v_mfma_f32_16x16x32_bf16 v[224:227], v[112:115], v[88:91], v[224:227]
    v_xor_b32 v92, 0x80008000, v92
    v_mfma_f32_16x16x32_bf16 v[228:231], v[116:119], v[88:91], v[228:231]
    v_xor_b32 v93, 0x80008000, v93
    v_mfma_f32_16x16x32_bf16 v[232:235], v[120:123], v[88:91], v[232:235]
    v_xor_b32 v94, 0x80008000, v94
    v_mfma_f32_16x16x32_bf16 v[236:239], v[124:127], v[88:91], v[236:239]
    v_xor_b32 v95, 0x80008000, v95
    ds_read_b128 v[88:91], v9 offset:57344
    s_nop 0
    v_mfma_f32_16x16x32_bf16 v[240:243], v[112:115], v[92:95], v[240:243]
    ds_read_b128 v[112:115], v11 offset:17408
    v_mfma_f32_16x16x32_bf16 v[244:247], v[116:119], v[92:95], v[244:247]
    ds_read_b128 v[116:119], v11 offset:19456
    v_mfma_f32_16x16x32_bf16 v[248:251], v[120:123], v[92:95], v[248:251]
    ds_read_b128 v[120:123], v11 offset:25600
    v_mfma_f32_16x16x32_bf16 v[252:255], v[124:127], v[92:95], v[252:255]
    ds_read_b128 v[124:127], v11 offset:27648
    ds_read_b128 v[92:95], v9 offset:59392
    s_waitcnt lgkmcnt(12)
    v_mfma_f32_16x16x32_bf16 v[128:131], v[96:99], v[64:67], v[128:131]
    s_waitcnt lgkmcnt(11)
    v_mfma_f32_16x16x32_bf16 v[132:135], v[100:103], v[64:67], v[132:135]
    s_waitcnt lgkmcnt(10)
    v_mfma_f32_16x16x32_bf16 v[136:139], v[104:107], v[64:67], v[136:139]
    s_waitcnt lgkmcnt(9)
    v_mfma_f32_16x16x32_bf16 v[140:143], v[108:111], v[64:67], v[140:143]
    v_mfma_f32_16x16x32_bf16 v[144:147], v[96:99], v[68:71], v[144:147]
    v_mfma_f32_16x16x32_bf16 v[148:151], v[100:103], v[68:71], v[148:151]
    v_mfma_f32_16x16x32_bf16 v[152:155], v[104:107], v[68:71], v[152:155]
    v_mfma_f32_16x16x32_bf16 v[156:159], v[108:111], v[68:71], v[156:159]
    s_waitcnt lgkmcnt(0)
    s_barrier
    v_mfma_f32_16x16x32_bf16 v[160:163], v[96:99], v[72:75], v[160:163]
    v_mfma_f32_16x16x32_bf16 v[164:167], v[100:103], v[72:75], v[164:167]
    v_mfma_f32_16x16x32_bf16 v[168:171], v[104:107], v[72:75], v[168:171]
    v_mfma_f32_16x16x32_bf16 v[172:175], v[108:111], v[72:75], v[172:175]
    v_mfma_f32_16x16x32_bf16 v[176:179], v[96:99], v[76:79], v[176:179]
    v_mfma_f32_16x16x32_bf16 v[180:183], v[100:103], v[76:79], v[180:183]
    v_mfma_f32_16x16x32_bf16 v[184:187], v[104:107], v[76:79], v[184:187]
    v_mfma_f32_16x16x32_bf16 v[188:191], v[108:111], v[76:79], v[188:191]
    v_mfma_f32_16x16x32_bf16 v[128:131], v[112:115], v[80:83], v[128:131]
    v_mfma_f32_16x16x32_bf16 v[132:135], v[116:119], v[80:83], v[132:135]
    v_mfma_f32_16x16x32_bf16 v[136:139], v[120:123], v[80:83], v[136:139]
    v_mfma_f32_16x16x32_bf16 v[140:143], v[124:127], v[80:83], v[140:143]
    v_mfma_f32_16x16x32_bf16 v[144:147], v[112:115], v[84:87], v[144:147]
    v_mfma_f32_16x16x32_bf16 v[148:151], v[116:119], v[84:87], v[148:151]
    v_mfma_f32_16x16x32_bf16 v[152:155], v[120:123], v[84:87], v[152:155]
    v_mfma_f32_16x16x32_bf16 v[156:159], v[124:127], v[84:87], v[156:159]
    v_mfma_f32_16x16x32_bf16 v[160:163], v[112:115], v[88:91], v[160:163]
    v_mfma_f32_16x16x32_bf16 v[164:167], v[116:119], v[88:91], v[164:167]
    v_mfma_f32_16x16x32_bf16 v[168:171], v[120:123], v[88:91], v[168:171]
    v_mfma_f32_16x16x32_bf16 v[172:175], v[124:127], v[88:91], v[172:175]
    v_mfma_f32_16x16x32_bf16 v[176:179], v[112:115], v[92:95], v[176:179]
    v_xor_b32 v64, 0x80008000, v64
    v_mfma_f32_16x16x32_bf16 v[180:183], v[116:119], v[92:95], v[180:183]
    v_xor_b32 v65, 0x80008000, v65
    v_mfma_f32_16x16x32_bf16 v[184:187], v[120:123], v[92:95], v[184:187]
    v_xor_b32 v66, 0x80008000, v66
    v_mfma_f32_16x16x32_bf16 v[188:191], v[124:127], v[92:95], v[188:191]
    v_xor_b32 v67, 0x80008000, v67
    s_nop 1
    v_mfma_f32_16x16x32_bf16 v[192:195], v[96:99], v[64:67], v[192:195]
    v_xor_b32 v68, 0x80008000, v68
    v_mfma_f32_16x16x32_bf16 v[196:199], v[100:103], v[64:67], v[196:199]
    v_xor_b32 v69, 0x80008000, v69
    v_mfma_f32_16x16x32_bf16 v[200:203], v[104:107], v[64:67], v[200:203]
    v_xor_b32 v70, 0x80008000, v70
    v_mfma_f32_16x16x32_bf16 v[204:207], v[108:111], v[64:67], v[204:207]
    v_xor_b32 v71, 0x80008000, v71
    s_nop 1
    v_mfma_f32_16x16x32_bf16 v[208:211], v[96:99], v[68:71], v[208:211]
    v_xor_b32 v72, 0x80008000, v72
    v_mfma_f32_16x16x32_bf16 v[212:215], v[100:103], v[68:71], v[212:215]
    v_xor_b32 v73, 0x80008000, v73
    v_mfma_f32_16x16x32_bf16 v[216:219], v[104:107], v[68:71], v[216:219]
    v_xor_b32 v74, 0x80008000, v74
    v_mfma_f32_16x16x32_bf16 v[220:223], v[108:111], v[68:71], v[220:223]
    v_xor_b32 v75, 0x80008000, v75
    s_barrier
    v_subrev_u32 v10, 65536, v10
    ds_read_b128 v[64:67], v10 offset:0
    v_mfma_f32_16x16x32_bf16 v[224:227], v[96:99], v[72:75], v[224:227]
    v_xor_b32 v76, 0x80008000, v76
    ds_read_b128 v[68:71], v10 offset:2048
    v_mfma_f32_16x16x32_bf16 v[228:231], v[100:103], v[72:75], v[228:231]
    v_xor_b32 v77, 0x80008000, v77
    v_mfma_f32_16x16x32_bf16 v[232:235], v[104:107], v[72:75], v[232:235]
    v_xor_b32 v78, 0x80008000, v78
    v_mfma_f32_16x16x32_bf16 v[236:239], v[108:111], v[72:75], v[236:239]
    v_xor_b32 v79, 0x80008000, v79
    ds_read_b128 v[72:75], v10 offset:8192
    s_nop 0
    v_mfma_f32_16x16x32_bf16 v[240:243], v[96:99], v[76:79], v[240:243]
    v_xor_b32 v80, 0x80008000, v80
    ds_read_b64_tr_b16 v[96:97], v12 offset:16384
    v_mfma_f32_16x16x32_bf16 v[244:247], v[100:103], v[76:79], v[244:247]
    v_xor_b32 v81, 0x80008000, v81
    ds_read_b64_tr_b16 v[98:99], v12 offset:17408
    v_mfma_f32_16x16x32_bf16 v[248:251], v[104:107], v[76:79], v[248:251]
    v_xor_b32 v82, 0x80008000, v82
    ds_read_b64_tr_b16 v[100:101], v13 offset:16384
    v_mfma_f32_16x16x32_bf16 v[252:255], v[108:111], v[76:79], v[252:255]
    v_xor_b32 v83, 0x80008000, v83
    ds_read_b64_tr_b16 v[102:103], v13 offset:17408
    s_nop 0
    v_mfma_f32_16x16x32_bf16 v[192:195], v[112:115], v[80:83], v[192:195]
    v_xor_b32 v84, 0x80008000, v84
    ds_read_b64_tr_b16 v[104:105], v14 offset:16384
    v_mfma_f32_16x16x32_bf16 v[196:199], v[116:119], v[80:83], v[196:199]
    v_xor_b32 v85, 0x80008000, v85
    ds_read_b64_tr_b16 v[106:107], v14 offset:17408
    v_mfma_f32_16x16x32_bf16 v[200:203], v[120:123], v[80:83], v[200:203]
    v_xor_b32 v86, 0x80008000, v86
    ds_read_b64_tr_b16 v[108:109], v15 offset:16384
    v_mfma_f32_16x16x32_bf16 v[204:207], v[124:127], v[80:83], v[204:207]
    v_xor_b32 v87, 0x80008000, v87
    ds_read_b64_tr_b16 v[110:111], v15 offset:17408
    s_nop 0
    v_mfma_f32_16x16x32_bf16 v[208:211], v[112:115], v[84:87], v[208:211]
    v_xor_b32 v88, 0x80008000, v88
    ds_read_b128 v[76:79], v10 offset:10240
    v_mfma_f32_16x16x32_bf16 v[212:215], v[116:119], v[84:87], v[212:215]
    v_xor_b32 v89, 0x80008000, v89
    ds_read_b128 v[80:83], v10 offset:1024
    v_mfma_f32_16x16x32_bf16 v[216:219], v[120:123], v[84:87], v[216:219]
    v_xor_b32 v90, 0x80008000, v90
    v_mfma_f32_16x16x32_bf16 v[220:223], v[124:127], v[84:87], v[220:223]
    v_xor_b32 v91, 0x80008000, v91
    ds_read_b128 v[84:87], v10 offset:3072
    s_nop 0
    v_mfma_f32_16x16x32_bf16 v[224:227], v[112:115], v[88:91], v[224:227]
    v_xor_b32 v92, 0x80008000, v92
    v_mfma_f32_16x16x32_bf16 v[228:231], v[116:119], v[88:91], v[228:231]
    v_xor_b32 v93, 0x80008000, v93
    v_mfma_f32_16x16x32_bf16 v[232:235], v[120:123], v[88:91], v[232:235]
    v_xor_b32 v94, 0x80008000, v94
    v_mfma_f32_16x16x32_bf16 v[236:239], v[124:127], v[88:91], v[236:239]
    v_xor_b32 v95, 0x80008000, v95
    ds_read_b128 v[88:91], v10 offset:9216
    s_nop 0
    v_mfma_f32_16x16x32_bf16 v[240:243], v[112:115], v[92:95], v[240:243]
    ds_read_b64_tr_b16 v[112:113], v12 offset:24576
    ds_read_b64_tr_b16 v[114:115], v12 offset:25600
    v_mfma_f32_16x16x32_bf16 v[244:247], v[116:119], v[92:95], v[244:247]
    ds_read_b64_tr_b16 v[116:117], v13 offset:24576
    ds_read_b64_tr_b16 v[118:119], v13 offset:25600
    v_mfma_f32_16x16x32_bf16 v[248:251], v[120:123], v[92:95], v[248:251]
    ds_read_b64_tr_b16 v[120:121], v14 offset:24576
    ds_read_b64_tr_b16 v[122:123], v14 offset:25600
    v_mfma_f32_16x16x32_bf16 v[252:255], v[124:127], v[92:95], v[252:255]
    ds_read_b64_tr_b16 v[124:125], v15 offset:24576
    ds_read_b64_tr_b16 v[126:127], v15 offset:25600
    s_waitcnt lgkmcnt(15)
    v_mfma_f32_16x16x32_bf16 v[192:195], v[96:99], v[64:67], v[192:195]
    ds_read_b128 v[92:95], v10 offset:11264
    v_mfma_f32_16x16x32_bf16 v[196:199], v[100:103], v[64:67], v[196:199]
    s_waitcnt lgkmcnt(15)
    v_mfma_f32_16x16x32_bf16 v[200:203], v[104:107], v[64:67], v[200:203]
    s_waitcnt lgkmcnt(13)
    v_mfma_f32_16x16x32_bf16 v[204:207], v[108:111], v[64:67], v[204:207]
    v_mfma_f32_16x16x32_bf16 v[208:211], v[96:99], v[68:71], v[208:211]
    v_mfma_f32_16x16x32_bf16 v[212:215], v[100:103], v[68:71], v[212:215]
    v_mfma_f32_16x16x32_bf16 v[216:219], v[104:107], v[68:71], v[216:219]
    v_mfma_f32_16x16x32_bf16 v[220:223], v[108:111], v[68:71], v[220:223]
    s_waitcnt lgkmcnt(0)
    s_barrier
    v_add_u32 v10, 81920, v10
    ds_read_b128 v[64:67], v10 offset:49152
    v_mfma_f32_16x16x32_bf16 v[224:227], v[96:99], v[72:75], v[224:227]
    ds_read_b128 v[68:71], v10 offset:51200
    v_mfma_f32_16x16x32_bf16 v[228:231], v[100:103], v[72:75], v[228:231]
    v_mfma_f32_16x16x32_bf16 v[232:235], v[104:107], v[72:75], v[232:235]
    v_mfma_f32_16x16x32_bf16 v[236:239], v[108:111], v[72:75], v[236:239]
    ds_read_b128 v[72:75], v10 offset:57344
    v_mfma_f32_16x16x32_bf16 v[240:243], v[96:99], v[76:79], v[240:243]
    ds_read_b64_tr_b16 v[96:97], v12 offset:49152
    ds_read_b64_tr_b16 v[98:99], v12 offset:50176
    v_mfma_f32_16x16x32_bf16 v[244:247], v[100:103], v[76:79], v[244:247]
    ds_read_b64_tr_b16 v[100:101], v13 offset:49152
    ds_read_b64_tr_b16 v[102:103], v13 offset:50176
    v_mfma_f32_16x16x32_bf16 v[248:251], v[104:107], v[76:79], v[248:251]
    ds_read_b64_tr_b16 v[104:105], v14 offset:49152
    ds_read_b64_tr_b16 v[106:107], v14 offset:50176
    v_mfma_f32_16x16x32_bf16 v[252:255], v[108:111], v[76:79], v[252:255]
    ds_read_b64_tr_b16 v[108:109], v15 offset:49152
    ds_read_b64_tr_b16 v[110:111], v15 offset:50176
    v_mfma_f32_16x16x32_bf16 v[192:195], v[112:115], v[80:83], v[192:195]
    ds_read_b128 v[76:79], v10 offset:59392
    v_mfma_f32_16x16x32_bf16 v[196:199], v[116:119], v[80:83], v[196:199]
    v_mfma_f32_16x16x32_bf16 v[200:203], v[120:123], v[80:83], v[200:203]
    v_mfma_f32_16x16x32_bf16 v[204:207], v[124:127], v[80:83], v[204:207]
    ds_read_b128 v[80:83], v10 offset:50176
    v_mfma_f32_16x16x32_bf16 v[208:211], v[112:115], v[84:87], v[208:211]
    v_mfma_f32_16x16x32_bf16 v[212:215], v[116:119], v[84:87], v[212:215]
    v_mfma_f32_16x16x32_bf16 v[216:219], v[120:123], v[84:87], v[216:219]
    v_mfma_f32_16x16x32_bf16 v[220:223], v[124:127], v[84:87], v[220:223]
    ds_read_b128 v[84:87], v10 offset:52224
    v_mfma_f32_16x16x32_bf16 v[224:227], v[112:115], v[88:91], v[224:227]
    v_mfma_f32_16x16x32_bf16 v[228:231], v[116:119], v[88:91], v[228:231]
    v_mfma_f32_16x16x32_bf16 v[232:235], v[120:123], v[88:91], v[232:235]
    v_mfma_f32_16x16x32_bf16 v[236:239], v[124:127], v[88:91], v[236:239]
    ds_read_b128 v[88:91], v10 offset:58368
    v_mfma_f32_16x16x32_bf16 v[240:243], v[112:115], v[92:95], v[240:243]
    ds_read_b64_tr_b16 v[112:113], v12 offset:57344
    ds_read_b64_tr_b16 v[114:115], v12 offset:58368
    v_mfma_f32_16x16x32_bf16 v[244:247], v[116:119], v[92:95], v[244:247]
    ds_read_b64_tr_b16 v[116:117], v13 offset:57344
    ds_read_b64_tr_b16 v[118:119], v13 offset:58368
    v_mfma_f32_16x16x32_bf16 v[248:251], v[120:123], v[92:95], v[248:251]
    ds_read_b64_tr_b16 v[120:121], v14 offset:57344
    ds_read_b64_tr_b16 v[122:123], v14 offset:58368
    v_mfma_f32_16x16x32_bf16 v[252:255], v[124:127], v[92:95], v[252:255]
    ds_read_b64_tr_b16 v[124:125], v15 offset:57344
    ds_read_b64_tr_b16 v[126:127], v15 offset:58368
    s_waitcnt lgkmcnt(15)
    v_mfma_f32_16x16x32_bf16 v[192:195], v[96:99], v[64:67], v[192:195]
    ds_read_b128 v[92:95], v10 offset:60416
    v_mfma_f32_16x16x32_bf16 v[196:199], v[100:103], v[64:67], v[196:199]
    s_waitcnt lgkmcnt(15)
    v_mfma_f32_16x16x32_bf16 v[200:203], v[104:107], v[64:67], v[200:203]
    s_waitcnt lgkmcnt(13)
    v_mfma_f32_16x16x32_bf16 v[204:207], v[108:111], v[64:67], v[204:207]
    v_mfma_f32_16x16x32_bf16 v[208:211], v[96:99], v[68:71], v[208:211]
    v_mfma_f32_16x16x32_bf16 v[212:215], v[100:103], v[68:71], v[212:215]
    v_mfma_f32_16x16x32_bf16 v[216:219], v[104:107], v[68:71], v[216:219]
    v_mfma_f32_16x16x32_bf16 v[220:223], v[108:111], v[68:71], v[220:223]
    s_waitcnt lgkmcnt(0)
    s_barrier
    ds_read_b128 v[64:67], v10 offset:0
    ds_read_b128 v[68:71], v10 offset:2048
    v_mfma_f32_16x16x32_bf16 v[224:227], v[96:99], v[72:75], v[224:227]
    v_mfma_f32_16x16x32_bf16 v[228:231], v[100:103], v[72:75], v[228:231]
    v_mfma_f32_16x16x32_bf16 v[232:235], v[104:107], v[72:75], v[232:235]
    v_mfma_f32_16x16x32_bf16 v[236:239], v[108:111], v[72:75], v[236:239]
    ds_read_b128 v[72:75], v10 offset:8192
    v_mfma_f32_16x16x32_bf16 v[240:243], v[96:99], v[76:79], v[240:243]
    ds_read_b64_tr_b16 v[96:97], v12 offset:32768
    ds_read_b64_tr_b16 v[98:99], v12 offset:33792
    v_mfma_f32_16x16x32_bf16 v[244:247], v[100:103], v[76:79], v[244:247]
    ds_read_b64_tr_b16 v[100:101], v13 offset:32768
    ds_read_b64_tr_b16 v[102:103], v13 offset:33792
    v_mfma_f32_16x16x32_bf16 v[248:251], v[104:107], v[76:79], v[248:251]
    ds_read_b64_tr_b16 v[104:105], v14 offset:32768
    ds_read_b64_tr_b16 v[106:107], v14 offset:33792
    v_mfma_f32_16x16x32_bf16 v[252:255], v[108:111], v[76:79], v[252:255]
    ds_read_b64_tr_b16 v[108:109], v15 offset:32768
    ds_read_b64_tr_b16 v[110:111], v15 offset:33792
    v_mfma_f32_16x16x32_bf16 v[192:195], v[112:115], v[80:83], v[192:195]
    ds_read_b128 v[76:79], v10 offset:10240
    v_mfma_f32_16x16x32_bf16 v[196:199], v[116:119], v[80:83], v[196:199]
    v_mfma_f32_16x16x32_bf16 v[200:203], v[120:123], v[80:83], v[200:203]
    v_mfma_f32_16x16x32_bf16 v[204:207], v[124:127], v[80:83], v[204:207]
    ds_read_b128 v[80:83], v10 offset:1024
    v_mfma_f32_16x16x32_bf16 v[208:211], v[112:115], v[84:87], v[208:211]
    v_mfma_f32_16x16x32_bf16 v[212:215], v[116:119], v[84:87], v[212:215]
    v_mfma_f32_16x16x32_bf16 v[216:219], v[120:123], v[84:87], v[216:219]
    v_mfma_f32_16x16x32_bf16 v[220:223], v[124:127], v[84:87], v[220:223]
    ds_read_b128 v[84:87], v10 offset:3072
    v_mfma_f32_16x16x32_bf16 v[224:227], v[112:115], v[88:91], v[224:227]
    v_mfma_f32_16x16x32_bf16 v[228:231], v[116:119], v[88:91], v[228:231]
    v_mfma_f32_16x16x32_bf16 v[232:235], v[120:123], v[88:91], v[232:235]
    v_mfma_f32_16x16x32_bf16 v[236:239], v[124:127], v[88:91], v[236:239]
    ds_read_b128 v[88:91], v10 offset:9216
    v_mfma_f32_16x16x32_bf16 v[240:243], v[112:115], v[92:95], v[240:243]
    ds_read_b64_tr_b16 v[112:113], v12 offset:40960
    ds_read_b64_tr_b16 v[114:115], v12 offset:41984
    v_mfma_f32_16x16x32_bf16 v[244:247], v[116:119], v[92:95], v[244:247]
    ds_read_b64_tr_b16 v[116:117], v13 offset:40960
    ds_read_b64_tr_b16 v[118:119], v13 offset:41984
    v_mfma_f32_16x16x32_bf16 v[248:251], v[120:123], v[92:95], v[248:251]
    ds_read_b64_tr_b16 v[120:121], v14 offset:40960
    ds_read_b64_tr_b16 v[122:123], v14 offset:41984
    v_mfma_f32_16x16x32_bf16 v[252:255], v[124:127], v[92:95], v[252:255]
    ds_read_b64_tr_b16 v[124:125], v15 offset:40960
    ds_read_b64_tr_b16 v[126:127], v15 offset:41984
    s_waitcnt lgkmcnt(15)
    v_mfma_f32_16x16x32_bf16 v[128:131], v[96:99], v[64:67], v[128:131]
    ds_read_b128 v[92:95], v10 offset:11264
    v_mfma_f32_16x16x32_bf16 v[132:135], v[100:103], v[64:67], v[132:135]
    s_waitcnt lgkmcnt(15)
    v_mfma_f32_16x16x32_bf16 v[136:139], v[104:107], v[64:67], v[136:139]
    s_waitcnt lgkmcnt(13)
    v_mfma_f32_16x16x32_bf16 v[140:143], v[108:111], v[64:67], v[140:143]
    v_mfma_f32_16x16x32_bf16 v[144:147], v[96:99], v[68:71], v[144:147]
    v_mfma_f32_16x16x32_bf16 v[148:151], v[100:103], v[68:71], v[148:151]
    v_mfma_f32_16x16x32_bf16 v[152:155], v[104:107], v[68:71], v[152:155]
    v_mfma_f32_16x16x32_bf16 v[156:159], v[108:111], v[68:71], v[156:159]
    s_waitcnt lgkmcnt(0)
    s_barrier
    v_subrev_u32 v10, 16384, v10
    ds_read_b128 v[64:67], v10 offset:0
    v_mfma_f32_16x16x32_bf16 v[160:163], v[96:99], v[72:75], v[160:163]
    ds_read_b128 v[68:71], v10 offset:2048
    v_mfma_f32_16x16x32_bf16 v[164:167], v[100:103], v[72:75], v[164:167]
    v_mfma_f32_16x16x32_bf16 v[168:171], v[104:107], v[72:75], v[168:171]
    v_mfma_f32_16x16x32_bf16 v[172:175], v[108:111], v[72:75], v[172:175]
    ds_read_b128 v[72:75], v10 offset:8192
    v_mfma_f32_16x16x32_bf16 v[176:179], v[96:99], v[76:79], v[176:179]
    v_mfma_f32_16x16x32_bf16 v[180:183], v[100:103], v[76:79], v[180:183]
    v_mfma_f32_16x16x32_bf16 v[184:187], v[104:107], v[76:79], v[184:187]
    v_mfma_f32_16x16x32_bf16 v[188:191], v[108:111], v[76:79], v[188:191]
    ds_read_b128 v[76:79], v10 offset:10240
    v_mfma_f32_16x16x32_bf16 v[128:131], v[112:115], v[80:83], v[128:131]
    v_mfma_f32_16x16x32_bf16 v[132:135], v[116:119], v[80:83], v[132:135]
    v_mfma_f32_16x16x32_bf16 v[136:139], v[120:123], v[80:83], v[136:139]
    v_mfma_f32_16x16x32_bf16 v[140:143], v[124:127], v[80:83], v[140:143]
    ds_read_b128 v[80:83], v10 offset:1024
    v_mfma_f32_16x16x32_bf16 v[144:147], v[112:115], v[84:87], v[144:147]
    v_mfma_f32_16x16x32_bf16 v[148:151], v[116:119], v[84:87], v[148:151]
    v_mfma_f32_16x16x32_bf16 v[152:155], v[120:123], v[84:87], v[152:155]
    v_mfma_f32_16x16x32_bf16 v[156:159], v[124:127], v[84:87], v[156:159]
    ds_read_b128 v[84:87], v10 offset:3072
    v_mfma_f32_16x16x32_bf16 v[160:163], v[112:115], v[88:91], v[160:163]
    v_mfma_f32_16x16x32_bf16 v[164:167], v[116:119], v[88:91], v[164:167]
    v_mfma_f32_16x16x32_bf16 v[168:171], v[120:123], v[88:91], v[168:171]
    v_mfma_f32_16x16x32_bf16 v[172:175], v[124:127], v[88:91], v[172:175]
    ds_read_b128 v[88:91], v10 offset:9216
    v_mfma_f32_16x16x32_bf16 v[176:179], v[112:115], v[92:95], v[176:179]
    v_mfma_f32_16x16x32_bf16 v[180:183], v[116:119], v[92:95], v[180:183]
    v_mfma_f32_16x16x32_bf16 v[184:187], v[120:123], v[92:95], v[184:187]
    v_mfma_f32_16x16x32_bf16 v[188:191], v[124:127], v[92:95], v[188:191]
    ds_read_b128 v[92:95], v10 offset:11264
    s_waitcnt lgkmcnt(7)
    v_mfma_f32_16x16x32_bf16 v[192:195], v[96:99], v[64:67], v[192:195]
    v_mfma_f32_16x16x32_bf16 v[196:199], v[100:103], v[64:67], v[196:199]
    v_mfma_f32_16x16x32_bf16 v[200:203], v[104:107], v[64:67], v[200:203]
    s_xor_b32 s84, s2, 1
    s_mul_i32 s50, s84, 49152
    v_mfma_f32_16x16x32_bf16 v[204:207], v[108:111], v[64:67], v[204:207]
    s_xor_b32 s84, s2, 2
    s_mul_i32 s51, s84, 49152
    s_waitcnt lgkmcnt(6)
    v_mfma_f32_16x16x32_bf16 v[208:211], v[96:99], v[68:71], v[208:211]
    s_xor_b32 s84, s2, 3
    s_mul_i32 s52, s84, 49152
    v_mfma_f32_16x16x32_bf16 v[212:215], v[100:103], v[68:71], v[212:215]
    s_lshl_b32 s84, s32, 12
    s_add_u32 s84, s84, 25165824
    v_mfma_f32_16x16x32_bf16 v[216:219], v[104:107], v[68:71], v[216:219]
    s_add_u32 s50, s50, s84
    s_add_u32 s50, s50, 0
    v_mfma_f32_16x16x32_bf16 v[220:223], v[108:111], v[68:71], v[220:223]
    s_waitcnt lgkmcnt(0)
    s_barrier
    ds_read_b128 v[64:67], v10 offset:49152
    ds_read_b128 v[68:71], v10 offset:51200
    v_mfma_f32_16x16x32_bf16 v[224:227], v[96:99], v[72:75], v[224:227]
    s_add_u32 s51, s51, s84
    s_add_u32 s51, s51, 16384
    v_mfma_f32_16x16x32_bf16 v[228:231], v[100:103], v[72:75], v[228:231]
    s_add_u32 s52, s52, s84
    s_add_u32 s52, s52, 32768
    v_mfma_f32_16x16x32_bf16 v[232:235], v[104:107], v[72:75], v[232:235]
    s_mul_i32 s44, s2, 49152
    s_add_u32 s44, s44, s84
    v_mfma_f32_16x16x32_bf16 v[236:239], v[108:111], v[72:75], v[236:239]
    ds_read_b128 v[72:75], v10 offset:57344
    v_and_b32 v2, 15, v1
    v_mfma_f32_16x16x32_bf16 v[240:243], v[96:99], v[76:79], v[240:243]
    v_add_u32 v12, 65536, v12
    v_add_u32 v13, 65536, v13
    v_add_u32 v14, 65536, v14
    v_add_u32 v15, 65536, v15
    ds_read_b64_tr_b16 v[96:97], v12 offset:32768
    v_mfma_f32_16x16x32_bf16 v[244:247], v[100:103], v[76:79], v[244:247]
    ds_read_b64_tr_b16 v[98:99], v12 offset:33792
    ds_read_b64_tr_b16 v[100:101], v13 offset:32768
    v_mfma_f32_16x16x32_bf16 v[248:251], v[104:107], v[76:79], v[248:251]
    ds_read_b64_tr_b16 v[102:103], v13 offset:33792
    ds_read_b64_tr_b16 v[104:105], v14 offset:32768
    v_mfma_f32_16x16x32_bf16 v[252:255], v[108:111], v[76:79], v[252:255]
    ds_read_b64_tr_b16 v[106:107], v14 offset:33792
    ds_read_b64_tr_b16 v[108:109], v15 offset:32768
    v_mfma_f32_16x16x32_bf16 v[192:195], v[112:115], v[80:83], v[192:195]
    ds_read_b64_tr_b16 v[110:111], v15 offset:33792
    ds_read_b128 v[76:79], v10 offset:59392
    v_mfma_f32_16x16x32_bf16 v[196:199], v[116:119], v[80:83], v[196:199]
    s_lshl_b32 s84, s40, 5
    v_add_u32 v2, s84, v2
    s_lshr_b32 s84, s33, 1
    v_mfma_f32_16x16x32_bf16 v[200:203], v[120:123], v[80:83], v[200:203]
    s_lshl_b32 s84, s84, 6
    v_xor_b32 v2, s84, v2
    s_lshl_b32 s84, s35, 8
    v_mfma_f32_16x16x32_bf16 v[204:207], v[124:127], v[80:83], v[204:207]
    ds_read_b128 v[80:83], v10 offset:50176
    s_add_u32 s84, s84, s34
    v_lshl_add_u32 v2, v2, 1, s84
    v_mfma_f32_16x16x32_bf16 v[208:211], v[112:115], v[84:87], v[208:211]
    v_sub_u32 v3, 2048, v2
    v_mov_b32 v4, 1024
    v_mfma_f32_16x16x32_bf16 v[212:215], v[116:119], v[84:87], v[212:215]
    v_cmp_eq_u32 vcc, 0, v2
    s_nop 1
    v_cndmask_b32 v4, v3, v4, vcc
    v_mfma_f32_16x16x32_bf16 v[216:219], v[120:123], v[84:87], v[216:219]
    v_lshlrev_b32 v24, 11, v2
    v_lshlrev_b32 v26, 11, v4
    v_mfma_f32_16x16x32_bf16 v[220:223], v[124:127], v[84:87], v[220:223]
    ds_read_b128 v[84:87], v10 offset:52224
    v_add_u32 v25, 65536, v24
    v_mfma_f32_16x16x32_bf16 v[224:227], v[112:115], v[88:91], v[224:227]
    v_lshlrev_b32 v27, 11, v3
    v_subrev_u32 v27, 65536, v27
    v_mfma_f32_16x16x32_bf16 v[228:231], v[116:119], v[88:91], v[228:231]
    v_and_b32 v2, 3, v1
    v_xor_b32 v2, s37, v2
    v_mfma_f32_16x16x32_bf16 v[232:235], v[120:123], v[88:91], v[232:235]
    v_lshlrev_b32 v16, 7, v2
    s_lshl_b32 s54, s36, 2
    s_add_u32 s54, s54, 21037120
    v_mfma_f32_16x16x32_bf16 v[236:239], v[124:127], v[88:91], v[236:239]
    ds_read_b128 v[88:91], v10 offset:58368
    s_lshr_b32 s46, s36, 2
    s_lshl_b32 s46, s46, 31
    v_mfma_f32_16x16x32_bf16 v[240:243], v[112:115], v[92:95], v[240:243]
    ds_read_b64_tr_b16 v[112:113], v12 offset:40960
    ds_read_b64_tr_b16 v[114:115], v12 offset:41984
    v_mfma_f32_16x16x32_bf16 v[244:247], v[116:119], v[92:95], v[244:247]
    ds_read_b64_tr_b16 v[116:117], v13 offset:40960
    ds_read_b64_tr_b16 v[118:119], v13 offset:41984
    v_mfma_f32_16x16x32_bf16 v[248:251], v[120:123], v[92:95], v[248:251]
    ds_read_b64_tr_b16 v[120:121], v14 offset:40960
    ds_read_b64_tr_b16 v[122:123], v14 offset:41984
    v_mfma_f32_16x16x32_bf16 v[252:255], v[124:127], v[92:95], v[252:255]
    ds_read_b64_tr_b16 v[124:125], v15 offset:40960
    ds_read_b64_tr_b16 v[126:127], v15 offset:41984
    s_waitcnt lgkmcnt(15)
    v_mfma_f32_16x16x32_bf16 v[128:131], v[96:99], v[64:67], v[128:131]
    ds_read_b128 v[92:95], v10 offset:60416
    v_mfma_f32_16x16x32_bf16 v[132:135], v[100:103], v[64:67], v[132:135]
    s_waitcnt lgkmcnt(15)
    v_mfma_f32_16x16x32_bf16 v[136:139], v[104:107], v[64:67], v[136:139]
    s_waitcnt lgkmcnt(13)
    v_mfma_f32_16x16x32_bf16 v[140:143], v[108:111], v[64:67], v[140:143]
    v_mfma_f32_16x16x32_bf16 v[144:147], v[96:99], v[68:71], v[144:147]
    v_mfma_f32_16x16x32_bf16 v[148:151], v[100:103], v[68:71], v[148:151]
    v_mfma_f32_16x16x32_bf16 v[152:155], v[104:107], v[68:71], v[152:155]
    v_mfma_f32_16x16x32_bf16 v[156:159], v[108:111], v[68:71], v[156:159]
    s_waitcnt lgkmcnt(0)
    s_barrier
    v_subrev_u32 v10, 65536, v10
    ds_read_b128 v[64:67], v10 offset:16384
    v_mfma_f32_16x16x32_bf16 v[160:163], v[96:99], v[72:75], v[160:163]
    ds_read_b128 v[68:71], v10 offset:18432
    v_mfma_f32_16x16x32_bf16 v[164:167], v[100:103], v[72:75], v[164:167]
    v_mfma_f32_16x16x32_bf16 v[168:171], v[104:107], v[72:75], v[168:171]
    v_mfma_f32_16x16x32_bf16 v[172:175], v[108:111], v[72:75], v[172:175]
    ds_read_b128 v[72:75], v10 offset:24576
    v_mfma_f32_16x16x32_bf16 v[176:179], v[96:99], v[76:79], v[176:179]
    v_mfma_f32_16x16x32_bf16 v[180:183], v[100:103], v[76:79], v[180:183]
    v_mfma_f32_16x16x32_bf16 v[184:187], v[104:107], v[76:79], v[184:187]
    v_mfma_f32_16x16x32_bf16 v[188:191], v[108:111], v[76:79], v[188:191]
    ds_read_b128 v[76:79], v10 offset:26624
    v_mfma_f32_16x16x32_bf16 v[128:131], v[112:115], v[80:83], v[128:131]
    v_mfma_f32_16x16x32_bf16 v[132:135], v[116:119], v[80:83], v[132:135]
    v_mfma_f32_16x16x32_bf16 v[136:139], v[120:123], v[80:83], v[136:139]
    v_mfma_f32_16x16x32_bf16 v[140:143], v[124:127], v[80:83], v[140:143]
    ds_read_b128 v[80:83], v10 offset:17408
    v_mfma_f32_16x16x32_bf16 v[144:147], v[112:115], v[84:87], v[144:147]
    v_mfma_f32_16x16x32_bf16 v[148:151], v[116:119], v[84:87], v[148:151]
    v_mfma_f32_16x16x32_bf16 v[152:155], v[120:123], v[84:87], v[152:155]
    v_mfma_f32_16x16x32_bf16 v[156:159], v[124:127], v[84:87], v[156:159]
    ds_read_b128 v[84:87], v10 offset:19456
    v_mfma_f32_16x16x32_bf16 v[160:163], v[112:115], v[88:91], v[160:163]
    v_mfma_f32_16x16x32_bf16 v[164:167], v[116:119], v[88:91], v[164:167]
    v_mfma_f32_16x16x32_bf16 v[168:171], v[120:123], v[88:91], v[168:171]
    v_mfma_f32_16x16x32_bf16 v[172:175], v[124:127], v[88:91], v[172:175]
    ds_read_b128 v[88:91], v10 offset:25600
    v_mfma_f32_16x16x32_bf16 v[176:179], v[112:115], v[92:95], v[176:179]
    v_mfma_f32_16x16x32_bf16 v[180:183], v[116:119], v[92:95], v[180:183]
    v_mfma_f32_16x16x32_bf16 v[184:187], v[120:123], v[92:95], v[184:187]
    v_mfma_f32_16x16x32_bf16 v[188:191], v[124:127], v[92:95], v[188:191]
    ds_read_b128 v[92:95], v10 offset:27648
    s_waitcnt lgkmcnt(7)
    v_mfma_f32_16x16x32_bf16 v[192:195], v[96:99], v[64:67], v[192:195]
    v_mfma_f32_16x16x32_bf16 v[196:199], v[100:103], v[64:67], v[196:199]
    v_mfma_f32_16x16x32_bf16 v[200:203], v[104:107], v[64:67], v[200:203]
    s_mov_b32 s85, 304128
    v_lshrrev_b32 v3, 4, v1
    v_min_u32 v2, 1, v3
    v_mfma_f32_16x16x32_bf16 v[204:207], v[108:111], v[64:67], v[204:207]
    v_lshlrev_b32 v2, 30, v2
    v_lshl_add_u32 v4, v24, 1, v2
    s_waitcnt lgkmcnt(6)
    v_mfma_f32_16x16x32_bf16 v[208:211], v[96:99], v[68:71], v[208:211]
    buffer_load_ushort v32, v4, s[76:79], 0 offen offset:1024
    buffer_load_ushort v36, v4, s[80:83], 0 offen offset:1024
    v_mfma_f32_16x16x32_bf16 v[212:215], v[100:103], v[68:71], v[212:215]
    v_lshl_add_u32 v4, v25, 1, v2
    buffer_load_ushort v34, v4, s[76:79], 0 offen offset:1024
    v_mfma_f32_16x16x32_bf16 v[216:219], v[104:107], v[68:71], v[216:219]
    buffer_load_ushort v38, v4, s[80:83], 0 offen offset:1024
    s_lshl_b32 s38, s36, 7
    s_lshl_b32 s39, s3, 6
    v_mfma_f32_16x16x32_bf16 v[220:223], v[108:111], v[68:71], v[220:223]
    s_waitcnt lgkmcnt(0)
    s_barrier
    ds_read_b128 v[64:67], v10 offset:49152
    ds_read_b128 v[68:71], v10 offset:51200
    v_mfma_f32_16x16x32_bf16 v[224:227], v[96:99], v[72:75], v[224:227]
    s_add_u32 s38, s38, s39
    s_lshl_b32 s39, s41, 5
    v_mfma_f32_16x16x32_bf16 v[228:231], v[100:103], v[72:75], v[228:231]
    s_add_u32 s38, s38, s39
    s_mov_b32 s47, 16809984
    v_mfma_f32_16x16x32_bf16 v[232:235], v[104:107], v[72:75], v[232:235]
    s_mov_b32 s48, 19482624
    v_and_b32 v4, 15, v1
    v_add_u32 v4, s38, v4
    v_mfma_f32_16x16x32_bf16 v[236:239], v[108:111], v[72:75], v[236:239]
    ds_read_b128 v[72:75], v10 offset:57344
    v_sub_u32 v5, 1024, v4
    v_mfma_f32_16x16x32_bf16 v[240:243], v[96:99], v[76:79], v[240:243]
    v_subrev_u32 v12, 65536, v12
    v_subrev_u32 v13, 65536, v13
    v_subrev_u32 v14, 65536, v14
    v_subrev_u32 v15, 65536, v15
    ds_read_b64_tr_b16 v[96:97], v12 offset:0
    v_mfma_f32_16x16x32_bf16 v[244:247], v[100:103], v[76:79], v[244:247]
    ds_read_b64_tr_b16 v[98:99], v12 offset:1024
    ds_read_b64_tr_b16 v[100:101], v13 offset:0
    v_mfma_f32_16x16x32_bf16 v[248:251], v[104:107], v[76:79], v[248:251]
    ds_read_b64_tr_b16 v[102:103], v13 offset:1024
    ds_read_b64_tr_b16 v[104:105], v14 offset:0
    v_mfma_f32_16x16x32_bf16 v[252:255], v[108:111], v[76:79], v[252:255]
    ds_read_b64_tr_b16 v[106:107], v14 offset:1024
    ds_read_b64_tr_b16 v[108:109], v15 offset:0
    v_mfma_f32_16x16x32_bf16 v[192:195], v[112:115], v[80:83], v[192:195]
    ds_read_b64_tr_b16 v[110:111], v15 offset:1024
    ds_read_b128 v[76:79], v10 offset:59392
    v_mfma_f32_16x16x32_bf16 v[196:199], v[116:119], v[80:83], v[196:199]
    v_min_u32 v4, v4, v5
    v_lshrrev_b32 v5, 6, v4
    v_mfma_f32_16x16x32_bf16 v[200:203], v[120:123], v[80:83], v[200:203]
    v_mul_u32_u24 v5, 33792, v5
    v_and_b32 v6, 1, v4
    v_mfma_f32_16x16x32_bf16 v[204:207], v[124:127], v[80:83], v[204:207]
    ds_read_b128 v[80:83], v10 offset:50176
    v_mad_u32_u24 v5, v6, s85, v5
    v_mfma_f32_16x16x32_bf16 v[208:211], v[112:115], v[84:87], v[208:211]
    v_bfe_u32 v4, v4, 1, 5
    v_lshl_add_u32 v4, v4, 4, v5
    v_mfma_f32_16x16x32_bf16 v[212:215], v[116:119], v[84:87], v[212:215]
    buffer_load_ushort v48, v4, s[24:27], s47 offen sc1
    buffer_load_ushort v52, v4, s[24:27], s48 offen sc1
    v_mfma_f32_16x16x32_bf16 v[216:219], v[120:123], v[84:87], v[216:219]
    v_and_b32 v4, 15, v1
    v_add_u32 v4, s38, v4
    v_mfma_f32_16x16x32_bf16 v[220:223], v[124:127], v[84:87], v[220:223]
    ds_read_b128 v[84:87], v10 offset:52224
    v_add_u32 v4, 16, v4
    v_mfma_f32_16x16x32_bf16 v[224:227], v[112:115], v[88:91], v[224:227]
    v_sub_u32 v5, 1024, v4
    v_min_u32 v4, v4, v5
    v_mfma_f32_16x16x32_bf16 v[228:231], v[116:119], v[88:91], v[228:231]
    v_lshrrev_b32 v5, 6, v4
    v_mul_u32_u24 v5, 33792, v5
    v_mfma_f32_16x16x32_bf16 v[232:235], v[120:123], v[88:91], v[232:235]
    v_and_b32 v6, 1, v4
    v_mad_u32_u24 v5, v6, s85, v5
    v_mfma_f32_16x16x32_bf16 v[236:239], v[124:127], v[88:91], v[236:239]
    ds_read_b128 v[88:91], v10 offset:58368
    v_bfe_u32 v4, v4, 1, 5
    v_mfma_f32_16x16x32_bf16 v[240:243], v[112:115], v[92:95], v[240:243]
    ds_read_b64_tr_b16 v[112:113], v12 offset:8192
    ds_read_b64_tr_b16 v[114:115], v12 offset:9216
    v_mfma_f32_16x16x32_bf16 v[244:247], v[116:119], v[92:95], v[244:247]
    ds_read_b64_tr_b16 v[116:117], v13 offset:8192
    ds_read_b64_tr_b16 v[118:119], v13 offset:9216
    v_mfma_f32_16x16x32_bf16 v[248:251], v[120:123], v[92:95], v[248:251]
    ds_read_b64_tr_b16 v[120:121], v14 offset:8192
    ds_read_b64_tr_b16 v[122:123], v14 offset:9216
    v_mfma_f32_16x16x32_bf16 v[252:255], v[124:127], v[92:95], v[252:255]
    ds_read_b64_tr_b16 v[124:125], v15 offset:8192
    ds_read_b64_tr_b16 v[126:127], v15 offset:9216
    s_waitcnt lgkmcnt(15)
    v_mfma_f32_16x16x32_bf16 v[128:131], v[96:99], v[64:67], v[128:131]
    ds_read_b128 v[92:95], v10 offset:60416
    v_lshl_add_u32 v4, v4, 4, v5
    v_mfma_f32_16x16x32_bf16 v[132:135], v[100:103], v[64:67], v[132:135]
    buffer_load_ushort v50, v4, s[24:27], s47 offen sc1
    buffer_load_ushort v54, v4, s[24:27], s48 offen sc1
    s_waitcnt lgkmcnt(15)
    v_mfma_f32_16x16x32_bf16 v[136:139], v[104:107], v[64:67], v[136:139]
    v_mov_b32 v33, 0
    v_mov_b32 v49, 0
    s_waitcnt lgkmcnt(13)
    v_mfma_f32_16x16x32_bf16 v[140:143], v[108:111], v[64:67], v[140:143]
    v_mov_b32 v35, 0
    v_mov_b32 v51, 0
    v_mfma_f32_16x16x32_bf16 v[144:147], v[96:99], v[68:71], v[144:147]
    v_mov_b32 v37, 0
    v_mov_b32 v39, 0
    v_mfma_f32_16x16x32_bf16 v[148:151], v[100:103], v[68:71], v[148:151]
    v_and_b32 v2, 1, v3
    v_lshlrev_b32 v2, 5, v2
    v_mfma_f32_16x16x32_bf16 v[152:155], v[104:107], v[68:71], v[152:155]
    v_lshrrev_b32 v3, 1, v3
    v_lshl_add_u32 v2, v3, 4, v2
    v_mfma_f32_16x16x32_bf16 v[156:159], v[108:111], v[68:71], v[156:159]
    s_waitcnt lgkmcnt(0)
    s_barrier
    v_add_u32 v10, 81920, v10
    ds_read_b128 v[64:67], v10 offset:49152
    v_mfma_f32_16x16x32_bf16 v[160:163], v[96:99], v[72:75], v[160:163]
    ds_read_b128 v[68:71], v10 offset:51200
    s_lshl_b32 s38, s38, 1
    v_add_u32 v2, s38, v2
    v_mfma_f32_16x16x32_bf16 v[164:167], v[100:103], v[72:75], v[164:167]
    v_add_u32 v24, v2, v24
    v_add_u32 v25, v2, v25
    v_mfma_f32_16x16x32_bf16 v[168:171], v[104:107], v[72:75], v[168:171]
    v_add_u32 v26, v2, v26
    v_add_u32 v27, v2, v27
    v_mfma_f32_16x16x32_bf16 v[172:175], v[108:111], v[72:75], v[172:175]
    ds_read_b128 v[72:75], v10 offset:57344
    s_add_u32 s55, s44, 0
    s_add_u32 s56, s44, 16384
    v_mfma_f32_16x16x32_bf16 v[176:179], v[96:99], v[76:79], v[176:179]
    s_add_u32 s57, s44, 32768
    buffer_load_dwordx4 v[56:59], v24, s[16:19], 0 offen
    buffer_load_dwordx4 v[60:63], v25, s[16:19], 0 offen
    v_mfma_f32_16x16x32_bf16 v[180:183], v[100:103], v[76:79], v[180:183]
    buffer_load_dwordx4 v[28:31], v26, s[16:19], 0 offen
    buffer_load_dwordx4 v[44:47], v27, s[16:19], 0 offen
    v_mfma_f32_16x16x32_bf16 v[184:187], v[104:107], v[76:79], v[184:187]
    s_mov_b32 s47, 0x00003f80
    s_mov_b32 s48, 0x3f800000
    v_mfma_f32_16x16x32_bf16 v[188:191], v[108:111], v[76:79], v[188:191]
    ds_read_b128 v[76:79], v10 offset:59392
    v_mfma_f32_16x16x32_bf16 v[128:131], v[112:115], v[80:83], v[128:131]
    v_mfma_f32_16x16x32_bf16 v[132:135], v[116:119], v[80:83], v[132:135]
    v_mfma_f32_16x16x32_bf16 v[136:139], v[120:123], v[80:83], v[136:139]
    v_mfma_f32_16x16x32_bf16 v[140:143], v[124:127], v[80:83], v[140:143]
    ds_read_b128 v[80:83], v10 offset:50176
    v_mfma_f32_16x16x32_bf16 v[144:147], v[112:115], v[84:87], v[144:147]
    v_mfma_f32_16x16x32_bf16 v[148:151], v[116:119], v[84:87], v[148:151]
    v_mfma_f32_16x16x32_bf16 v[152:155], v[120:123], v[84:87], v[152:155]
    v_mfma_f32_16x16x32_bf16 v[156:159], v[124:127], v[84:87], v[156:159]
    ds_read_b128 v[84:87], v10 offset:52224
    v_mfma_f32_16x16x32_bf16 v[160:163], v[112:115], v[88:91], v[160:163]
    v_mfma_f32_16x16x32_bf16 v[164:167], v[116:119], v[88:91], v[164:167]
    v_mfma_f32_16x16x32_bf16 v[168:171], v[120:123], v[88:91], v[168:171]
    v_mfma_f32_16x16x32_bf16 v[172:175], v[124:127], v[88:91], v[172:175]
    ds_read_b128 v[88:91], v10 offset:58368
    v_mfma_f32_16x16x32_bf16 v[176:179], v[112:115], v[92:95], v[176:179]
    v_mfma_f32_16x16x32_bf16 v[180:183], v[116:119], v[92:95], v[180:183]
    v_mfma_f32_16x16x32_bf16 v[184:187], v[120:123], v[92:95], v[184:187]
    v_mfma_f32_16x16x32_bf16 v[188:191], v[124:127], v[92:95], v[188:191]
    ds_read_b128 v[92:95], v10 offset:60416
    s_waitcnt lgkmcnt(7)
    v_mfma_f32_16x16x32_bf16 v[192:195], v[96:99], v[64:67], v[192:195]
    v_mfma_f32_16x16x32_bf16 v[196:199], v[100:103], v[64:67], v[196:199]
    v_mfma_f32_16x16x32_bf16 v[200:203], v[104:107], v[64:67], v[200:203]
    v_mfma_f32_16x16x32_bf16 v[204:207], v[108:111], v[64:67], v[204:207]
    s_waitcnt lgkmcnt(6)
    v_mfma_f32_16x16x32_bf16 v[208:211], v[96:99], v[68:71], v[208:211]
    v_mfma_f32_16x16x32_bf16 v[212:215], v[100:103], v[68:71], v[212:215]
    v_mfma_f32_16x16x32_bf16 v[216:219], v[104:107], v[68:71], v[216:219]
    v_mfma_f32_16x16x32_bf16 v[220:223], v[108:111], v[68:71], v[220:223]
    s_waitcnt lgkmcnt(0)
    s_barrier
    ds_read_b128 v[64:67], v10 offset:0
    ds_read_b128 v[68:71], v10 offset:2048
    v_mfma_f32_16x16x32_bf16 v[224:227], v[96:99], v[72:75], v[224:227]
    v_mfma_f32_16x16x32_bf16 v[228:231], v[100:103], v[72:75], v[228:231]
    v_mfma_f32_16x16x32_bf16 v[232:235], v[104:107], v[72:75], v[232:235]
    v_mfma_f32_16x16x32_bf16 v[236:239], v[108:111], v[72:75], v[236:239]
    ds_read_b128 v[72:75], v10 offset:8192
    v_mfma_f32_16x16x32_bf16 v[240:243], v[96:99], v[76:79], v[240:243]
    ds_read_b64_tr_b16 v[96:97], v12 offset:32768
    ds_read_b64_tr_b16 v[98:99], v12 offset:33792
    v_mfma_f32_16x16x32_bf16 v[244:247], v[100:103], v[76:79], v[244:247]
    ds_read_b64_tr_b16 v[100:101], v13 offset:32768
    ds_read_b64_tr_b16 v[102:103], v13 offset:33792
    v_mfma_f32_16x16x32_bf16 v[248:251], v[104:107], v[76:79], v[248:251]
    ds_read_b64_tr_b16 v[104:105], v14 offset:32768
    ds_read_b64_tr_b16 v[106:107], v14 offset:33792
    v_mfma_f32_16x16x32_bf16 v[252:255], v[108:111], v[76:79], v[252:255]
    ds_read_b64_tr_b16 v[108:109], v15 offset:32768
    ds_read_b64_tr_b16 v[110:111], v15 offset:33792
    v_mfma_f32_16x16x32_bf16 v[192:195], v[112:115], v[80:83], v[192:195]
    ds_read_b128 v[76:79], v10 offset:10240
    v_mfma_f32_16x16x32_bf16 v[196:199], v[116:119], v[80:83], v[196:199]
    v_mfma_f32_16x16x32_bf16 v[200:203], v[120:123], v[80:83], v[200:203]
    v_mfma_f32_16x16x32_bf16 v[204:207], v[124:127], v[80:83], v[204:207]
    ds_read_b128 v[80:83], v10 offset:1024
    v_mfma_f32_16x16x32_bf16 v[208:211], v[112:115], v[84:87], v[208:211]
    v_mfma_f32_16x16x32_bf16 v[212:215], v[116:119], v[84:87], v[212:215]
    v_mfma_f32_16x16x32_bf16 v[216:219], v[120:123], v[84:87], v[216:219]
    v_mfma_f32_16x16x32_bf16 v[220:223], v[124:127], v[84:87], v[220:223]
    ds_read_b128 v[84:87], v10 offset:3072
    v_mfma_f32_16x16x32_bf16 v[224:227], v[112:115], v[88:91], v[224:227]
    v_mfma_f32_16x16x32_bf16 v[228:231], v[116:119], v[88:91], v[228:231]
    v_mfma_f32_16x16x32_bf16 v[232:235], v[120:123], v[88:91], v[232:235]
    v_mfma_f32_16x16x32_bf16 v[236:239], v[124:127], v[88:91], v[236:239]
    ds_read_b128 v[88:91], v10 offset:9216
    v_mfma_f32_16x16x32_bf16 v[240:243], v[112:115], v[92:95], v[240:243]
    ds_read_b64_tr_b16 v[112:113], v12 offset:40960
    ds_read_b64_tr_b16 v[114:115], v12 offset:41984
    v_mfma_f32_16x16x32_bf16 v[244:247], v[116:119], v[92:95], v[244:247]
    ds_read_b64_tr_b16 v[116:117], v13 offset:40960
    ds_read_b64_tr_b16 v[118:119], v13 offset:41984
    v_mfma_f32_16x16x32_bf16 v[248:251], v[120:123], v[92:95], v[248:251]
    ds_read_b64_tr_b16 v[120:121], v14 offset:40960
    ds_read_b64_tr_b16 v[122:123], v14 offset:41984
    v_mfma_f32_16x16x32_bf16 v[252:255], v[124:127], v[92:95], v[252:255]
    ds_read_b64_tr_b16 v[124:125], v15 offset:40960
    ds_read_b64_tr_b16 v[126:127], v15 offset:41984
    s_waitcnt lgkmcnt(15)
    v_mfma_f32_16x16x32_bf16 v[128:131], v[96:99], v[64:67], v[128:131]
    ds_read_b128 v[92:95], v10 offset:11264
    v_mfma_f32_16x16x32_bf16 v[132:135], v[100:103], v[64:67], v[132:135]
    s_waitcnt lgkmcnt(15)
    v_mfma_f32_16x16x32_bf16 v[136:139], v[104:107], v[64:67], v[136:139]
    s_waitcnt lgkmcnt(13)
    v_mfma_f32_16x16x32_bf16 v[140:143], v[108:111], v[64:67], v[140:143]
    v_mfma_f32_16x16x32_bf16 v[144:147], v[96:99], v[68:71], v[144:147]
    v_mfma_f32_16x16x32_bf16 v[148:151], v[100:103], v[68:71], v[148:151]
    v_mfma_f32_16x16x32_bf16 v[152:155], v[104:107], v[68:71], v[152:155]
    v_mfma_f32_16x16x32_bf16 v[156:159], v[108:111], v[68:71], v[156:159]
    s_waitcnt lgkmcnt(0)
    s_barrier
    v_subrev_u32 v10, 16384, v10
    ds_read_b128 v[64:67], v10 offset:0
    v_mfma_f32_16x16x32_bf16 v[160:163], v[96:99], v[72:75], v[160:163]
    ds_read_b128 v[68:71], v10 offset:2048
    v_mfma_f32_16x16x32_bf16 v[164:167], v[100:103], v[72:75], v[164:167]
    v_mfma_f32_16x16x32_bf16 v[168:171], v[104:107], v[72:75], v[168:171]
    v_mfma_f32_16x16x32_bf16 v[172:175], v[108:111], v[72:75], v[172:175]
    ds_read_b128 v[72:75], v10 offset:8192
    v_mfma_f32_16x16x32_bf16 v[176:179], v[96:99], v[76:79], v[176:179]
    v_mfma_f32_16x16x32_bf16 v[180:183], v[100:103], v[76:79], v[180:183]
    v_mfma_f32_16x16x32_bf16 v[184:187], v[104:107], v[76:79], v[184:187]
    v_mfma_f32_16x16x32_bf16 v[188:191], v[108:111], v[76:79], v[188:191]
    ds_read_b128 v[76:79], v10 offset:10240
    v_mfma_f32_16x16x32_bf16 v[128:131], v[112:115], v[80:83], v[128:131]
    v_mfma_f32_16x16x32_bf16 v[132:135], v[116:119], v[80:83], v[132:135]
    v_mfma_f32_16x16x32_bf16 v[136:139], v[120:123], v[80:83], v[136:139]
    v_mfma_f32_16x16x32_bf16 v[140:143], v[124:127], v[80:83], v[140:143]
    ds_read_b128 v[80:83], v10 offset:1024
    v_mfma_f32_16x16x32_bf16 v[144:147], v[112:115], v[84:87], v[144:147]
    v_mfma_f32_16x16x32_bf16 v[148:151], v[116:119], v[84:87], v[148:151]
    v_mfma_f32_16x16x32_bf16 v[152:155], v[120:123], v[84:87], v[152:155]
    v_mfma_f32_16x16x32_bf16 v[156:159], v[124:127], v[84:87], v[156:159]
    ds_read_b128 v[84:87], v10 offset:3072
    v_mfma_f32_16x16x32_bf16 v[160:163], v[112:115], v[88:91], v[160:163]
    v_mfma_f32_16x16x32_bf16 v[164:167], v[116:119], v[88:91], v[164:167]
    v_mfma_f32_16x16x32_bf16 v[168:171], v[120:123], v[88:91], v[168:171]
    v_mfma_f32_16x16x32_bf16 v[172:175], v[124:127], v[88:91], v[172:175]
    ds_read_b128 v[88:91], v10 offset:9216
    v_mfma_f32_16x16x32_bf16 v[176:179], v[112:115], v[92:95], v[176:179]
    v_mfma_f32_16x16x32_bf16 v[180:183], v[116:119], v[92:95], v[180:183]
    v_mfma_f32_16x16x32_bf16 v[184:187], v[120:123], v[92:95], v[184:187]
    v_mfma_f32_16x16x32_bf16 v[188:191], v[124:127], v[92:95], v[188:191]
    ds_read_b128 v[92:95], v10 offset:11264
    s_waitcnt lgkmcnt(7)
    v_mfma_f32_16x16x32_bf16 v[192:195], v[96:99], v[64:67], v[192:195]
    v_mfma_f32_16x16x32_bf16 v[196:199], v[100:103], v[64:67], v[196:199]
    v_mfma_f32_16x16x32_bf16 v[200:203], v[104:107], v[64:67], v[200:203]
    v_mfma_f32_16x16x32_bf16 v[204:207], v[108:111], v[64:67], v[204:207]
    s_waitcnt lgkmcnt(6)
    v_mfma_f32_16x16x32_bf16 v[208:211], v[96:99], v[68:71], v[208:211]
    v_mfma_f32_16x16x32_bf16 v[212:215], v[100:103], v[68:71], v[212:215]
    v_mfma_f32_16x16x32_bf16 v[216:219], v[104:107], v[68:71], v[216:219]
    v_mfma_f32_16x16x32_bf16 v[220:223], v[108:111], v[68:71], v[220:223]
    s_waitcnt lgkmcnt(0)
    s_barrier
    ds_read_b128 v[64:67], v10 offset:49152
    ds_read_b128 v[68:71], v10 offset:51200
    v_mfma_f32_16x16x32_bf16 v[224:227], v[96:99], v[72:75], v[224:227]
    v_mfma_f32_16x16x32_bf16 v[228:231], v[100:103], v[72:75], v[228:231]
    v_mfma_f32_16x16x32_bf16 v[232:235], v[104:107], v[72:75], v[232:235]
    v_mfma_f32_16x16x32_bf16 v[236:239], v[108:111], v[72:75], v[236:239]
    ds_read_b128 v[72:75], v10 offset:57344
    v_mfma_f32_16x16x32_bf16 v[240:243], v[96:99], v[76:79], v[240:243]
    v_add_u32 v12, 65536, v12
    v_add_u32 v13, 65536, v13
    v_add_u32 v14, 65536, v14
    v_add_u32 v15, 65536, v15
    ds_read_b64_tr_b16 v[96:97], v12 offset:32768
    v_mfma_f32_16x16x32_bf16 v[244:247], v[100:103], v[76:79], v[244:247]
    ds_read_b64_tr_b16 v[98:99], v12 offset:33792
    ds_read_b64_tr_b16 v[100:101], v13 offset:32768
    v_mfma_f32_16x16x32_bf16 v[248:251], v[104:107], v[76:79], v[248:251]
    ds_read_b64_tr_b16 v[102:103], v13 offset:33792
    ds_read_b64_tr_b16 v[104:105], v14 offset:32768
    v_mfma_f32_16x16x32_bf16 v[252:255], v[108:111], v[76:79], v[252:255]
    ds_read_b64_tr_b16 v[106:107], v14 offset:33792
    ds_read_b64_tr_b16 v[108:109], v15 offset:32768
    v_mfma_f32_16x16x32_bf16 v[192:195], v[112:115], v[80:83], v[192:195]
    ds_read_b64_tr_b16 v[110:111], v15 offset:33792
    ds_read_b128 v[76:79], v10 offset:59392
    v_mfma_f32_16x16x32_bf16 v[196:199], v[116:119], v[80:83], v[196:199]
    v_mfma_f32_16x16x32_bf16 v[200:203], v[120:123], v[80:83], v[200:203]
    v_mfma_f32_16x16x32_bf16 v[204:207], v[124:127], v[80:83], v[204:207]
    ds_read_b128 v[80:83], v10 offset:50176
    v_mfma_f32_16x16x32_bf16 v[208:211], v[112:115], v[84:87], v[208:211]
    v_mfma_f32_16x16x32_bf16 v[212:215], v[116:119], v[84:87], v[212:215]
    v_mfma_f32_16x16x32_bf16 v[216:219], v[120:123], v[84:87], v[216:219]
    v_mfma_f32_16x16x32_bf16 v[220:223], v[124:127], v[84:87], v[220:223]
    ds_read_b128 v[84:87], v10 offset:52224
    v_mfma_f32_16x16x32_bf16 v[224:227], v[112:115], v[88:91], v[224:227]
    v_mfma_f32_16x16x32_bf16 v[228:231], v[116:119], v[88:91], v[228:231]
    v_mfma_f32_16x16x32_bf16 v[232:235], v[120:123], v[88:91], v[232:235]
    v_mfma_f32_16x16x32_bf16 v[236:239], v[124:127], v[88:91], v[236:239]
    ds_read_b128 v[88:91], v10 offset:58368
    v_mfma_f32_16x16x32_bf16 v[240:243], v[112:115], v[92:95], v[240:243]
    ds_read_b64_tr_b16 v[112:113], v12 offset:40960
    ds_read_b64_tr_b16 v[114:115], v12 offset:41984
    v_mfma_f32_16x16x32_bf16 v[244:247], v[116:119], v[92:95], v[244:247]
    ds_read_b64_tr_b16 v[116:117], v13 offset:40960
    ds_read_b64_tr_b16 v[118:119], v13 offset:41984
    v_mfma_f32_16x16x32_bf16 v[248:251], v[120:123], v[92:95], v[248:251]
    ds_read_b64_tr_b16 v[120:121], v14 offset:40960
    ds_read_b64_tr_b16 v[122:123], v14 offset:41984
    v_mfma_f32_16x16x32_bf16 v[252:255], v[124:127], v[92:95], v[252:255]
    ds_read_b64_tr_b16 v[124:125], v15 offset:40960
    ds_read_b64_tr_b16 v[126:127], v15 offset:41984
    s_waitcnt lgkmcnt(15)
    v_mfma_f32_16x16x32_bf16 v[128:131], v[96:99], v[64:67], v[128:131]
    ds_read_b128 v[92:95], v10 offset:60416
    v_mfma_f32_16x16x32_bf16 v[132:135], v[100:103], v[64:67], v[132:135]
    s_waitcnt lgkmcnt(15)
    v_mfma_f32_16x16x32_bf16 v[136:139], v[104:107], v[64:67], v[136:139]
    s_waitcnt lgkmcnt(13)
    v_mfma_f32_16x16x32_bf16 v[140:143], v[108:111], v[64:67], v[140:143]
    v_mfma_f32_16x16x32_bf16 v[144:147], v[96:99], v[68:71], v[144:147]
    v_mfma_f32_16x16x32_bf16 v[148:151], v[100:103], v[68:71], v[148:151]
    v_mfma_f32_16x16x32_bf16 v[152:155], v[104:107], v[68:71], v[152:155]
    v_mfma_f32_16x16x32_bf16 v[156:159], v[108:111], v[68:71], v[156:159]
    s_waitcnt lgkmcnt(0)
    s_barrier
    v_subrev_u32 v10, 65536, v10
    ds_read_b128 v[64:67], v10 offset:16384
    v_mfma_f32_16x16x32_bf16 v[160:163], v[96:99], v[72:75], v[160:163]
    ds_read_b128 v[68:71], v10 offset:18432
    v_mfma_f32_16x16x32_bf16 v[164:167], v[100:103], v[72:75], v[164:167]
    v_mfma_f32_16x16x32_bf16 v[168:171], v[104:107], v[72:75], v[168:171]
    v_mfma_f32_16x16x32_bf16 v[172:175], v[108:111], v[72:75], v[172:175]
    ds_read_b128 v[72:75], v10 offset:24576
    v_mfma_f32_16x16x32_bf16 v[176:179], v[96:99], v[76:79], v[176:179]
    v_mfma_f32_16x16x32_bf16 v[180:183], v[100:103], v[76:79], v[180:183]
    v_mfma_f32_16x16x32_bf16 v[184:187], v[104:107], v[76:79], v[184:187]
    v_mfma_f32_16x16x32_bf16 v[188:191], v[108:111], v[76:79], v[188:191]
    ds_read_b128 v[76:79], v10 offset:26624
    v_mfma_f32_16x16x32_bf16 v[128:131], v[112:115], v[80:83], v[128:131]
    v_mfma_f32_16x16x32_bf16 v[132:135], v[116:119], v[80:83], v[132:135]
    v_mfma_f32_16x16x32_bf16 v[136:139], v[120:123], v[80:83], v[136:139]
    v_mfma_f32_16x16x32_bf16 v[140:143], v[124:127], v[80:83], v[140:143]
    ds_read_b128 v[80:83], v10 offset:17408
    v_mfma_f32_16x16x32_bf16 v[144:147], v[112:115], v[84:87], v[144:147]
    v_mfma_f32_16x16x32_bf16 v[148:151], v[116:119], v[84:87], v[148:151]
    v_mfma_f32_16x16x32_bf16 v[152:155], v[120:123], v[84:87], v[152:155]
    v_mfma_f32_16x16x32_bf16 v[156:159], v[124:127], v[84:87], v[156:159]
    ds_read_b128 v[84:87], v10 offset:19456
    v_mfma_f32_16x16x32_bf16 v[160:163], v[112:115], v[88:91], v[160:163]
    v_mfma_f32_16x16x32_bf16 v[164:167], v[116:119], v[88:91], v[164:167]
    v_mfma_f32_16x16x32_bf16 v[168:171], v[120:123], v[88:91], v[168:171]
    v_mfma_f32_16x16x32_bf16 v[172:175], v[124:127], v[88:91], v[172:175]
    ds_read_b128 v[88:91], v10 offset:25600
    v_mfma_f32_16x16x32_bf16 v[176:179], v[112:115], v[92:95], v[176:179]
    v_mfma_f32_16x16x32_bf16 v[180:183], v[116:119], v[92:95], v[180:183]
    v_mfma_f32_16x16x32_bf16 v[184:187], v[120:123], v[92:95], v[184:187]
    v_mfma_f32_16x16x32_bf16 v[188:191], v[124:127], v[92:95], v[188:191]
    ds_read_b128 v[92:95], v10 offset:27648
    s_waitcnt lgkmcnt(7)
    v_mfma_f32_16x16x32_bf16 v[192:195], v[96:99], v[64:67], v[192:195]
    v_mfma_f32_16x16x32_bf16 v[196:199], v[100:103], v[64:67], v[196:199]
    v_mfma_f32_16x16x32_bf16 v[200:203], v[104:107], v[64:67], v[200:203]
    s_waitcnt vmcnt(0)
    v_lshl_or_b32 v36, v36, 16, v32
    v_xor_b32 v36, s46, v36
    v_mfma_f32_16x16x32_bf16 v[204:207], v[108:111], v[64:67], v[204:207]
    v_xor_b32 v32, 0x80000000, v36
    v_lshl_or_b32 v48, v52, 16, v48
    s_waitcnt lgkmcnt(6)
    v_mfma_f32_16x16x32_bf16 v[208:211], v[96:99], v[68:71], v[208:211]
    v_lshl_or_b32 v38, v38, 16, v34
    v_xor_b32 v38, s46, v38
    v_mfma_f32_16x16x32_bf16 v[212:215], v[100:103], v[68:71], v[212:215]
    v_xor_b32 v34, 0x80000000, v38
    v_lshl_or_b32 v50, v54, 16, v50
    v_mfma_f32_16x16x32_bf16 v[216:219], v[104:107], v[68:71], v[216:219]
    v_permlane16_swap_b32 v56, v58
    v_permlane16_swap_b32 v57, v59
    v_mfma_f32_16x16x32_bf16 v[220:223], v[108:111], v[68:71], v[220:223]
    s_waitcnt lgkmcnt(0)
    s_barrier
    ds_read_b128 v[64:67], v10 offset:49152
    ds_read_b128 v[68:71], v10 offset:51200
    v_mfma_f32_16x16x32_bf16 v[224:227], v[96:99], v[72:75], v[224:227]
    v_permlane16_swap_b32 v60, v62
    v_permlane16_swap_b32 v61, v63
    v_mfma_f32_16x16x32_bf16 v[228:231], v[100:103], v[72:75], v[228:231]
    v_permlane16_swap_b32 v28, v30
    v_permlane16_swap_b32 v29, v31
    v_mfma_f32_16x16x32_bf16 v[232:235], v[104:107], v[72:75], v[232:235]
    v_permlane16_swap_b32 v44, v46
    v_permlane16_swap_b32 v45, v47
    v_mfma_f32_16x16x32_bf16 v[236:239], v[108:111], v[72:75], v[236:239]
    ds_read_b128 v[72:75], v10 offset:57344
    v_mfma_f32_16x16x32_bf16 v[240:243], v[96:99], v[76:79], v[240:243]
    v_subrev_u32 v12, 65536, v12
    v_subrev_u32 v13, 65536, v13
    v_subrev_u32 v14, 65536, v14
    v_subrev_u32 v15, 65536, v15
    ds_read_b64_tr_b16 v[96:97], v12 offset:0
    v_mfma_f32_16x16x32_bf16 v[244:247], v[100:103], v[76:79], v[244:247]
    ds_read_b64_tr_b16 v[98:99], v12 offset:1024
    ds_read_b64_tr_b16 v[100:101], v13 offset:0
    v_mfma_f32_16x16x32_bf16 v[248:251], v[104:107], v[76:79], v[248:251]
    ds_read_b64_tr_b16 v[102:103], v13 offset:1024
    ds_read_b64_tr_b16 v[104:105], v14 offset:0
    v_mfma_f32_16x16x32_bf16 v[252:255], v[108:111], v[76:79], v[252:255]
    ds_read_b64_tr_b16 v[106:107], v14 offset:1024
    ds_read_b64_tr_b16 v[108:109], v15 offset:0
    v_mfma_f32_16x16x32_bf16 v[192:195], v[112:115], v[80:83], v[192:195]
    ds_read_b64_tr_b16 v[110:111], v15 offset:1024
    ds_read_b128 v[76:79], v10 offset:59392
    v_mfma_f32_16x16x32_bf16 v[196:199], v[116:119], v[80:83], v[196:199]
    v_mfma_f32_16x16x32_bf16 v[200:203], v[120:123], v[80:83], v[200:203]
    v_mfma_f32_16x16x32_bf16 v[204:207], v[124:127], v[80:83], v[204:207]
    ds_read_b128 v[80:83], v10 offset:50176
    v_mfma_f32_16x16x32_bf16 v[208:211], v[112:115], v[84:87], v[208:211]
    v_mfma_f32_16x16x32_bf16 v[212:215], v[116:119], v[84:87], v[212:215]
    v_mfma_f32_16x16x32_bf16 v[216:219], v[120:123], v[84:87], v[216:219]
    v_mfma_f32_16x16x32_bf16 v[220:223], v[124:127], v[84:87], v[220:223]
    ds_read_b128 v[84:87], v10 offset:52224
    v_mfma_f32_16x16x32_bf16 v[224:227], v[112:115], v[88:91], v[224:227]
    v_mfma_f32_16x16x32_bf16 v[228:231], v[116:119], v[88:91], v[228:231]
    v_mfma_f32_16x16x32_bf16 v[232:235], v[120:123], v[88:91], v[232:235]
    v_mfma_f32_16x16x32_bf16 v[236:239], v[124:127], v[88:91], v[236:239]
    ds_read_b128 v[88:91], v10 offset:58368
    v_mfma_f32_16x16x32_bf16 v[240:243], v[112:115], v[92:95], v[240:243]
    ds_read_b64_tr_b16 v[112:113], v12 offset:8192
    ds_read_b64_tr_b16 v[114:115], v12 offset:9216
    v_mfma_f32_16x16x32_bf16 v[244:247], v[116:119], v[92:95], v[244:247]
    ds_read_b64_tr_b16 v[116:117], v13 offset:8192
    ds_read_b64_tr_b16 v[118:119], v13 offset:9216
    v_mfma_f32_16x16x32_bf16 v[248:251], v[120:123], v[92:95], v[248:251]
    ds_read_b64_tr_b16 v[120:121], v14 offset:8192
    ds_read_b64_tr_b16 v[122:123], v14 offset:9216
    v_mfma_f32_16x16x32_bf16 v[252:255], v[124:127], v[92:95], v[252:255]
    ds_read_b64_tr_b16 v[124:125], v15 offset:8192
    ds_read_b64_tr_b16 v[126:127], v15 offset:9216
    s_waitcnt lgkmcnt(15)
    v_mfma_f32_16x16x32_bf16 v[128:131], v[96:99], v[64:67], v[128:131]
    ds_read_b128 v[92:95], v10 offset:60416
    v_mfma_f32_16x16x32_bf16 v[132:135], v[100:103], v[64:67], v[132:135]
    s_waitcnt lgkmcnt(15)
    v_mfma_f32_16x16x32_bf16 v[136:139], v[104:107], v[64:67], v[136:139]
    s_waitcnt lgkmcnt(13)
    v_mfma_f32_16x16x32_bf16 v[140:143], v[108:111], v[64:67], v[140:143]
    v_mfma_f32_16x16x16_bf16 v[192:195], v[48:49], v[36:37], v[192:195]
    v_mfma_f32_16x16x16_bf16 v[196:199], v[50:51], v[36:37], v[196:199]
    v_mfma_f32_16x16x32_bf16 v[144:147], v[96:99], v[68:71], v[144:147]
    v_mfma_f32_16x16x16_bf16 v[208:211], v[48:49], v[38:39], v[208:211]
    v_mfma_f32_16x16x16_bf16 v[212:215], v[50:51], v[38:39], v[212:215]
    v_mfma_f32_16x16x32_bf16 v[148:151], v[100:103], v[68:71], v[148:151]
    v_mfma_f32_16x16x32_bf16 v[152:155], v[104:107], v[68:71], v[152:155]
    v_mfma_f32_16x16x32_bf16 v[156:159], v[108:111], v[68:71], v[156:159]
    s_waitcnt lgkmcnt(0)
    s_barrier
    v_add_u32 v10, 81920, v10
    ds_read_b128 v[64:67], v10 offset:49152
    v_mfma_f32_16x16x32_bf16 v[160:163], v[96:99], v[72:75], v[160:163]
    ds_read_b128 v[68:71], v10 offset:51200
    v_mfma_f32_16x16x32_bf16 v[164:167], v[100:103], v[72:75], v[164:167]
    v_mfma_f32_16x16x32_bf16 v[168:171], v[104:107], v[72:75], v[168:171]
    v_mfma_f32_16x16x32_bf16 v[172:175], v[108:111], v[72:75], v[172:175]
    ds_read_b128 v[72:75], v10 offset:57344
    v_mfma_f32_16x16x32_bf16 v[176:179], v[96:99], v[76:79], v[176:179]
    v_mfma_f32_16x16x32_bf16 v[180:183], v[100:103], v[76:79], v[180:183]
    v_dot2c_f32_bf16 v192, s47, v28
    v_dot2c_f32_bf16 v193, s48, v28
    v_mfma_f32_16x16x32_bf16 v[184:187], v[104:107], v[76:79], v[184:187]
    v_dot2c_f32_bf16 v194, s47, v29
    v_dot2c_f32_bf16 v195, s48, v29
    v_mfma_f32_16x16x32_bf16 v[188:191], v[108:111], v[76:79], v[188:191]
    ds_read_b128 v[76:79], v10 offset:59392
    v_dot2c_f32_bf16 v196, s47, v30
    v_mfma_f32_16x16x32_bf16 v[128:131], v[112:115], v[80:83], v[128:131]
    v_dot2c_f32_bf16 v197, s48, v30
    v_dot2c_f32_bf16 v198, s47, v31
    v_mfma_f32_16x16x32_bf16 v[132:135], v[116:119], v[80:83], v[132:135]
    v_dot2c_f32_bf16 v199, s48, v31
    v_dot2c_f32_bf16 v208, s47, v44
    v_mfma_f32_16x16x32_bf16 v[136:139], v[120:123], v[80:83], v[136:139]
    v_dot2c_f32_bf16 v209, s48, v44
    v_dot2c_f32_bf16 v210, s47, v45
    v_mfma_f32_16x16x32_bf16 v[140:143], v[124:127], v[80:83], v[140:143]
    ds_read_b128 v[80:83], v10 offset:50176
    v_dot2c_f32_bf16 v211, s48, v45
    v_mfma_f32_16x16x32_bf16 v[144:147], v[112:115], v[84:87], v[144:147]
    v_dot2c_f32_bf16 v212, s47, v46
    v_dot2c_f32_bf16 v213, s48, v46
    v_mfma_f32_16x16x32_bf16 v[148:151], v[116:119], v[84:87], v[148:151]
    v_dot2c_f32_bf16 v214, s47, v47
    v_dot2c_f32_bf16 v215, s48, v47
    v_mfma_f32_16x16x32_bf16 v[152:155], v[120:123], v[84:87], v[152:155]
    v_mfma_f32_16x16x32_bf16 v[156:159], v[124:127], v[84:87], v[156:159]
    ds_read_b128 v[84:87], v10 offset:52224
    v_mfma_f32_16x16x32_bf16 v[160:163], v[112:115], v[88:91], v[160:163]
    v_mfma_f32_16x16x32_bf16 v[164:167], v[116:119], v[88:91], v[164:167]
    v_mfma_f32_16x16x32_bf16 v[168:171], v[120:123], v[88:91], v[168:171]
    v_mfma_f32_16x16x32_bf16 v[172:175], v[124:127], v[88:91], v[172:175]
    ds_read_b128 v[88:91], v10 offset:58368
    v_mfma_f32_16x16x32_bf16 v[176:179], v[112:115], v[92:95], v[176:179]
    v_mfma_f32_16x16x32_bf16 v[180:183], v[116:119], v[92:95], v[180:183]
    v_mfma_f32_16x16x32_bf16 v[184:187], v[120:123], v[92:95], v[184:187]
    v_mfma_f32_16x16x32_bf16 v[188:191], v[124:127], v[92:95], v[188:191]
    ds_read_b128 v[92:95], v10 offset:60416
    s_waitcnt lgkmcnt(7)
    v_mfma_f32_16x16x32_bf16 v[192:195], v[96:99], v[64:67], v[192:195]
    v_mfma_f32_16x16x32_bf16 v[196:199], v[100:103], v[64:67], v[196:199]
    v_mfma_f32_16x16x32_bf16 v[200:203], v[104:107], v[64:67], v[200:203]
    v_mfma_f32_16x16x32_bf16 v[204:207], v[108:111], v[64:67], v[204:207]
    v_mfma_f32_16x16x16_bf16 v[128:131], v[48:49], v[32:33], v[128:131]
    v_mfma_f32_16x16x16_bf16 v[132:135], v[50:51], v[32:33], v[132:135]
    s_waitcnt lgkmcnt(6)
    v_mfma_f32_16x16x32_bf16 v[208:211], v[96:99], v[68:71], v[208:211]
    v_mfma_f32_16x16x16_bf16 v[144:147], v[48:49], v[34:35], v[144:147]
    v_mfma_f32_16x16x16_bf16 v[148:151], v[50:51], v[34:35], v[148:151]
    v_mfma_f32_16x16x32_bf16 v[212:215], v[100:103], v[68:71], v[212:215]
    v_mfma_f32_16x16x32_bf16 v[216:219], v[104:107], v[68:71], v[216:219]
    v_mfma_f32_16x16x32_bf16 v[220:223], v[108:111], v[68:71], v[220:223]
    s_waitcnt lgkmcnt(0)
    s_barrier
    ds_read_b128 v[64:67], v10 offset:0
    ds_read_b128 v[68:71], v10 offset:2048
    v_mfma_f32_16x16x32_bf16 v[224:227], v[96:99], v[72:75], v[224:227]
    v_mfma_f32_16x16x32_bf16 v[228:231], v[100:103], v[72:75], v[228:231]
    v_mfma_f32_16x16x32_bf16 v[232:235], v[104:107], v[72:75], v[232:235]
    v_mfma_f32_16x16x32_bf16 v[236:239], v[108:111], v[72:75], v[236:239]
    ds_read_b128 v[72:75], v10 offset:8192
    v_mfma_f32_16x16x32_bf16 v[240:243], v[96:99], v[76:79], v[240:243]
    ds_read_b64_tr_b16 v[96:97], v12 offset:32768
    ds_read_b64_tr_b16 v[98:99], v12 offset:33792
    v_mfma_f32_16x16x32_bf16 v[244:247], v[100:103], v[76:79], v[244:247]
    ds_read_b64_tr_b16 v[100:101], v13 offset:32768
    ds_read_b64_tr_b16 v[102:103], v13 offset:33792
    v_mfma_f32_16x16x32_bf16 v[248:251], v[104:107], v[76:79], v[248:251]
    ds_read_b64_tr_b16 v[104:105], v14 offset:32768
    ds_read_b64_tr_b16 v[106:107], v14 offset:33792
    v_mfma_f32_16x16x32_bf16 v[252:255], v[108:111], v[76:79], v[252:255]
    ds_read_b64_tr_b16 v[108:109], v15 offset:32768
    ds_read_b64_tr_b16 v[110:111], v15 offset:33792
    v_mfma_f32_16x16x32_bf16 v[192:195], v[112:115], v[80:83], v[192:195]
    ds_read_b128 v[76:79], v10 offset:10240
    v_dot2c_f32_bf16 v128, s47, v56
    v_mfma_f32_16x16x32_bf16 v[196:199], v[116:119], v[80:83], v[196:199]
    v_dot2c_f32_bf16 v129, s48, v56
    v_dot2c_f32_bf16 v130, s47, v57
    v_mfma_f32_16x16x32_bf16 v[200:203], v[120:123], v[80:83], v[200:203]
    v_dot2c_f32_bf16 v131, s48, v57
    v_dot2c_f32_bf16 v132, s47, v58
    v_mfma_f32_16x16x32_bf16 v[204:207], v[124:127], v[80:83], v[204:207]
    ds_read_b128 v[80:83], v10 offset:1024
    v_dot2c_f32_bf16 v133, s48, v58
    v_mfma_f32_16x16x32_bf16 v[208:211], v[112:115], v[84:87], v[208:211]
    v_dot2c_f32_bf16 v134, s47, v59
    v_dot2c_f32_bf16 v135, s48, v59
    v_mfma_f32_16x16x32_bf16 v[212:215], v[116:119], v[84:87], v[212:215]
    v_dot2c_f32_bf16 v144, s47, v60
    v_dot2c_f32_bf16 v145, s48, v60
    v_mfma_f32_16x16x32_bf16 v[216:219], v[120:123], v[84:87], v[216:219]
    v_dot2c_f32_bf16 v146, s47, v61
    v_dot2c_f32_bf16 v147, s48, v61
    v_mfma_f32_16x16x32_bf16 v[220:223], v[124:127], v[84:87], v[220:223]
    ds_read_b128 v[84:87], v10 offset:3072
    v_dot2c_f32_bf16 v148, s47, v62
    v_mfma_f32_16x16x32_bf16 v[224:227], v[112:115], v[88:91], v[224:227]
    v_dot2c_f32_bf16 v149, s48, v62
    v_dot2c_f32_bf16 v150, s47, v63
    v_mfma_f32_16x16x32_bf16 v[228:231], v[116:119], v[88:91], v[228:231]
    v_dot2c_f32_bf16 v151, s48, v63
    v_mfma_f32_16x16x32_bf16 v[232:235], v[120:123], v[88:91], v[232:235]
    v_mfma_f32_16x16x32_bf16 v[236:239], v[124:127], v[88:91], v[236:239]
    ds_read_b128 v[88:91], v10 offset:9216
    v_mfma_f32_16x16x32_bf16 v[240:243], v[112:115], v[92:95], v[240:243]
    ds_read_b64_tr_b16 v[112:113], v12 offset:40960
    ds_read_b64_tr_b16 v[114:115], v12 offset:41984
    v_mfma_f32_16x16x32_bf16 v[244:247], v[116:119], v[92:95], v[244:247]
    ds_read_b64_tr_b16 v[116:117], v13 offset:40960
    ds_read_b64_tr_b16 v[118:119], v13 offset:41984
    v_mfma_f32_16x16x32_bf16 v[248:251], v[120:123], v[92:95], v[248:251]
    ds_read_b64_tr_b16 v[120:121], v14 offset:40960
    ds_read_b64_tr_b16 v[122:123], v14 offset:41984
    v_mfma_f32_16x16x32_bf16 v[252:255], v[124:127], v[92:95], v[252:255]
    ds_read_b64_tr_b16 v[124:125], v15 offset:40960
    ds_read_b64_tr_b16 v[126:127], v15 offset:41984
    s_waitcnt lgkmcnt(15)
    v_mfma_f32_16x16x32_bf16 v[128:131], v[96:99], v[64:67], v[128:131]
    ds_read_b128 v[92:95], v10 offset:11264
    v_mfma_f32_16x16x32_bf16 v[132:135], v[100:103], v[64:67], v[132:135]
    s_waitcnt lgkmcnt(15)
    v_mfma_f32_16x16x32_bf16 v[136:139], v[104:107], v[64:67], v[136:139]
    s_waitcnt lgkmcnt(13)
    v_mfma_f32_16x16x32_bf16 v[140:143], v[108:111], v[64:67], v[140:143]
    v_mfma_f32_16x16x32_bf16 v[144:147], v[96:99], v[68:71], v[144:147]
    v_mfma_f32_16x16x32_bf16 v[148:151], v[100:103], v[68:71], v[148:151]
    v_mfma_f32_16x16x32_bf16 v[152:155], v[104:107], v[68:71], v[152:155]
    v_mfma_f32_16x16x32_bf16 v[156:159], v[108:111], v[68:71], v[156:159]
    s_waitcnt lgkmcnt(0)
    s_barrier
    v_subrev_u32 v10, 16384, v10
    ds_read_b128 v[64:67], v10 offset:0
    v_mfma_f32_16x16x32_bf16 v[160:163], v[96:99], v[72:75], v[160:163]
    ds_read_b128 v[68:71], v10 offset:2048
    v_mfma_f32_16x16x32_bf16 v[164:167], v[100:103], v[72:75], v[164:167]
    v_mfma_f32_16x16x32_bf16 v[168:171], v[104:107], v[72:75], v[168:171]
    v_mfma_f32_16x16x32_bf16 v[172:175], v[108:111], v[72:75], v[172:175]
    ds_read_b128 v[72:75], v10 offset:8192
    v_mfma_f32_16x16x32_bf16 v[176:179], v[96:99], v[76:79], v[176:179]
    v_mfma_f32_16x16x32_bf16 v[180:183], v[100:103], v[76:79], v[180:183]
    v_mfma_f32_16x16x32_bf16 v[184:187], v[104:107], v[76:79], v[184:187]
    v_mfma_f32_16x16x32_bf16 v[188:191], v[108:111], v[76:79], v[188:191]
    ds_read_b128 v[76:79], v10 offset:10240
    v_mfma_f32_16x16x32_bf16 v[128:131], v[112:115], v[80:83], v[128:131]
    v_mfma_f32_16x16x32_bf16 v[132:135], v[116:119], v[80:83], v[132:135]
    v_mfma_f32_16x16x32_bf16 v[136:139], v[120:123], v[80:83], v[136:139]
    v_mfma_f32_16x16x32_bf16 v[140:143], v[124:127], v[80:83], v[140:143]
    ds_read_b128 v[80:83], v10 offset:1024
    v_mfma_f32_16x16x32_bf16 v[144:147], v[112:115], v[84:87], v[144:147]
    v_mfma_f32_16x16x32_bf16 v[148:151], v[116:119], v[84:87], v[148:151]
    v_mfma_f32_16x16x32_bf16 v[152:155], v[120:123], v[84:87], v[152:155]
    v_mfma_f32_16x16x32_bf16 v[156:159], v[124:127], v[84:87], v[156:159]
    ds_read_b128 v[84:87], v10 offset:3072
    v_mfma_f32_16x16x32_bf16 v[160:163], v[112:115], v[88:91], v[160:163]
    v_mfma_f32_16x16x32_bf16 v[164:167], v[116:119], v[88:91], v[164:167]
    v_mfma_f32_16x16x32_bf16 v[168:171], v[120:123], v[88:91], v[168:171]
    v_mfma_f32_16x16x32_bf16 v[172:175], v[124:127], v[88:91], v[172:175]
    ds_read_b128 v[88:91], v10 offset:9216
    v_mfma_f32_16x16x32_bf16 v[176:179], v[112:115], v[92:95], v[176:179]
    v_mfma_f32_16x16x32_bf16 v[180:183], v[116:119], v[92:95], v[180:183]
    v_mfma_f32_16x16x32_bf16 v[184:187], v[120:123], v[92:95], v[184:187]
    v_mfma_f32_16x16x32_bf16 v[188:191], v[124:127], v[92:95], v[188:191]
    ds_read_b128 v[92:95], v10 offset:11264
    s_waitcnt lgkmcnt(7)
    v_mfma_f32_16x16x32_bf16 v[192:195], v[96:99], v[64:67], v[192:195]
    v_mfma_f32_16x16x32_bf16 v[196:199], v[100:103], v[64:67], v[196:199]
    v_mfma_f32_16x16x32_bf16 v[200:203], v[104:107], v[64:67], v[200:203]
    v_mfma_f32_16x16x32_bf16 v[204:207], v[108:111], v[64:67], v[204:207]
    s_waitcnt lgkmcnt(6)
    v_mfma_f32_16x16x32_bf16 v[208:211], v[96:99], v[68:71], v[208:211]
    v_mfma_f32_16x16x32_bf16 v[212:215], v[100:103], v[68:71], v[212:215]
    v_mfma_f32_16x16x32_bf16 v[216:219], v[104:107], v[68:71], v[216:219]
    v_mfma_f32_16x16x32_bf16 v[220:223], v[108:111], v[68:71], v[220:223]
    s_waitcnt lgkmcnt(0)
    s_barrier
    ds_read_b128 v[64:67], v10 offset:49152
    ds_read_b128 v[68:71], v10 offset:51200
    v_mfma_f32_16x16x32_bf16 v[224:227], v[96:99], v[72:75], v[224:227]
    v_mfma_f32_16x16x32_bf16 v[228:231], v[100:103], v[72:75], v[228:231]
    v_mfma_f32_16x16x32_bf16 v[232:235], v[104:107], v[72:75], v[232:235]
    v_mfma_f32_16x16x32_bf16 v[236:239], v[108:111], v[72:75], v[236:239]
    ds_read_b128 v[72:75], v10 offset:57344
    v_mfma_f32_16x16x32_bf16 v[240:243], v[96:99], v[76:79], v[240:243]
    v_add_u32 v12, 65536, v12
    v_add_u32 v13, 65536, v13
    v_add_u32 v14, 65536, v14
    v_add_u32 v15, 65536, v15
    ds_read_b64_tr_b16 v[96:97], v12 offset:32768
    v_mfma_f32_16x16x32_bf16 v[244:247], v[100:103], v[76:79], v[244:247]
    ds_read_b64_tr_b16 v[98:99], v12 offset:33792
    ds_read_b64_tr_b16 v[100:101], v13 offset:32768
    v_mfma_f32_16x16x32_bf16 v[248:251], v[104:107], v[76:79], v[248:251]
    ds_read_b64_tr_b16 v[102:103], v13 offset:33792
    ds_read_b64_tr_b16 v[104:105], v14 offset:32768
    v_mfma_f32_16x16x32_bf16 v[252:255], v[108:111], v[76:79], v[252:255]
    ds_read_b64_tr_b16 v[106:107], v14 offset:33792
    ds_read_b64_tr_b16 v[108:109], v15 offset:32768
    v_mfma_f32_16x16x32_bf16 v[192:195], v[112:115], v[80:83], v[192:195]
    ds_read_b64_tr_b16 v[110:111], v15 offset:33792
    ds_read_b128 v[76:79], v10 offset:59392
    v_mfma_f32_16x16x32_bf16 v[196:199], v[116:119], v[80:83], v[196:199]
    v_mfma_f32_16x16x32_bf16 v[200:203], v[120:123], v[80:83], v[200:203]
    v_mfma_f32_16x16x32_bf16 v[204:207], v[124:127], v[80:83], v[204:207]
    ds_read_b128 v[80:83], v10 offset:50176
    v_mfma_f32_16x16x32_bf16 v[208:211], v[112:115], v[84:87], v[208:211]
    v_mfma_f32_16x16x32_bf16 v[212:215], v[116:119], v[84:87], v[212:215]
    v_mfma_f32_16x16x32_bf16 v[216:219], v[120:123], v[84:87], v[216:219]
    v_mfma_f32_16x16x32_bf16 v[220:223], v[124:127], v[84:87], v[220:223]
    ds_read_b128 v[84:87], v10 offset:52224
    v_mfma_f32_16x16x32_bf16 v[224:227], v[112:115], v[88:91], v[224:227]
    v_mfma_f32_16x16x32_bf16 v[228:231], v[116:119], v[88:91], v[228:231]
    v_mfma_f32_16x16x32_bf16 v[232:235], v[120:123], v[88:91], v[232:235]
    v_mfma_f32_16x16x32_bf16 v[236:239], v[124:127], v[88:91], v[236:239]
    ds_read_b128 v[88:91], v10 offset:58368
    v_mfma_f32_16x16x32_bf16 v[240:243], v[112:115], v[92:95], v[240:243]
    ds_read_b64_tr_b16 v[112:113], v12 offset:40960
    ds_read_b64_tr_b16 v[114:115], v12 offset:41984
    v_mfma_f32_16x16x32_bf16 v[244:247], v[116:119], v[92:95], v[244:247]
    ds_read_b64_tr_b16 v[116:117], v13 offset:40960
    ds_read_b64_tr_b16 v[118:119], v13 offset:41984
    v_mfma_f32_16x16x32_bf16 v[248:251], v[120:123], v[92:95], v[248:251]
    ds_read_b64_tr_b16 v[120:121], v14 offset:40960
    ds_read_b64_tr_b16 v[122:123], v14 offset:41984
    v_mfma_f32_16x16x32_bf16 v[252:255], v[124:127], v[92:95], v[252:255]
    ds_read_b64_tr_b16 v[124:125], v15 offset:40960
    ds_read_b64_tr_b16 v[126:127], v15 offset:41984
    s_waitcnt lgkmcnt(15)
    v_mfma_f32_16x16x32_bf16 v[128:131], v[96:99], v[64:67], v[128:131]
    ds_read_b128 v[92:95], v10 offset:60416
    v_mfma_f32_16x16x32_bf16 v[132:135], v[100:103], v[64:67], v[132:135]
    s_waitcnt lgkmcnt(15)
    v_mfma_f32_16x16x32_bf16 v[136:139], v[104:107], v[64:67], v[136:139]
    s_waitcnt lgkmcnt(13)
    v_mfma_f32_16x16x32_bf16 v[140:143], v[108:111], v[64:67], v[140:143]
    v_mfma_f32_16x16x32_bf16 v[144:147], v[96:99], v[68:71], v[144:147]
    v_mfma_f32_16x16x32_bf16 v[148:151], v[100:103], v[68:71], v[148:151]
    v_mfma_f32_16x16x32_bf16 v[152:155], v[104:107], v[68:71], v[152:155]
    v_mfma_f32_16x16x32_bf16 v[156:159], v[108:111], v[68:71], v[156:159]
    s_waitcnt lgkmcnt(0)
    s_barrier
    v_subrev_u32 v10, 65536, v10
    ds_read_b128 v[64:67], v10 offset:16384
    v_mfma_f32_16x16x32_bf16 v[160:163], v[96:99], v[72:75], v[160:163]
    ds_read_b128 v[68:71], v10 offset:18432
    v_mfma_f32_16x16x32_bf16 v[164:167], v[100:103], v[72:75], v[164:167]
    v_mfma_f32_16x16x32_bf16 v[168:171], v[104:107], v[72:75], v[168:171]
    v_mfma_f32_16x16x32_bf16 v[172:175], v[108:111], v[72:75], v[172:175]
    ds_read_b128 v[72:75], v10 offset:24576
    v_mfma_f32_16x16x32_bf16 v[176:179], v[96:99], v[76:79], v[176:179]
    v_mfma_f32_16x16x32_bf16 v[180:183], v[100:103], v[76:79], v[180:183]
    v_mfma_f32_16x16x32_bf16 v[184:187], v[104:107], v[76:79], v[184:187]
    v_mfma_f32_16x16x32_bf16 v[188:191], v[108:111], v[76:79], v[188:191]
    ds_read_b128 v[76:79], v10 offset:26624
    v_mfma_f32_16x16x32_bf16 v[128:131], v[112:115], v[80:83], v[128:131]
    v_mfma_f32_16x16x32_bf16 v[132:135], v[116:119], v[80:83], v[132:135]
    v_mfma_f32_16x16x32_bf16 v[136:139], v[120:123], v[80:83], v[136:139]
    v_mfma_f32_16x16x32_bf16 v[140:143], v[124:127], v[80:83], v[140:143]
    ds_read_b128 v[80:83], v10 offset:17408
    v_mfma_f32_16x16x32_bf16 v[144:147], v[112:115], v[84:87], v[144:147]
    v_mfma_f32_16x16x32_bf16 v[148:151], v[116:119], v[84:87], v[148:151]
    v_mfma_f32_16x16x32_bf16 v[152:155], v[120:123], v[84:87], v[152:155]
    v_mfma_f32_16x16x32_bf16 v[156:159], v[124:127], v[84:87], v[156:159]
    ds_read_b128 v[84:87], v10 offset:19456
    v_mfma_f32_16x16x32_bf16 v[160:163], v[112:115], v[88:91], v[160:163]
    v_mfma_f32_16x16x32_bf16 v[164:167], v[116:119], v[88:91], v[164:167]
    v_mfma_f32_16x16x32_bf16 v[168:171], v[120:123], v[88:91], v[168:171]
    v_mfma_f32_16x16x32_bf16 v[172:175], v[124:127], v[88:91], v[172:175]
    ds_read_b128 v[88:91], v10 offset:25600
    v_mfma_f32_16x16x32_bf16 v[176:179], v[112:115], v[92:95], v[176:179]
    v_mfma_f32_16x16x32_bf16 v[180:183], v[116:119], v[92:95], v[180:183]
    v_mfma_f32_16x16x32_bf16 v[184:187], v[120:123], v[92:95], v[184:187]
    v_mfma_f32_16x16x32_bf16 v[188:191], v[124:127], v[92:95], v[188:191]
    ds_read_b128 v[92:95], v10 offset:27648
    s_waitcnt lgkmcnt(7)
    v_mfma_f32_16x16x32_bf16 v[192:195], v[96:99], v[64:67], v[192:195]
    v_mfma_f32_16x16x32_bf16 v[196:199], v[100:103], v[64:67], v[196:199]
    v_mfma_f32_16x16x32_bf16 v[200:203], v[104:107], v[64:67], v[200:203]
    v_mfma_f32_16x16x32_bf16 v[204:207], v[108:111], v[64:67], v[204:207]
    s_waitcnt lgkmcnt(6)
    v_mfma_f32_16x16x32_bf16 v[208:211], v[96:99], v[68:71], v[208:211]
    v_mfma_f32_16x16x32_bf16 v[212:215], v[100:103], v[68:71], v[212:215]
    v_mfma_f32_16x16x32_bf16 v[216:219], v[104:107], v[68:71], v[216:219]
    v_mfma_f32_16x16x32_bf16 v[220:223], v[108:111], v[68:71], v[220:223]
    s_waitcnt lgkmcnt(0)
    s_barrier
    ds_read_b128 v[64:67], v10 offset:49152
    ds_read_b128 v[68:71], v10 offset:51200
    v_mfma_f32_16x16x32_bf16 v[224:227], v[96:99], v[72:75], v[224:227]
    v_mfma_f32_16x16x32_bf16 v[228:231], v[100:103], v[72:75], v[228:231]
    v_mfma_f32_16x16x32_bf16 v[232:235], v[104:107], v[72:75], v[232:235]
    v_mfma_f32_16x16x32_bf16 v[236:239], v[108:111], v[72:75], v[236:239]
    ds_read_b128 v[72:75], v10 offset:57344
    v_mfma_f32_16x16x32_bf16 v[240:243], v[96:99], v[76:79], v[240:243]
    v_subrev_u32 v12, 65536, v12
    v_subrev_u32 v13, 65536, v13
    v_subrev_u32 v14, 65536, v14
    v_subrev_u32 v15, 65536, v15
    ds_read_b64_tr_b16 v[96:97], v12 offset:0
    v_mfma_f32_16x16x32_bf16 v[244:247], v[100:103], v[76:79], v[244:247]
    ds_read_b64_tr_b16 v[98:99], v12 offset:1024
    ds_read_b64_tr_b16 v[100:101], v13 offset:0
    buffer_load_dword v17, v16, s[24:27], s54 offen sc1
    v_mfma_f32_16x16x32_bf16 v[248:251], v[104:107], v[76:79], v[248:251]
    ds_read_b64_tr_b16 v[102:103], v13 offset:1024
    ds_read_b64_tr_b16 v[104:105], v14 offset:0
    v_mfma_f32_16x16x32_bf16 v[252:255], v[108:111], v[76:79], v[252:255]
    ds_read_b64_tr_b16 v[106:107], v14 offset:1024
    ds_read_b64_tr_b16 v[108:109], v15 offset:0
    v_mfma_f32_16x16x32_bf16 v[192:195], v[112:115], v[80:83], v[192:195]
    ds_read_b64_tr_b16 v[110:111], v15 offset:1024
    ds_read_b128 v[76:79], v10 offset:59392
    v_mfma_f32_16x16x32_bf16 v[196:199], v[116:119], v[80:83], v[196:199]
    v_mfma_f32_16x16x32_bf16 v[200:203], v[120:123], v[80:83], v[200:203]
    v_mfma_f32_16x16x32_bf16 v[204:207], v[124:127], v[80:83], v[204:207]
    ds_read_b128 v[80:83], v10 offset:50176
    v_mfma_f32_16x16x32_bf16 v[208:211], v[112:115], v[84:87], v[208:211]
    v_mfma_f32_16x16x32_bf16 v[212:215], v[116:119], v[84:87], v[212:215]
    v_mfma_f32_16x16x32_bf16 v[216:219], v[120:123], v[84:87], v[216:219]
    v_mfma_f32_16x16x32_bf16 v[220:223], v[124:127], v[84:87], v[220:223]
    ds_read_b128 v[84:87], v10 offset:52224
    v_mfma_f32_16x16x32_bf16 v[224:227], v[112:115], v[88:91], v[224:227]
    v_mfma_f32_16x16x32_bf16 v[228:231], v[116:119], v[88:91], v[228:231]
    v_mfma_f32_16x16x32_bf16 v[232:235], v[120:123], v[88:91], v[232:235]
    v_mfma_f32_16x16x32_bf16 v[236:239], v[124:127], v[88:91], v[236:239]
    ds_read_b128 v[88:91], v10 offset:58368
    v_mfma_f32_16x16x32_bf16 v[240:243], v[112:115], v[92:95], v[240:243]
    ds_read_b64_tr_b16 v[112:113], v12 offset:8192
    ds_read_b64_tr_b16 v[114:115], v12 offset:9216
    v_mfma_f32_16x16x32_bf16 v[244:247], v[116:119], v[92:95], v[244:247]
    ds_read_b64_tr_b16 v[116:117], v13 offset:8192
    ds_read_b64_tr_b16 v[118:119], v13 offset:9216
    v_mfma_f32_16x16x32_bf16 v[248:251], v[120:123], v[92:95], v[248:251]
    ds_read_b64_tr_b16 v[120:121], v14 offset:8192
    ds_read_b64_tr_b16 v[122:123], v14 offset:9216
    v_mfma_f32_16x16x32_bf16 v[252:255], v[124:127], v[92:95], v[252:255]
    ds_read_b64_tr_b16 v[124:125], v15 offset:8192
    ds_read_b64_tr_b16 v[126:127], v15 offset:9216
    s_waitcnt lgkmcnt(15)
    v_mfma_f32_16x16x32_bf16 v[128:131], v[96:99], v[64:67], v[128:131]
    ds_read_b128 v[92:95], v10 offset:60416
    v_mfma_f32_16x16x32_bf16 v[132:135], v[100:103], v[64:67], v[132:135]
    s_waitcnt lgkmcnt(15)
    v_mfma_f32_16x16x32_bf16 v[136:139], v[104:107], v[64:67], v[136:139]
    s_waitcnt lgkmcnt(13)
    v_mfma_f32_16x16x32_bf16 v[140:143], v[108:111], v[64:67], v[140:143]
    v_mfma_f32_16x16x32_bf16 v[144:147], v[96:99], v[68:71], v[144:147]
    v_mfma_f32_16x16x32_bf16 v[148:151], v[100:103], v[68:71], v[148:151]
    v_mfma_f32_16x16x32_bf16 v[152:155], v[104:107], v[68:71], v[152:155]
    v_mfma_f32_16x16x32_bf16 v[156:159], v[108:111], v[68:71], v[156:159]
    s_waitcnt lgkmcnt(0)
    s_barrier
    ds_read_b128 v[64:67], v10 offset:32768
    ds_read_b128 v[68:71], v10 offset:34816
    v_mfma_f32_16x16x32_bf16 v[160:163], v[96:99], v[72:75], v[160:163]
    v_mfma_f32_16x16x32_bf16 v[164:167], v[100:103], v[72:75], v[164:167]
    v_mfma_f32_16x16x32_bf16 v[168:171], v[104:107], v[72:75], v[168:171]
    v_mfma_f32_16x16x32_bf16 v[172:175], v[108:111], v[72:75], v[172:175]
    ds_read_b128 v[72:75], v10 offset:40960
    v_mfma_f32_16x16x32_bf16 v[176:179], v[96:99], v[76:79], v[176:179]
    v_add_u32 v12, 81920, v12
    v_add_u32 v13, 81920, v13
    v_add_u32 v14, 81920, v14
    v_add_u32 v15, 81920, v15
    ds_read_b64_tr_b16 v[96:97], v12 offset:49152
    v_mfma_f32_16x16x32_bf16 v[180:183], v[100:103], v[76:79], v[180:183]
    ds_read_b64_tr_b16 v[98:99], v12 offset:50176
    ds_read_b64_tr_b16 v[100:101], v13 offset:49152
    v_mfma_f32_16x16x32_bf16 v[184:187], v[104:107], v[76:79], v[184:187]
    ds_read_b64_tr_b16 v[102:103], v13 offset:50176
    ds_read_b64_tr_b16 v[104:105], v14 offset:49152
    v_mfma_f32_16x16x32_bf16 v[188:191], v[108:111], v[76:79], v[188:191]
    ds_read_b64_tr_b16 v[106:107], v14 offset:50176
    ds_read_b64_tr_b16 v[108:109], v15 offset:49152
    v_mfma_f32_16x16x32_bf16 v[128:131], v[112:115], v[80:83], v[128:131]
    ds_read_b64_tr_b16 v[110:111], v15 offset:50176
    ds_read_b128 v[76:79], v10 offset:43008
    v_mfma_f32_16x16x32_bf16 v[132:135], v[116:119], v[80:83], v[132:135]
    v_mfma_f32_16x16x32_bf16 v[136:139], v[120:123], v[80:83], v[136:139]
    v_mfma_f32_16x16x32_bf16 v[140:143], v[124:127], v[80:83], v[140:143]
    ds_read_b128 v[80:83], v10 offset:33792
    v_mfma_f32_16x16x32_bf16 v[144:147], v[112:115], v[84:87], v[144:147]
    v_mfma_f32_16x16x32_bf16 v[148:151], v[116:119], v[84:87], v[148:151]
    v_mfma_f32_16x16x32_bf16 v[152:155], v[120:123], v[84:87], v[152:155]
    v_mfma_f32_16x16x32_bf16 v[156:159], v[124:127], v[84:87], v[156:159]
    ds_read_b128 v[84:87], v10 offset:35840
    v_mfma_f32_16x16x32_bf16 v[160:163], v[112:115], v[88:91], v[160:163]
    v_mfma_f32_16x16x32_bf16 v[164:167], v[116:119], v[88:91], v[164:167]
    v_mfma_f32_16x16x32_bf16 v[168:171], v[120:123], v[88:91], v[168:171]
    v_mfma_f32_16x16x32_bf16 v[172:175], v[124:127], v[88:91], v[172:175]
    ds_read_b128 v[88:91], v10 offset:41984
    v_mfma_f32_16x16x32_bf16 v[176:179], v[112:115], v[92:95], v[176:179]
    ds_read_b64_tr_b16 v[112:113], v12 offset:57344
    ds_read_b64_tr_b16 v[114:115], v12 offset:58368
    v_mfma_f32_16x16x32_bf16 v[180:183], v[116:119], v[92:95], v[180:183]
    ds_read_b64_tr_b16 v[116:117], v13 offset:57344
    ds_read_b64_tr_b16 v[118:119], v13 offset:58368
    v_mfma_f32_16x16x32_bf16 v[184:187], v[120:123], v[92:95], v[184:187]
    ds_read_b64_tr_b16 v[120:121], v14 offset:57344
    ds_read_b64_tr_b16 v[122:123], v14 offset:58368
    v_mfma_f32_16x16x32_bf16 v[188:191], v[124:127], v[92:95], v[188:191]
    ds_read_b64_tr_b16 v[124:125], v15 offset:57344
    ds_read_b64_tr_b16 v[126:127], v15 offset:58368
    s_waitcnt lgkmcnt(15)
    v_mfma_f32_16x16x32_bf16 v[128:131], v[96:99], v[64:67], v[128:131]
    ds_read_b128 v[92:95], v10 offset:44032
    v_mfma_f32_16x16x32_bf16 v[132:135], v[100:103], v[64:67], v[132:135]
    s_waitcnt lgkmcnt(15)
    v_mfma_f32_16x16x32_bf16 v[136:139], v[104:107], v[64:67], v[136:139]
    s_waitcnt lgkmcnt(13)
    v_mfma_f32_16x16x32_bf16 v[140:143], v[108:111], v[64:67], v[140:143]
    v_mfma_f32_16x16x32_bf16 v[144:147], v[96:99], v[68:71], v[144:147]
    v_mfma_f32_16x16x32_bf16 v[148:151], v[100:103], v[68:71], v[148:151]
    v_mfma_f32_16x16x32_bf16 v[152:155], v[104:107], v[68:71], v[152:155]
    v_mfma_f32_16x16x32_bf16 v[156:159], v[108:111], v[68:71], v[156:159]
    s_waitcnt lgkmcnt(0)
    s_mov_b32 s87, 0x40000
    s_waitcnt vmcnt(0)
L_pl_1:
    v_cmp_ne_u32 vcc, 0, v17
    s_cmp_eq_u64 vcc, -1
    s_cbranch_scc1 L_ok_1
    buffer_load_dword v17, v16, s[24:27], s54 offen sc1
    s_waitcnt vmcnt(0)
    s_sub_u32 s87, s87, 1
    s_cbranch_scc0 L_pl_1
L_ok_1:
    s_barrier
    v_add_u32 v10, 65536, v10
    ds_read_b128 v[64:67], v10 offset:0
    v_mfma_f32_16x16x32_bf16 v[160:163], v[96:99], v[72:75], v[160:163]
    ds_read_b128 v[68:71], v10 offset:2048
    v_mfma_f32_16x16x32_bf16 v[164:167], v[100:103], v[72:75], v[164:167]
    v_mfma_f32_16x16x32_bf16 v[168:171], v[104:107], v[72:75], v[168:171]
    v_mfma_f32_16x16x32_bf16 v[172:175], v[108:111], v[72:75], v[172:175]
    ds_read_b128 v[72:75], v10 offset:8192
    v_mfma_f32_16x16x32_bf16 v[176:179], v[96:99], v[76:79], v[176:179]
    ds_read_b64_tr_b16 v[96:97], v12 offset:0
    ds_read_b64_tr_b16 v[98:99], v12 offset:1024
    v_mfma_f32_16x16x32_bf16 v[180:183], v[100:103], v[76:79], v[180:183]
    ds_read_b64_tr_b16 v[100:101], v13 offset:0
    ds_read_b64_tr_b16 v[102:103], v13 offset:1024
    v_mfma_f32_16x16x32_bf16 v[184:187], v[104:107], v[76:79], v[184:187]
    ds_read_b64_tr_b16 v[104:105], v14 offset:0
    ds_read_b64_tr_b16 v[106:107], v14 offset:1024
    v_mfma_f32_16x16x32_bf16 v[188:191], v[108:111], v[76:79], v[188:191]
    ds_read_b64_tr_b16 v[108:109], v15 offset:0
    ds_read_b64_tr_b16 v[110:111], v15 offset:1024
    v_mfma_f32_16x16x32_bf16 v[128:131], v[112:115], v[80:83], v[128:131]
    ds_read_b128 v[76:79], v10 offset:10240
    v_mfma_f32_16x16x32_bf16 v[132:135], v[116:119], v[80:83], v[132:135]
    v_mfma_f32_16x16x32_bf16 v[136:139], v[120:123], v[80:83], v[136:139]
    v_mfma_f32_16x16x32_bf16 v[140:143], v[124:127], v[80:83], v[140:143]
    ds_read_b128 v[80:83], v10 offset:1024
    v_mfma_f32_16x16x32_bf16 v[144:147], v[112:115], v[84:87], v[144:147]
    v_mfma_f32_16x16x32_bf16 v[148:151], v[116:119], v[84:87], v[148:151]
    v_mfma_f32_16x16x32_bf16 v[152:155], v[120:123], v[84:87], v[152:155]
    v_mfma_f32_16x16x32_bf16 v[156:159], v[124:127], v[84:87], v[156:159]
    ds_read_b128 v[84:87], v10 offset:3072
    v_mfma_f32_16x16x32_bf16 v[160:163], v[112:115], v[88:91], v[160:163]
    v_mfma_f32_16x16x32_bf16 v[164:167], v[116:119], v[88:91], v[164:167]
    v_mfma_f32_16x16x32_bf16 v[168:171], v[120:123], v[88:91], v[168:171]
    v_mfma_f32_16x16x32_bf16 v[172:175], v[124:127], v[88:91], v[172:175]
    ds_read_b128 v[88:91], v10 offset:9216
    v_mfma_f32_16x16x32_bf16 v[176:179], v[112:115], v[92:95], v[176:179]
    ds_read_b64_tr_b16 v[112:113], v12 offset:8192
    ds_read_b64_tr_b16 v[114:115], v12 offset:9216
    v_mfma_f32_16x16x32_bf16 v[180:183], v[116:119], v[92:95], v[180:183]
    ds_read_b64_tr_b16 v[116:117], v13 offset:8192
    ds_read_b64_tr_b16 v[118:119], v13 offset:9216
    v_mfma_f32_16x16x32_bf16 v[184:187], v[120:123], v[92:95], v[184:187]
    ds_read_b64_tr_b16 v[120:121], v14 offset:8192
    ds_read_b64_tr_b16 v[122:123], v14 offset:9216
    v_mfma_f32_16x16x32_bf16 v[188:191], v[124:127], v[92:95], v[188:191]
    ds_read_b64_tr_b16 v[124:125], v15 offset:8192
    ds_read_b64_tr_b16 v[126:127], v15 offset:9216
    s_waitcnt lgkmcnt(15)
    v_mfma_f32_16x16x32_bf16 v[128:131], v[96:99], v[64:67], v[128:131]
    ds_read_b128 v[92:95], v10 offset:11264
    v_mfma_f32_16x16x32_bf16 v[132:135], v[100:103], v[64:67], v[132:135]
    s_waitcnt lgkmcnt(15)
    v_mfma_f32_16x16x32_bf16 v[136:139], v[104:107], v[64:67], v[136:139]
    s_waitcnt lgkmcnt(13)
    v_mfma_f32_16x16x32_bf16 v[140:143], v[108:111], v[64:67], v[140:143]
    v_mfma_f32_16x16x32_bf16 v[144:147], v[96:99], v[68:71], v[144:147]
    v_mfma_f32_16x16x32_bf16 v[148:151], v[100:103], v[68:71], v[148:151]
    v_mfma_f32_16x16x32_bf16 v[152:155], v[104:107], v[68:71], v[152:155]
    v_mfma_f32_16x16x32_bf16 v[156:159], v[108:111], v[68:71], v[156:159]
    s_waitcnt lgkmcnt(0)
    s_barrier
    ds_read_b128 v[64:67], v10 offset:49152
    ds_read_b128 v[68:71], v10 offset:51200
    v_mfma_f32_16x16x32_bf16 v[160:163], v[96:99], v[72:75], v[160:163]
    v_mfma_f32_16x16x32_bf16 v[164:167], v[100:103], v[72:75], v[164:167]
    v_mfma_f32_16x16x32_bf16 v[168:171], v[104:107], v[72:75], v[168:171]
    v_mfma_f32_16x16x32_bf16 v[172:175], v[108:111], v[72:75], v[172:175]
    ds_read_b128 v[72:75], v10 offset:57344
    v_mfma_f32_16x16x32_bf16 v[176:179], v[96:99], v[76:79], v[176:179]
    ds_read_b64_tr_b16 v[96:97], v12 offset:16384
    ds_read_b64_tr_b16 v[98:99], v12 offset:17408
    v_mfma_f32_16x16x32_bf16 v[180:183], v[100:103], v[76:79], v[180:183]
    ds_read_b64_tr_b16 v[100:101], v13 offset:16384
    ds_read_b64_tr_b16 v[102:103], v13 offset:17408
    v_mfma_f32_16x16x32_bf16 v[184:187], v[104:107], v[76:79], v[184:187]
    ds_read_b64_tr_b16 v[104:105], v14 offset:16384
    ds_read_b64_tr_b16 v[106:107], v14 offset:17408
    v_mfma_f32_16x16x32_bf16 v[188:191], v[108:111], v[76:79], v[188:191]
    ds_read_b64_tr_b16 v[108:109], v15 offset:16384
    ds_read_b64_tr_b16 v[110:111], v15 offset:17408
    v_mfma_f32_16x16x32_bf16 v[128:131], v[112:115], v[80:83], v[128:131]
    ds_read_b128 v[76:79], v10 offset:59392
    v_mfma_f32_16x16x32_bf16 v[132:135], v[116:119], v[80:83], v[132:135]
    v_mfma_f32_16x16x32_bf16 v[136:139], v[120:123], v[80:83], v[136:139]
    v_mfma_f32_16x16x32_bf16 v[140:143], v[124:127], v[80:83], v[140:143]
    ds_read_b128 v[80:83], v10 offset:50176
    v_mfma_f32_16x16x32_bf16 v[144:147], v[112:115], v[84:87], v[144:147]
    v_mfma_f32_16x16x32_bf16 v[148:151], v[116:119], v[84:87], v[148:151]
    v_mfma_f32_16x16x32_bf16 v[152:155], v[120:123], v[84:87], v[152:155]
    v_mfma_f32_16x16x32_bf16 v[156:159], v[124:127], v[84:87], v[156:159]
    ds_read_b128 v[84:87], v10 offset:52224
    v_mfma_f32_16x16x32_bf16 v[160:163], v[112:115], v[88:91], v[160:163]
    v_mfma_f32_16x16x32_bf16 v[164:167], v[116:119], v[88:91], v[164:167]
    v_mfma_f32_16x16x32_bf16 v[168:171], v[120:123], v[88:91], v[168:171]
    v_mfma_f32_16x16x32_bf16 v[172:175], v[124:127], v[88:91], v[172:175]
    ds_read_b128 v[88:91], v10 offset:58368
    v_mfma_f32_16x16x32_bf16 v[176:179], v[112:115], v[92:95], v[176:179]
    ds_read_b64_tr_b16 v[112:113], v12 offset:24576
    ds_read_b64_tr_b16 v[114:115], v12 offset:25600
    v_mfma_f32_16x16x32_bf16 v[180:183], v[116:119], v[92:95], v[180:183]
    ds_read_b64_tr_b16 v[116:117], v13 offset:24576
    ds_read_b64_tr_b16 v[118:119], v13 offset:25600
    v_mfma_f32_16x16x32_bf16 v[184:187], v[120:123], v[92:95], v[184:187]
    ds_read_b64_tr_b16 v[120:121], v14 offset:24576
    ds_read_b64_tr_b16 v[122:123], v14 offset:25600
    v_mfma_f32_16x16x32_bf16 v[188:191], v[124:127], v[92:95], v[188:191]
    ds_read_b64_tr_b16 v[124:125], v15 offset:24576
    ds_read_b64_tr_b16 v[126:127], v15 offset:25600
    s_waitcnt lgkmcnt(15)
    v_mfma_f32_16x16x32_bf16 v[160:163], v[96:99], v[72:75], v[160:163]
    ds_read_b128 v[92:95], v10 offset:60416
    v_mfma_f32_16x16x32_bf16 v[164:167], v[100:103], v[72:75], v[164:167]
    s_waitcnt lgkmcnt(15)
    v_mfma_f32_16x16x32_bf16 v[168:171], v[104:107], v[72:75], v[168:171]
    s_waitcnt lgkmcnt(13)
    v_mfma_f32_16x16x32_bf16 v[172:175], v[108:111], v[72:75], v[172:175]
    s_waitcnt lgkmcnt(12)
    v_mfma_f32_16x16x32_bf16 v[176:179], v[96:99], v[76:79], v[176:179]
    v_mfma_f32_16x16x32_bf16 v[180:183], v[100:103], v[76:79], v[180:183]
    v_mfma_f32_16x16x32_bf16 v[184:187], v[104:107], v[76:79], v[184:187]
    v_mfma_f32_16x16x32_bf16 v[188:191], v[108:111], v[76:79], v[188:191]
    s_waitcnt lgkmcnt(0)
    s_barrier
    v_mfma_f32_16x16x32_bf16 v[160:163], v[112:115], v[88:91], v[160:163]
    v_mfma_f32_16x16x32_bf16 v[164:167], v[116:119], v[88:91], v[164:167]
    v_mfma_f32_16x16x32_bf16 v[168:171], v[120:123], v[88:91], v[168:171]
    v_mfma_f32_16x16x32_bf16 v[172:175], v[124:127], v[88:91], v[172:175]
    v_mfma_f32_16x16x32_bf16 v[176:179], v[112:115], v[92:95], v[176:179]
    v_mfma_f32_16x16x32_bf16 v[180:183], v[116:119], v[92:95], v[180:183]
    v_mfma_f32_16x16x32_bf16 v[184:187], v[120:123], v[92:95], v[184:187]
    s_nop 1
    v_cvt_pk_bf16_f32 v160, v160, v161
    v_cvt_pk_bf16_f32 v161, v162, v163
    v_mfma_f32_16x16x32_bf16 v[188:191], v[124:127], v[92:95], v[188:191]
    v_cvt_pk_bf16_f32 v162, v164, v165
    v_cvt_pk_bf16_f32 v163, v166, v167
    v_mfma_f32_16x16x32_bf16 v[136:139], v[104:107], v[64:67], v[136:139]
    buffer_store_dwordx4 v[160:163], v20, s[24:27], s51 offen offset:0 sc1
    v_cvt_pk_bf16_f32 v168, v168, v169
    v_mfma_f32_16x16x32_bf16 v[140:143], v[108:111], v[64:67], v[140:143]
    v_cvt_pk_bf16_f32 v169, v170, v171
    v_cvt_pk_bf16_f32 v170, v172, v173
    v_mfma_f32_16x16x32_bf16 v[152:155], v[104:107], v[68:71], v[152:155]
    v_cvt_pk_bf16_f32 v171, v174, v175
    buffer_store_dwordx4 v[168:171], v20, s[24:27], s52 offen offset:0 sc1
    v_mfma_f32_16x16x32_bf16 v[156:159], v[108:111], v[68:71], v[156:159]
    v_cvt_pk_bf16_f32 v176, v176, v177
    v_cvt_pk_bf16_f32 v177, v178, v179
    v_mfma_f32_16x16x32_bf16 v[136:139], v[120:123], v[80:83], v[136:139]
    v_cvt_pk_bf16_f32 v178, v180, v181
    v_cvt_pk_bf16_f32 v179, v182, v183
    v_mfma_f32_16x16x32_bf16 v[140:143], v[124:127], v[80:83], v[140:143]
    buffer_store_dwordx4 v[176:179], v20, s[24:27], s51 offen offset:1024 sc1
    v_cvt_pk_bf16_f32 v184, v184, v185
    v_mfma_f32_16x16x32_bf16 v[152:155], v[120:123], v[84:87], v[152:155]
    v_cvt_pk_bf16_f32 v185, v186, v187
    v_cvt_pk_bf16_f32 v186, v188, v189
    v_mfma_f32_16x16x32_bf16 v[156:159], v[124:127], v[84:87], v[156:159]
    v_cvt_pk_bf16_f32 v187, v190, v191
    buffer_store_dwordx4 v[184:187], v20, s[24:27], s52 offen offset:1024 sc1
    v_mfma_f32_16x16x32_bf16 v[128:131], v[96:99], v[64:67], v[128:131]
    v_cvt_pk_bf16_f32 v136, v136, v137
    v_cvt_pk_bf16_f32 v137, v138, v139
    v_mfma_f32_16x16x32_bf16 v[132:135], v[100:103], v[64:67], v[132:135]
    v_subrev_u32 v10, 65536, v10
    ds_read_b128 v[64:67], v10 offset:16384
    v_mfma_f32_16x16x32_bf16 v[144:147], v[96:99], v[68:71], v[144:147]
    v_subrev_u32 v12, 81920, v12
    v_subrev_u32 v13, 81920, v13
    v_subrev_u32 v14, 81920, v14
    v_subrev_u32 v15, 81920, v15
    ds_read_b64_tr_b16 v[96:97], v12 offset:0
    v_mfma_f32_16x16x32_bf16 v[148:151], v[100:103], v[68:71], v[148:151]
    ds_read_b64_tr_b16 v[98:99], v12 offset:1024
    ds_read_b64_tr_b16 v[100:101], v13 offset:0
    v_mfma_f32_16x16x32_bf16 v[128:131], v[112:115], v[80:83], v[128:131]
    ds_read_b64_tr_b16 v[102:103], v13 offset:1024
    ds_read_b64_tr_b16 v[104:105], v14 offset:0
    v_mfma_f32_16x16x32_bf16 v[132:135], v[116:119], v[80:83], v[132:135]
    ds_read_b64_tr_b16 v[106:107], v14 offset:1024
    ds_read_b64_tr_b16 v[108:109], v15 offset:0
    v_mfma_f32_16x16x32_bf16 v[144:147], v[112:115], v[84:87], v[144:147]
    ds_read_b64_tr_b16 v[110:111], v15 offset:1024
    ds_read_b128 v[68:71], v10 offset:18432
    v_mfma_f32_16x16x32_bf16 v[148:151], v[116:119], v[84:87], v[148:151]
    ds_read_b128 v[72:75], v10 offset:24576
    ds_read_b128 v[76:79], v10 offset:26624
    s_waitcnt lgkmcnt(9)
    v_mfma_f32_16x16x32_bf16 v[192:195], v[96:99], v[64:67], v[192:195]
    ds_read_b64_tr_b16 v[112:113], v12 offset:8192
    ds_read_b64_tr_b16 v[114:115], v12 offset:9216
    s_waitcnt lgkmcnt(9)
    v_mfma_f32_16x16x32_bf16 v[196:199], v[100:103], v[64:67], v[196:199]
    ds_read_b128 v[80:83], v10 offset:17408
    ds_read_b64_tr_b16 v[116:117], v13 offset:8192
    s_waitcnt lgkmcnt(9)
    v_mfma_f32_16x16x32_bf16 v[200:203], v[104:107], v[64:67], v[200:203]
    ds_read_b64_tr_b16 v[118:119], v13 offset:9216
    ds_read_b64_tr_b16 v[120:121], v14 offset:8192
    s_waitcnt lgkmcnt(9)
    v_mfma_f32_16x16x32_bf16 v[204:207], v[108:111], v[64:67], v[204:207]
    ds_read_b64_tr_b16 v[122:123], v14 offset:9216
    ds_read_b64_tr_b16 v[124:125], v15 offset:8192
    s_waitcnt lgkmcnt(10)
    v_mfma_f32_16x16x32_bf16 v[208:211], v[96:99], v[68:71], v[208:211]
    ds_read_b64_tr_b16 v[126:127], v15 offset:9216
    ds_read_b128 v[84:87], v10 offset:19456
    v_mfma_f32_16x16x32_bf16 v[212:215], v[100:103], v[68:71], v[212:215]
    ds_read_b128 v[88:91], v10 offset:25600
    ds_read_b128 v[92:95], v10 offset:27648
    v_mfma_f32_16x16x32_bf16 v[216:219], v[104:107], v[68:71], v[216:219]
    v_cvt_pk_bf16_f32 v138, v140, v141
    v_cvt_pk_bf16_f32 v139, v142, v143
    v_mfma_f32_16x16x32_bf16 v[220:223], v[108:111], v[68:71], v[220:223]
    s_waitcnt lgkmcnt(0)
    s_barrier
    ds_read_b128 v[64:67], v10 offset:49152
    ds_read_b128 v[68:71], v10 offset:51200
    v_mfma_f32_16x16x32_bf16 v[224:227], v[96:99], v[72:75], v[224:227]
    buffer_store_dwordx4 v[136:139], v20, s[24:27], s50 offen offset:0 sc1
    v_cvt_pk_bf16_f32 v152, v152, v153
    v_mfma_f32_16x16x32_bf16 v[228:231], v[100:103], v[72:75], v[228:231]
    v_cvt_pk_bf16_f32 v153, v154, v155
    v_cvt_pk_bf16_f32 v154, v156, v157
    v_mfma_f32_16x16x32_bf16 v[232:235], v[104:107], v[72:75], v[232:235]
    v_cvt_pk_bf16_f32 v155, v158, v159
    buffer_store_dwordx4 v[152:155], v20, s[24:27], s50 offen offset:1024 sc1
    v_mfma_f32_16x16x32_bf16 v[236:239], v[108:111], v[72:75], v[236:239]
    ds_read_b128 v[72:75], v10 offset:57344
    v_mfma_f32_16x16x32_bf16 v[240:243], v[96:99], v[76:79], v[240:243]
    v_add_u32 v12, 81920, v12
    v_add_u32 v13, 81920, v13
    v_add_u32 v14, 81920, v14
    v_add_u32 v15, 81920, v15
    ds_read_b64_tr_b16 v[96:97], v12 offset:49152
    v_mfma_f32_16x16x32_bf16 v[244:247], v[100:103], v[76:79], v[244:247]
    ds_read_b64_tr_b16 v[98:99], v12 offset:50176
    ds_read_b64_tr_b16 v[100:101], v13 offset:49152
    v_mfma_f32_16x16x32_bf16 v[248:251], v[104:107], v[76:79], v[248:251]
    ds_read_b64_tr_b16 v[102:103], v13 offset:50176
    ds_read_b64_tr_b16 v[104:105], v14 offset:49152
    v_mfma_f32_16x16x32_bf16 v[252:255], v[108:111], v[76:79], v[252:255]
    ds_read_b64_tr_b16 v[106:107], v14 offset:50176
    ds_read_b64_tr_b16 v[108:109], v15 offset:49152
    v_mfma_f32_16x16x32_bf16 v[192:195], v[112:115], v[80:83], v[192:195]
    ds_read_b64_tr_b16 v[110:111], v15 offset:50176
    ds_read_b128 v[76:79], v10 offset:59392
    v_mfma_f32_16x16x32_bf16 v[196:199], v[116:119], v[80:83], v[196:199]
    v_mfma_f32_16x16x32_bf16 v[200:203], v[120:123], v[80:83], v[200:203]
    v_mfma_f32_16x16x32_bf16 v[204:207], v[124:127], v[80:83], v[204:207]
    ds_read_b128 v[80:83], v10 offset:50176
    v_mfma_f32_16x16x32_bf16 v[208:211], v[112:115], v[84:87], v[208:211]
    v_mfma_f32_16x16x32_bf16 v[212:215], v[116:119], v[84:87], v[212:215]
    v_mfma_f32_16x16x32_bf16 v[216:219], v[120:123], v[84:87], v[216:219]
    v_mfma_f32_16x16x32_bf16 v[220:223], v[124:127], v[84:87], v[220:223]
    ds_read_b128 v[84:87], v10 offset:52224
    v_mfma_f32_16x16x32_bf16 v[224:227], v[112:115], v[88:91], v[224:227]
    v_mfma_f32_16x16x32_bf16 v[228:231], v[116:119], v[88:91], v[228:231]
    v_mfma_f32_16x16x32_bf16 v[232:235], v[120:123], v[88:91], v[232:235]
    v_mfma_f32_16x16x32_bf16 v[236:239], v[124:127], v[88:91], v[236:239]
    ds_read_b128 v[88:91], v10 offset:58368
    v_mfma_f32_16x16x32_bf16 v[240:243], v[112:115], v[92:95], v[240:243]
    ds_read_b64_tr_b16 v[112:113], v12 offset:57344
    ds_read_b64_tr_b16 v[114:115], v12 offset:58368
    v_mfma_f32_16x16x32_bf16 v[244:247], v[116:119], v[92:95], v[244:247]
    ds_read_b64_tr_b16 v[116:117], v13 offset:57344
    ds_read_b64_tr_b16 v[118:119], v13 offset:58368
    v_mfma_f32_16x16x32_bf16 v[248:251], v[120:123], v[92:95], v[248:251]
    ds_read_b64_tr_b16 v[120:121], v14 offset:57344
    ds_read_b64_tr_b16 v[122:123], v14 offset:58368
    v_mfma_f32_16x16x32_bf16 v[252:255], v[124:127], v[92:95], v[252:255]
    ds_read_b64_tr_b16 v[124:125], v15 offset:57344
    ds_read_b64_tr_b16 v[126:127], v15 offset:58368
    s_waitcnt lgkmcnt(15)
    v_mfma_f32_16x16x32_bf16 v[192:195], v[96:99], v[64:67], v[192:195]
    ds_read_b128 v[92:95], v10 offset:60416
    v_mfma_f32_16x16x32_bf16 v[196:199], v[100:103], v[64:67], v[196:199]
    s_waitcnt lgkmcnt(15)
    v_mfma_f32_16x16x32_bf16 v[200:203], v[104:107], v[64:67], v[200:203]
    s_waitcnt lgkmcnt(13)
    v_mfma_f32_16x16x32_bf16 v[204:207], v[108:111], v[64:67], v[204:207]
    v_mfma_f32_16x16x32_bf16 v[208:211], v[96:99], v[68:71], v[208:211]
    v_mfma_f32_16x16x32_bf16 v[212:215], v[100:103], v[68:71], v[212:215]
    v_mfma_f32_16x16x32_bf16 v[216:219], v[104:107], v[68:71], v[216:219]
    v_mfma_f32_16x16x32_bf16 v[220:223], v[108:111], v[68:71], v[220:223]
    s_waitcnt lgkmcnt(0)
    s_barrier
    ds_read_b128 v[64:67], v10 offset:32768
    ds_read_b128 v[68:71], v10 offset:34816
    v_mfma_f32_16x16x32_bf16 v[224:227], v[96:99], v[72:75], v[224:227]
    v_mfma_f32_16x16x32_bf16 v[228:231], v[100:103], v[72:75], v[228:231]
    v_mfma_f32_16x16x32_bf16 v[232:235], v[104:107], v[72:75], v[232:235]
    v_mfma_f32_16x16x32_bf16 v[236:239], v[108:111], v[72:75], v[236:239]
    ds_read_b128 v[72:75], v10 offset:40960
    v_mfma_f32_16x16x32_bf16 v[240:243], v[96:99], v[76:79], v[240:243]
    ds_read_b64_tr_b16 v[96:97], v12 offset:0
    ds_read_b64_tr_b16 v[98:99], v12 offset:1024
    v_mfma_f32_16x16x32_bf16 v[244:247], v[100:103], v[76:79], v[244:247]
    ds_read_b64_tr_b16 v[100:101], v13 offset:0
    ds_read_b64_tr_b16 v[102:103], v13 offset:1024
    v_mfma_f32_16x16x32_bf16 v[248:251], v[104:107], v[76:79], v[248:251]
    ds_read_b64_tr_b16 v[104:105], v14 offset:0
    ds_read_b64_tr_b16 v[106:107], v14 offset:1024
    v_mfma_f32_16x16x32_bf16 v[252:255], v[108:111], v[76:79], v[252:255]
    ds_read_b64_tr_b16 v[108:109], v15 offset:0
    ds_read_b64_tr_b16 v[110:111], v15 offset:1024
    v_mfma_f32_16x16x32_bf16 v[192:195], v[112:115], v[80:83], v[192:195]
    ds_read_b128 v[76:79], v10 offset:43008
    v_mfma_f32_16x16x32_bf16 v[196:199], v[116:119], v[80:83], v[196:199]
    v_mfma_f32_16x16x32_bf16 v[200:203], v[120:123], v[80:83], v[200:203]
    v_mfma_f32_16x16x32_bf16 v[204:207], v[124:127], v[80:83], v[204:207]
    ds_read_b128 v[80:83], v10 offset:33792
    v_mfma_f32_16x16x32_bf16 v[208:211], v[112:115], v[84:87], v[208:211]
    v_mfma_f32_16x16x32_bf16 v[212:215], v[116:119], v[84:87], v[212:215]
    v_mfma_f32_16x16x32_bf16 v[216:219], v[120:123], v[84:87], v[216:219]
    v_mfma_f32_16x16x32_bf16 v[220:223], v[124:127], v[84:87], v[220:223]
    ds_read_b128 v[84:87], v10 offset:35840
    v_mfma_f32_16x16x32_bf16 v[224:227], v[112:115], v[88:91], v[224:227]
    v_mfma_f32_16x16x32_bf16 v[228:231], v[116:119], v[88:91], v[228:231]
    v_mfma_f32_16x16x32_bf16 v[232:235], v[120:123], v[88:91], v[232:235]
    v_mfma_f32_16x16x32_bf16 v[236:239], v[124:127], v[88:91], v[236:239]
    ds_read_b128 v[88:91], v10 offset:41984
    v_mfma_f32_16x16x32_bf16 v[240:243], v[112:115], v[92:95], v[240:243]
    ds_read_b64_tr_b16 v[112:113], v12 offset:8192
    ds_read_b64_tr_b16 v[114:115], v12 offset:9216
    v_mfma_f32_16x16x32_bf16 v[244:247], v[116:119], v[92:95], v[244:247]
    ds_read_b64_tr_b16 v[116:117], v13 offset:8192
    ds_read_b64_tr_b16 v[118:119], v13 offset:9216
    v_mfma_f32_16x16x32_bf16 v[248:251], v[120:123], v[92:95], v[248:251]
    ds_read_b64_tr_b16 v[120:121], v14 offset:8192
    ds_read_b64_tr_b16 v[122:123], v14 offset:9216
    v_mfma_f32_16x16x32_bf16 v[252:255], v[124:127], v[92:95], v[252:255]
    ds_read_b64_tr_b16 v[124:125], v15 offset:8192
    ds_read_b64_tr_b16 v[126:127], v15 offset:9216
    s_waitcnt lgkmcnt(15)
    v_mfma_f32_16x16x32_bf16 v[192:195], v[96:99], v[64:67], v[192:195]
    ds_read_b128 v[92:95], v10 offset:44032
    v_mfma_f32_16x16x32_bf16 v[196:199], v[100:103], v[64:67], v[196:199]
    s_waitcnt lgkmcnt(15)
    v_mfma_f32_16x16x32_bf16 v[200:203], v[104:107], v[64:67], v[200:203]
    s_waitcnt lgkmcnt(13)
    v_mfma_f32_16x16x32_bf16 v[204:207], v[108:111], v[64:67], v[204:207]
    v_mfma_f32_16x16x32_bf16 v[208:211], v[96:99], v[68:71], v[208:211]
    v_mfma_f32_16x16x32_bf16 v[212:215], v[100:103], v[68:71], v[212:215]
    v_mfma_f32_16x16x32_bf16 v[216:219], v[104:107], v[68:71], v[216:219]
    v_mfma_f32_16x16x32_bf16 v[220:223], v[108:111], v[68:71], v[220:223]
    s_waitcnt lgkmcnt(0)
    s_barrier
    v_mfma_f32_16x16x32_bf16 v[224:227], v[96:99], v[72:75], v[224:227]
    v_mfma_f32_16x16x32_bf16 v[228:231], v[100:103], v[72:75], v[228:231]
    v_mfma_f32_16x16x32_bf16 v[232:235], v[104:107], v[72:75], v[232:235]
    v_mfma_f32_16x16x32_bf16 v[236:239], v[108:111], v[72:75], v[236:239]
    v_add_u32 v10, 65536, v10
    ds_read_b128 v[72:75], v10 offset:8192
    v_mfma_f32_16x16x32_bf16 v[240:243], v[96:99], v[76:79], v[240:243]
    ds_read_b64_tr_b16 v[96:97], v12 offset:16384
    ds_read_b64_tr_b16 v[98:99], v12 offset:17408
    v_mfma_f32_16x16x32_bf16 v[244:247], v[100:103], v[76:79], v[244:247]
    ds_read_b64_tr_b16 v[100:101], v13 offset:16384
    ds_read_b64_tr_b16 v[102:103], v13 offset:17408
    v_mfma_f32_16x16x32_bf16 v[248:251], v[104:107], v[76:79], v[248:251]
    ds_read_b64_tr_b16 v[104:105], v14 offset:16384
    ds_read_b64_tr_b16 v[106:107], v14 offset:17408
    v_mfma_f32_16x16x32_bf16 v[252:255], v[108:111], v[76:79], v[252:255]
    ds_read_b64_tr_b16 v[108:109], v15 offset:16384
    ds_read_b64_tr_b16 v[110:111], v15 offset:17408
    v_mfma_f32_16x16x32_bf16 v[192:195], v[112:115], v[80:83], v[192:195]
    ds_read_b128 v[76:79], v10 offset:10240
    ds_read_b128 v[64:67], v10 offset:0
    v_mfma_f32_16x16x32_bf16 v[196:199], v[116:119], v[80:83], v[196:199]
    ds_read_b128 v[68:71], v10 offset:2048
    v_mfma_f32_16x16x32_bf16 v[200:203], v[120:123], v[80:83], v[200:203]
    v_mfma_f32_16x16x32_bf16 v[204:207], v[124:127], v[80:83], v[204:207]
    ds_read_b128 v[80:83], v10 offset:1024
    v_mfma_f32_16x16x32_bf16 v[208:211], v[112:115], v[84:87], v[208:211]
    v_mfma_f32_16x16x32_bf16 v[212:215], v[116:119], v[84:87], v[212:215]
    v_mfma_f32_16x16x32_bf16 v[216:219], v[120:123], v[84:87], v[216:219]
    v_mfma_f32_16x16x32_bf16 v[220:223], v[124:127], v[84:87], v[220:223]
    ds_read_b128 v[84:87], v10 offset:3072
    v_mfma_f32_16x16x32_bf16 v[224:227], v[112:115], v[88:91], v[224:227]
    v_mfma_f32_16x16x32_bf16 v[228:231], v[116:119], v[88:91], v[228:231]
    v_mfma_f32_16x16x32_bf16 v[232:235], v[120:123], v[88:91], v[232:235]
    v_mfma_f32_16x16x32_bf16 v[236:239], v[124:127], v[88:91], v[236:239]
    ds_read_b128 v[88:91], v10 offset:9216
    v_mfma_f32_16x16x32_bf16 v[240:243], v[112:115], v[92:95], v[240:243]
    ds_read_b64_tr_b16 v[112:113], v12 offset:24576
    ds_read_b64_tr_b16 v[114:115], v12 offset:25600
    v_mfma_f32_16x16x32_bf16 v[244:247], v[116:119], v[92:95], v[244:247]
    ds_read_b64_tr_b16 v[116:117], v13 offset:24576
    ds_read_b64_tr_b16 v[118:119], v13 offset:25600
    v_mfma_f32_16x16x32_bf16 v[248:251], v[120:123], v[92:95], v[248:251]
    ds_read_b64_tr_b16 v[120:121], v14 offset:24576
    ds_read_b64_tr_b16 v[122:123], v14 offset:25600
    v_mfma_f32_16x16x32_bf16 v[252:255], v[124:127], v[92:95], v[252:255]
    ds_read_b64_tr_b16 v[124:125], v15 offset:24576
    ds_read_b64_tr_b16 v[126:127], v15 offset:25600
    s_waitcnt lgkmcnt(15)
    v_mfma_f32_16x16x32_bf16 v[224:227], v[96:99], v[72:75], v[224:227]
    ds_read_b128 v[92:95], v10 offset:11264
    v_mfma_f32_16x16x32_bf16 v[228:231], v[100:103], v[72:75], v[228:231]
    v_mfma_f32_16x16x32_bf16 v[232:235], v[104:107], v[72:75], v[232:235]
    buffer_load_dwordx4 v[136:139], v20, s[24:27], s55 offen offset:0 sc1
    buffer_load_dwordx4 v[140:143], v20, s[24:27], s56 offen offset:0 sc1
    buffer_load_dwordx4 v[152:155], v20, s[24:27], s57 offen offset:0 sc1
    s_waitcnt lgkmcnt(15)
    v_mfma_f32_16x16x32_bf16 v[236:239], v[108:111], v[72:75], v[236:239]
    buffer_load_dwordx4 v[156:159], v20, s[24:27], s55 offen offset:1024 sc1
    buffer_load_dwordx4 v[160:163], v20, s[24:27], s56 offen offset:1024 sc1
    buffer_load_dwordx4 v[164:167], v20, s[24:27], s57 offen offset:1024 sc1
    s_waitcnt lgkmcnt(14)
    v_mfma_f32_16x16x32_bf16 v[240:243], v[96:99], v[76:79], v[240:243]
    v_mfma_f32_16x16x32_bf16 v[244:247], v[100:103], v[76:79], v[244:247]
    v_mfma_f32_16x16x32_bf16 v[248:251], v[104:107], v[76:79], v[248:251]
    v_mfma_f32_16x16x32_bf16 v[252:255], v[108:111], v[76:79], v[252:255]
    s_waitcnt lgkmcnt(0)
    s_barrier
    v_mfma_f32_16x16x32_bf16 v[224:227], v[112:115], v[88:91], v[224:227]
    v_mfma_f32_16x16x32_bf16 v[228:231], v[116:119], v[88:91], v[228:231]
    v_mfma_f32_16x16x32_bf16 v[232:235], v[120:123], v[88:91], v[232:235]
    v_mfma_f32_16x16x32_bf16 v[236:239], v[124:127], v[88:91], v[236:239]
    v_mfma_f32_16x16x32_bf16 v[240:243], v[112:115], v[92:95], v[240:243]
    v_mfma_f32_16x16x32_bf16 v[244:247], v[116:119], v[92:95], v[244:247]
    v_mfma_f32_16x16x32_bf16 v[248:251], v[120:123], v[92:95], v[248:251]
    s_nop 1
    v_cvt_pk_bf16_f32 v224, v224, v225
    v_cvt_pk_bf16_f32 v225, v226, v227
    v_cvt_pk_bf16_f32 v226, v228, v229
    v_mfma_f32_16x16x32_bf16 v[252:255], v[124:127], v[92:95], v[252:255]
    v_cvt_pk_bf16_f32 v227, v230, v231
    buffer_store_dwordx4 v[224:227], v20, s[24:27], s51 offen offset:2048 sc1
    v_cvt_pk_bf16_f32 v232, v232, v233
    v_mfma_f32_16x16x32_bf16 v[200:203], v[104:107], v[64:67], v[200:203]
    v_cvt_pk_bf16_f32 v233, v234, v235
    v_cvt_pk_bf16_f32 v234, v236, v237
    v_cvt_pk_bf16_f32 v235, v238, v239
    v_mfma_f32_16x16x32_bf16 v[204:207], v[108:111], v[64:67], v[204:207]
    buffer_store_dwordx4 v[232:235], v20, s[24:27], s52 offen offset:2048 sc1
    v_mfma_f32_16x16x32_bf16 v[216:219], v[104:107], v[68:71], v[216:219]
    v_cvt_pk_bf16_f32 v240, v240, v241
    v_cvt_pk_bf16_f32 v241, v242, v243
    v_cvt_pk_bf16_f32 v242, v244, v245
    v_mfma_f32_16x16x32_bf16 v[220:223], v[108:111], v[68:71], v[220:223]
    v_cvt_pk_bf16_f32 v243, v246, v247
    buffer_store_dwordx4 v[240:243], v20, s[24:27], s51 offen offset:3072 sc1
    v_cvt_pk_bf16_f32 v248, v248, v249
    v_mfma_f32_16x16x32_bf16 v[200:203], v[120:123], v[80:83], v[200:203]
    v_cvt_pk_bf16_f32 v249, v250, v251
    v_cvt_pk_bf16_f32 v250, v252, v253
    v_cvt_pk_bf16_f32 v251, v254, v255
    v_mfma_f32_16x16x32_bf16 v[204:207], v[124:127], v[80:83], v[204:207]
    buffer_store_dwordx4 v[248:251], v20, s[24:27], s52 offen offset:3072 sc1
    v_mfma_f32_16x16x32_bf16 v[216:219], v[120:123], v[84:87], v[216:219]
    v_mfma_f32_16x16x32_bf16 v[220:223], v[124:127], v[84:87], v[220:223]
    v_mfma_f32_16x16x32_bf16 v[192:195], v[96:99], v[64:67], v[192:195]
    v_cvt_pk_bf16_f32 v200, v200, v201
    v_cvt_pk_bf16_f32 v201, v202, v203
    s_nop 1
    v_cvt_pk_bf16_f32 v202, v204, v205
    v_mfma_f32_16x16x32_bf16 v[196:199], v[100:103], v[64:67], v[196:199]
    v_cvt_pk_bf16_f32 v203, v206, v207
    buffer_store_dwordx4 v[200:203], v20, s[24:27], s50 offen offset:2048 sc1
    v_mfma_f32_16x16x32_bf16 v[208:211], v[96:99], v[68:71], v[208:211]
    v_cvt_pk_bf16_f32 v216, v216, v217
    v_cvt_pk_bf16_f32 v217, v218, v219
    v_cvt_pk_bf16_f32 v218, v220, v221
    v_mfma_f32_16x16x32_bf16 v[212:215], v[100:103], v[68:71], v[212:215]
    v_cvt_pk_bf16_f32 v219, v222, v223
    buffer_store_dwordx4 v[216:219], v20, s[24:27], s50 offen offset:3072 sc1
    v_mfma_f32_16x16x32_bf16 v[192:195], v[112:115], v[80:83], v[192:195]
    v_mfma_f32_16x16x32_bf16 v[196:199], v[116:119], v[80:83], v[196:199]
    v_mfma_f32_16x16x32_bf16 v[208:211], v[112:115], v[84:87], v[208:211]
    v_mfma_f32_16x16x32_bf16 v[212:215], v[116:119], v[84:87], v[212:215]
    s_mov_b32 s87, 0x40000
    s_waitcnt vmcnt(9)
L_rv_00:
    v_max3_u32 v2, v136, v137, v138
    v_max3_u32 v3, v139, v140, v141
    v_max3_u32 v2, v2, v142, v143
    v_max3_u32 v3, v3, v152, v153
    v_max3_u32 v2, v2, v154, v155
    v_max_u32 v2, v2, v3
    v_cmp_eq_u32 vcc, -1, v2
    s_nop 4
    s_cbranch_vccnz L_rr_00
L_rk_00:
    v_dot2c_f32_bf16 v128, s47, v136
    v_dot2c_f32_bf16 v129, s48, v136
    v_dot2c_f32_bf16 v130, s47, v137
    v_dot2c_f32_bf16 v131, s48, v137
    v_dot2c_f32_bf16 v132, s47, v138
    v_dot2c_f32_bf16 v133, s48, v138
    v_dot2c_f32_bf16 v134, s47, v139
    v_dot2c_f32_bf16 v135, s48, v139
    v_dot2c_f32_bf16 v128, s47, v140
    v_dot2c_f32_bf16 v129, s48, v140
    v_dot2c_f32_bf16 v130, s47, v141
    v_dot2c_f32_bf16 v131, s48, v141
    v_dot2c_f32_bf16 v132, s47, v142
    v_dot2c_f32_bf16 v133, s48, v142
    v_dot2c_f32_bf16 v134, s47, v143
    v_dot2c_f32_bf16 v135, s48, v143
    v_dot2c_f32_bf16 v128, s47, v152
    v_dot2c_f32_bf16 v129, s48, v152
    v_dot2c_f32_bf16 v130, s47, v153
    v_dot2c_f32_bf16 v131, s48, v153
    v_dot2c_f32_bf16 v132, s47, v154
    v_dot2c_f32_bf16 v133, s48, v154
    v_dot2c_f32_bf16 v134, s47, v155
    v_dot2c_f32_bf16 v135, s48, v155
    v_cvt_pk_bf16_f32 v128, v128, v129
    v_cvt_pk_bf16_f32 v129, v130, v131
    v_cvt_pk_bf16_f32 v130, v132, v133
    v_cvt_pk_bf16_f32 v131, v134, v135
    s_nop 0
    v_permlane16_swap_b32 v128, v130
    v_permlane16_swap_b32 v129, v131
    buffer_store_dwordx4 v[128:131], v24, s[72:75], 0 offen
    s_waitcnt vmcnt(7)
L_rv_01:
    v_max3_u32 v2, v156, v157, v158
    v_max3_u32 v3, v159, v160, v161
    v_max3_u32 v2, v2, v162, v163
    v_max3_u32 v3, v3, v164, v165
    v_max3_u32 v2, v2, v166, v167
    v_max_u32 v2, v2, v3
    v_cmp_eq_u32 vcc, -1, v2
    s_nop 4
    s_cbranch_vccnz L_rr_01
L_rk_01:
    v_dot2c_f32_bf16 v144, s47, v156
    v_dot2c_f32_bf16 v145, s48, v156
    v_dot2c_f32_bf16 v146, s47, v157
    v_dot2c_f32_bf16 v147, s48, v157
    v_dot2c_f32_bf16 v148, s47, v158
    v_dot2c_f32_bf16 v149, s48, v158
    v_dot2c_f32_bf16 v150, s47, v159
    v_dot2c_f32_bf16 v151, s48, v159
    v_dot2c_f32_bf16 v144, s47, v160
    v_dot2c_f32_bf16 v145, s48, v160
    v_dot2c_f32_bf16 v146, s47, v161
    v_dot2c_f32_bf16 v147, s48, v161
    v_dot2c_f32_bf16 v148, s47, v162
    v_dot2c_f32_bf16 v149, s48, v162
    v_dot2c_f32_bf16 v150, s47, v163
    v_dot2c_f32_bf16 v151, s48, v163
    v_dot2c_f32_bf16 v144, s47, v164
    v_dot2c_f32_bf16 v145, s48, v164
    v_dot2c_f32_bf16 v146, s47, v165
    v_dot2c_f32_bf16 v147, s48, v165
    v_dot2c_f32_bf16 v148, s47, v166
    v_dot2c_f32_bf16 v149, s48, v166
    v_dot2c_f32_bf16 v150, s47, v167
    v_dot2c_f32_bf16 v151, s48, v167
    v_cvt_pk_bf16_f32 v144, v144, v145
    v_cvt_pk_bf16_f32 v145, v146, v147
    v_cvt_pk_bf16_f32 v146, v148, v149
    v_cvt_pk_bf16_f32 v147, v150, v151
    s_nop 0
    v_permlane16_swap_b32 v144, v146
    v_permlane16_swap_b32 v145, v147
    buffer_store_dwordx4 v[144:147], v25, s[72:75], 0 offen
    buffer_load_dwordx4 v[168:171], v20, s[24:27], s55 offen offset:2048 sc1
    buffer_load_dwordx4 v[172:175], v20, s[24:27], s56 offen offset:2048 sc1
    buffer_load_dwordx4 v[176:179], v20, s[24:27], s57 offen offset:2048 sc1
    buffer_load_dwordx4 v[180:183], v20, s[24:27], s55 offen offset:3072 sc1
    buffer_load_dwordx4 v[184:187], v20, s[24:27], s56 offen offset:3072 sc1
    buffer_load_dwordx4 v[188:191], v20, s[24:27], s57 offen offset:3072 sc1
    s_waitcnt vmcnt(3)
L_rv_10:
    v_max3_u32 v2, v168, v169, v170
    v_max3_u32 v3, v171, v172, v173
    v_max3_u32 v2, v2, v174, v175
    v_max3_u32 v3, v3, v176, v177
    v_max3_u32 v2, v2, v178, v179
    v_max_u32 v2, v2, v3
    v_cmp_eq_u32 vcc, -1, v2
    s_nop 4
    s_cbranch_vccnz L_rr_10
L_rk_10:
    v_dot2c_f32_bf16 v192, s47, v168
    v_dot2c_f32_bf16 v193, s48, v168
    v_dot2c_f32_bf16 v194, s47, v169
    v_dot2c_f32_bf16 v195, s48, v169
    v_dot2c_f32_bf16 v196, s47, v170
    v_dot2c_f32_bf16 v197, s48, v170
    v_dot2c_f32_bf16 v198, s47, v171
    v_dot2c_f32_bf16 v199, s48, v171
    v_dot2c_f32_bf16 v192, s47, v172
    v_dot2c_f32_bf16 v193, s48, v172
    v_dot2c_f32_bf16 v194, s47, v173
    v_dot2c_f32_bf16 v195, s48, v173
    v_dot2c_f32_bf16 v196, s47, v174
    v_dot2c_f32_bf16 v197, s48, v174
    v_dot2c_f32_bf16 v198, s47, v175
    v_dot2c_f32_bf16 v199, s48, v175
    v_dot2c_f32_bf16 v192, s47, v176
    v_dot2c_f32_bf16 v193, s48, v176
    v_dot2c_f32_bf16 v194, s47, v177
    v_dot2c_f32_bf16 v195, s48, v177
    v_dot2c_f32_bf16 v196, s47, v178
    v_dot2c_f32_bf16 v197, s48, v178
    v_dot2c_f32_bf16 v198, s47, v179
    v_dot2c_f32_bf16 v199, s48, v179
    v_cvt_pk_bf16_f32 v192, v192, v193
    v_cvt_pk_bf16_f32 v193, v194, v195
    v_cvt_pk_bf16_f32 v194, v196, v197
    v_cvt_pk_bf16_f32 v195, v198, v199
    s_nop 0
    v_permlane16_swap_b32 v192, v194
    v_permlane16_swap_b32 v193, v195
    buffer_store_dwordx4 v[192:195], v26, s[72:75], 0 offen
    s_waitcnt vmcnt(1)
L_rv_11:
    v_max3_u32 v2, v180, v181, v182
    v_max3_u32 v3, v183, v184, v185
    v_max3_u32 v2, v2, v186, v187
    v_max3_u32 v3, v3, v188, v189
    v_max3_u32 v2, v2, v190, v191
    v_max_u32 v2, v2, v3
    v_cmp_eq_u32 vcc, -1, v2
    s_nop 4
    s_cbranch_vccnz L_rr_11
L_rk_11:
    v_dot2c_f32_bf16 v208, s47, v180
    v_dot2c_f32_bf16 v209, s48, v180
    v_dot2c_f32_bf16 v210, s47, v181
    v_dot2c_f32_bf16 v211, s48, v181
    v_dot2c_f32_bf16 v212, s47, v182
    v_dot2c_f32_bf16 v213, s48, v182
    v_dot2c_f32_bf16 v214, s47, v183
    v_dot2c_f32_bf16 v215, s48, v183
    v_dot2c_f32_bf16 v208, s47, v184
    v_dot2c_f32_bf16 v209, s48, v184
    v_dot2c_f32_bf16 v210, s47, v185
    v_dot2c_f32_bf16 v211, s48, v185
    v_dot2c_f32_bf16 v212, s47, v186
    v_dot2c_f32_bf16 v213, s48, v186
    v_dot2c_f32_bf16 v214, s47, v187
    v_dot2c_f32_bf16 v215, s48, v187
    v_dot2c_f32_bf16 v208, s47, v188
    v_dot2c_f32_bf16 v209, s48, v188
    v_dot2c_f32_bf16 v210, s47, v189
    v_dot2c_f32_bf16 v211, s48, v189
    v_dot2c_f32_bf16 v212, s47, v190
    v_dot2c_f32_bf16 v213, s48, v190
    v_dot2c_f32_bf16 v214, s47, v191
    v_dot2c_f32_bf16 v215, s48, v191
    v_cvt_pk_bf16_f32 v208, v208, v209
    v_cvt_pk_bf16_f32 v209, v210, v211
    v_cvt_pk_bf16_f32 v210, v212, v213
    v_cvt_pk_bf16_f32 v211, v214, v215
    s_nop 0
    v_permlane16_swap_b32 v208, v210
    v_permlane16_swap_b32 v209, v211
    buffer_store_dwordx4 v[208:211], v27, s[72:75], 0 offen
    s_branch L_fin
L_prod:
    s_sub_u32 s40, s32, 4
    s_lshl_b32 s48, s40, 12
    v_lshrrev_b32 v3, 4, v1
    v_and_b32 v2, 15, v1
    v_lshlrev_b32 v4, 1, v3
    v_xor_b32 v2, v2, v4
    v_lshlrev_b32 v2, 4, v2
    s_mul_i32 s38, s33, 7
    s_add_u32 s38, s38, s36
    s_lshl_b32 s38, s38, 8
    s_mul_i32 s39, s40, 114688
    s_add_u32 s38, s38, s39
    s_sub_u32 s38, s38, 256
    v_mul_u32_u24 v4, 7168, v3
    v_add3_u32 v16, v4, v2, s38
    v_add_u32 v17, 27648, v16
    v_xor_b32 v4, 128, v16
    v_add_u32 v18, 55296, v4
    v_add_u32 v19, 82944, v4
    s_mul_i32 s43, s33, 0
    s_mul_i32 s38, s34, 0
    s_add_u32 s43, s43, s38
    s_and_b32 s43, s43, 2047
    s_mov_b32 s41, s43
    s_mov_b32 s42, s43
    s_add_u32 m0, s48, 0
    s_mul_i32 s44, s43, 3584
    buffer_load_dwordx4 v16, s[20:23], s44 offen offset:0 lds
    buffer_load_dwordx4 v17, s[20:23], s44 offen offset:1024 lds
    buffer_load_dwordx4 v18, s[20:23], s44 offen offset:2048 lds
    buffer_load_dwordx4 v19, s[20:23], s44 offen offset:3072 lds
    s_add_u32 s43, s43, 128
    s_and_b32 s43, s43, 2047
    v_lshrrev_b32 v4, 3, v1
    s_lshl_b32 s38, s40, 5
    v_add_u32 v4, s38, v4
    s_lshr_b32 s38, s33, 1
    s_lshl_b32 s38, s38, 6
    v_xor_b32 v4, s38, v4
    s_lshl_b32 s38, s35, 8
    s_add_u32 s38, s38, s34
    v_lshl_add_u32 v4, v4, 1, s38
    v_and_b32 v5, 7, v1
    v_lshrrev_b32 v6, 4, v1
    v_xor_b32 v5, v5, v6
    v_lshlrev_b32 v5, 4, v5
    v_lshl_add_u32 v8, v4, 11, v5
    v_xor_b32 v6, 64, v8
    v_add_u32 v9, 31744, v6
    v_add_u32 v10, 63488, v8
    v_add_u32 v11, 95232, v6
    s_add_u32 m0, s48, 16384
    s_nop 0
    buffer_load_dwordx4 v8, s[16:19], s41 offen offset:0 lds
    buffer_load_dwordx4 v9, s[16:19], s41 offen offset:1024 lds
    buffer_load_dwordx4 v10, s[16:19], s41 offen offset:2048 lds
    buffer_load_dwordx4 v11, s[16:19], s41 offen offset:3072 lds
    s_add_u32 s41, s41, 128
    s_and_b32 s41, s41, 2047
    v_sub_u32 v58, 2048, v4
    v_mov_b32 v6, 1024
    v_cmp_eq_u32 vcc, 0, v4
    s_nop 1
    v_cndmask_b32 v58, v58, v6, vcc
    v_lshl_add_u32 v12, v58, 11, v5
    v_sub_u32 v4, 2048, v4
    v_lshl_add_u32 v4, v4, 11, v5
    v_xor_b32 v6, 64, v4
    v_subrev_u32 v13, 33792, v6
    v_subrev_u32 v14, 67584, v4
    v_subrev_u32 v15, 101376, v6
    s_add_u32 m0, s48, 32768
    s_nop 0
    buffer_load_dwordx4 v12, s[16:19], s42 offen offset:0 lds
    buffer_load_dwordx4 v13, s[16:19], s42 offen offset:1024 lds
    buffer_load_dwordx4 v14, s[16:19], s42 offen offset:2048 lds
    buffer_load_dwordx4 v15, s[16:19], s42 offen offset:3072 lds
    s_add_u32 s42, s42, 128
    s_and_b32 s42, s42, 2047
    v_and_b32 v49, 31, v1
    v_lshlrev_b32 v49, 2, v49
    s_lshr_b32 s38, s40, 1
    s_lshl_b32 s38, s38, 5
    s_and_b32 s39, s40, 1
    s_lshl3_add_u32 s38, s39, s38
    v_lshrrev_b32 v4, 3, v1
    v_add_u32 v4, s38, v4
    v_and_b32 v5, 1, v1
    v_lshl_add_u32 v4, v5, 4, v4
    v_bfe_u32 v5, v1, 1, 1
    v_lshl_add_u32 v4, v5, 6, v4
    s_lshr_b32 s38, s33, 1
    s_lshl_b32 s38, s38, 6
    v_xor_b32 v4, s38, v4
    s_lshl_b32 s38, s35, 8
    s_add_u32 s38, s38, s34
    v_lshl_add_u32 v4, v4, 1, s38
    v_sub_u32 v5, 2048, v4
    v_mov_b32 v6, 1024
    v_cmp_eq_u32 vcc, 0, v4
    s_nop 1
    v_cndmask_b32 v5, v5, v6, vcc
    v_and_b32 v6, 4, v1
    v_cmp_ne_u32 vcc, 0, v6
    s_nop 1
    v_cndmask_b32 v4, v4, v5, vcc
    v_lshlrev_b32 v51, 3, v4
    s_lshl_b32 s51, s37, 7
    s_lshl_b32 s38, s36, 2
    s_add_u32 s51, s51, s38
    s_add_u32 s51, s51, 21037056
    v_add_u32 v4, s40, v1
    v_min_u32 v4, 1, v4
    v_lshlrev_b32 v56, 30, v4
    v_mov_b32 v57, 1
    v_lshrrev_b32 v3, 4, v1
    v_and_b32 v2, 15, v1
    v_lshlrev_b32 v4, 1, v3
    v_xor_b32 v2, v2, v4
    v_lshlrev_b32 v2, 4, v2
    s_lshl_b32 s38, s3, 7
    v_xor_b32 v2, s38, v2
    s_mul_i32 s38, s33, 896
    s_lshr_b32 s39, s40, 1
    s_lshl_b32 s39, s39, 5
    s_add_u32 s38, s38, s39
    s_and_b32 s39, s40, 1
    s_lshl_b32 s39, s39, 3
    s_add_u32 s38, s38, s39
    s_lshl_b32 s38, s38, 11
    s_lshl_b32 s39, s36, 8
    s_add_u32 s38, s38, s39
    v_lshl_add_u32 v4, v3, 11, v2
    v_add_u32 v20, s38, v4
    v_add_u32 v21, 31744, v20
    v_xor_b32 v4, 128, v20
    v_add_u32 v22, 6144, v4
    v_add_u32 v23, 37888, v4
    s_lshl_b32 s38, s34, 2
    s_add_u32 s38, s38, s35
    s_mul_i32 s38, s38, 112
    s_mul_i32 s39, s33, 14
    s_add_u32 s38, s38, s39
    s_lshl_b32 s38, s38, 14
    v_lshl_add_u32 v30, v1, 4, s48
    v_add_u32 v31, 49152, v30
    v_add_u32 v32, 98304, v30
    v_add_u32 v28, s38, v30
    v_add_u32 v29, 917504, v28
    s_max_u32 s38, s36, 1
    s_sub_u32 s38, s38, 1
    s_lshl_b32 s45, s38, 15
    s_mov_b32 s47, s45
    s_mov_b32 s57, 0
    s_mov_b32 s46, s45
    s_lshl_b32 s56, s37, 7
    s_add_u32 s56, s56, 21037056
    v_and_b32 v35, 15, v1
    v_lshlrev_b32 v35, 2, v35
    s_mul_i32 s54, s35, 0
    s_add_u32 s54, s54, s33
    s_and_b32 s54, s54, 3
    s_lshl_b32 s38, s54, 3
    s_and_b32 s39, s36, 0
    s_lshl1_add_u32 s54, s54, s39
    s_lshl_b32 s54, s54, 7
    v_add_u32 v36, s38, v1
    v_cmp_gt_u32 vcc, 8, v1
    s_nop 1
    v_cndmask_b32 v36, 0, v36, vcc
    v_lshlrev_b32 v36, 7, v36
    v_add_u32 v36, 21037056, v36
    s_lshl_b32 s38, s40, 5
    v_lshrrev_b32 v4, 3, v1
    v_add_u32 v4, s38, v4
    s_lshr_b32 s38, s33, 1
    s_lshl_b32 s38, s38, 6
    v_xor_b32 v4, s38, v4
    s_lshl_b32 s38, s35, 8
    s_add_u32 s38, s38, s34
    v_lshl_add_u32 v4, v4, 1, s38
    v_and_b32 v5, 7, v1
    v_lshrrev_b32 v6, 4, v1
    v_xor_b32 v5, v5, v6
    v_lshlrev_b32 v5, 4, v5
    v_lshl_add_u32 v24, v4, 12, v5
    v_xor_b32 v6, 64, v24
    v_add_u32 v25, 64512, v6
    v_add_u32 v26, 129024, v24
    v_add_u32 v27, 193536, v6
    v_sub_u32 v58, 2048, v4
    v_mov_b32 v6, 1024
    v_cmp_eq_u32 vcc, 0, v4
    s_nop 1
    v_cndmask_b32 v58, v58, v6, vcc
    v_lshl_add_u32 v84, v58, 12, v5
    v_sub_u32 v4, 2048, v4
    v_lshl_add_u32 v4, v4, 12, v5
    v_xor_b32 v6, 64, v4
    v_subrev_u32 v85, 66560, v6
    v_subrev_u32 v86, 133120, v4
    v_subrev_u32 v87, 199680, v6
    s_cmp_ge_u32 s36, 4
    s_cselect_b64 vcc, -1, 0
    v_cndmask_b32 v84, v84, v24, vcc
    v_cndmask_b32 v85, v85, v25, vcc
    v_cndmask_b32 v86, v86, v26, vcc
    v_cndmask_b32 v87, v87, v27, vcc
    s_lshl_b32 s38, s40, 5
    s_lshl_b32 s84, s3, 6
    s_xor_b32 s38, s38, s84
    s_lshl_b32 s39, s36, 7
    s_add_u32 s39, s38, s39
    s_mov_b32 s38, 0
    s_mul_i32 s84, s34, 608256
    s_add_u32 s38, s38, s84
    s_add_u32 s38, s38, 16777216
    s_mov_b32 s85, 304128
    v_lshrrev_b32 v3, 4, v1
    v_lshl_add_u32 v3, v3, 9, s38
    v_and_b32 v4, 15, v1
    v_add_u32 v4, s39, v4
    v_sub_u32 v5, 1024, v4
    v_min_u32 v4, v4, v5
    v_lshrrev_b32 v5, 6, v4
    v_mul_u32_u24 v5, 33792, v5
    v_and_b32 v6, 1, v4
    v_mad_u32_u24 v5, v6, s85, v5
    v_bfe_u32 v4, v4, 1, 5
    v_lshl_add_u32 v4, v4, 4, v5
    v_add_u32 v4, v3, v4
    v_mov_b32 v74, v4
    v_add_u32 v75, 1024, v4
    v_and_b32 v4, 15, v1
    v_add_u32 v4, s39, v4
    v_add_u32 v4, 16, v4
    v_sub_u32 v5, 1024, v4
    v_min_u32 v4, v4, v5
    v_lshrrev_b32 v5, 6, v4
    v_mul_u32_u24 v5, 33792, v5
    v_and_b32 v6, 1, v4
    v_mad_u32_u24 v5, v6, s85, v5
    v_bfe_u32 v4, v4, 1, 5
    v_lshl_add_u32 v4, v4, 4, v5
    v_add_u32 v4, v3, v4
    v_subrev_u32 v4, 2048, v4
    v_mov_b32 v76, v4
    v_add_u32 v77, 1024, v4
    s_waitcnt vmcnt(8)
    s_waitcnt vmcnt(4)
    s_barrier
    s_add_u32 m0, s48, 49152
    s_mul_i32 s44, s43, 3584
    buffer_load_dwordx4 v16, s[20:23], s44 offen offset:0 lds
    buffer_load_dwordx4 v17, s[20:23], s44 offen offset:1024 lds
    buffer_load_dwordx4 v18, s[20:23], s44 offen offset:2048 lds
    buffer_load_dwordx4 v19, s[20:23], s44 offen offset:3072 lds
    s_add_u32 s43, s43, 128
    s_and_b32 s43, s43, 2047
    s_add_u32 m0, s48, 65536
    s_nop 0
    buffer_load_dwordx4 v8, s[16:19], s41 offen offset:0 lds
    buffer_load_dwordx4 v9, s[16:19], s41 offen offset:1024 lds
    buffer_load_dwordx4 v10, s[16:19], s41 offen offset:2048 lds
    buffer_load_dwordx4 v11, s[16:19], s41 offen offset:3072 lds
    s_add_u32 s41, s41, 128
    s_and_b32 s41, s41, 2047
    s_add_u32 m0, s48, 81920
    s_nop 0
    buffer_load_dwordx4 v12, s[16:19], s42 offen offset:0 lds
    buffer_load_dwordx4 v13, s[16:19], s42 offen offset:1024 lds
    buffer_load_dwordx4 v14, s[16:19], s42 offen offset:2048 lds
    buffer_load_dwordx4 v15, s[16:19], s42 offen offset:3072 lds
    s_add_u32 s42, s42, 128
    s_and_b32 s42, s42, 2047
    s_waitcnt vmcnt(12)
    s_barrier
    s_add_u32 m0, s48, 98304
    s_mul_i32 s44, s43, 3584
    buffer_load_dwordx4 v16, s[20:23], s44 offen offset:0 lds
    buffer_load_dwordx4 v17, s[20:23], s44 offen offset:1024 lds
    buffer_load_dwordx4 v18, s[20:23], s44 offen offset:2048 lds
    buffer_load_dwordx4 v19, s[20:23], s44 offen offset:3072 lds
    s_add_u32 s43, s43, 128
    s_and_b32 s43, s43, 2047
    s_add_u32 m0, s48, 114688
    s_nop 0
    buffer_load_dwordx4 v8, s[16:19], s41 offen offset:0 lds
    buffer_load_dwordx4 v9, s[16:19], s41 offen offset:1024 lds
    buffer_load_dwordx4 v10, s[16:19], s41 offen offset:2048 lds
    buffer_load_dwordx4 v11, s[16:19], s41 offen offset:3072 lds
    s_add_u32 s41, s41, 128
    s_and_b32 s41, s41, 2047
    s_add_u32 m0, s48, 131072
    s_nop 0
    buffer_load_dwordx4 v12, s[16:19], s42 offen offset:0 lds
    buffer_load_dwordx4 v13, s[16:19], s42 offen offset:1024 lds
    buffer_load_dwordx4 v14, s[16:19], s42 offen offset:2048 lds
    buffer_load_dwordx4 v15, s[16:19], s42 offen offset:3072 lds
    s_add_u32 s42, s42, 128
    s_and_b32 s42, s42, 2047
    s_waitcnt vmcnt(20)
    s_waitcnt vmcnt(16)
    s_barrier
    s_add_u32 m0, s48, 0
    s_mul_i32 s44, s43, 3584
    buffer_load_dwordx4 v16, s[20:23], s44 offen offset:0 lds
    buffer_load_dwordx4 v17, s[20:23], s44 offen offset:1024 lds
    buffer_load_dwordx4 v18, s[20:23], s44 offen offset:2048 lds
    buffer_load_dwordx4 v19, s[20:23], s44 offen offset:3072 lds
    s_add_u32 s43, s43, 128
    s_and_b32 s43, s43, 2047
    s_add_u32 m0, s48, 16384
    s_nop 0
    buffer_load_dwordx4 v8, s[16:19], s41 offen offset:0 lds
    buffer_load_dwordx4 v9, s[16:19], s41 offen offset:1024 lds
    buffer_load_dwordx4 v10, s[16:19], s41 offen offset:2048 lds
    buffer_load_dwordx4 v11, s[16:19], s41 offen offset:3072 lds
    s_add_u32 s41, s41, 128
    s_and_b32 s41, s41, 2047
    s_waitcnt vmcnt(20)
    s_barrier
    s_add_u32 m0, s48, 32768
    s_nop 0
    buffer_load_dwordx4 v12, s[16:19], s42 offen offset:0 lds
    buffer_load_dwordx4 v13, s[16:19], s42 offen offset:1024 lds
    buffer_load_dwordx4 v14, s[16:19], s42 offen offset:2048 lds
    buffer_load_dwordx4 v15, s[16:19], s42 offen offset:3072 lds
    s_add_u32 s42, s42, 128
    s_and_b32 s42, s42, 2047
    s_add_u32 m0, s48, 49152
    s_mul_i32 s44, s43, 3584
    buffer_load_dwordx4 v16, s[20:23], s44 offen offset:0 lds
    buffer_load_dwordx4 v17, s[20:23], s44 offen offset:1024 lds
    buffer_load_dwordx4 v18, s[20:23], s44 offen offset:2048 lds
    buffer_load_dwordx4 v19, s[20:23], s44 offen offset:3072 lds
    s_add_u32 s43, s43, 128
    s_and_b32 s43, s43, 2047
    s_waitcnt vmcnt(24)
    s_waitcnt vmcnt(20)
    s_barrier
    s_add_u32 m0, s48, 65536
    s_nop 0
    buffer_load_dwordx4 v8, s[16:19], s41 offen offset:0 lds
    buffer_load_dwordx4 v9, s[16:19], s41 offen offset:1024 lds
    buffer_load_dwordx4 v10, s[16:19], s41 offen offset:2048 lds
    buffer_load_dwordx4 v11, s[16:19], s41 offen offset:3072 lds
    s_add_u32 s41, s41, 128
    s_and_b32 s41, s41, 2047
    s_add_u32 m0, s48, 81920
    s_nop 0
    buffer_load_dwordx4 v12, s[16:19], s42 offen offset:0 lds
    buffer_load_dwordx4 v13, s[16:19], s42 offen offset:1024 lds
    buffer_load_dwordx4 v14, s[16:19], s42 offen offset:2048 lds
    buffer_load_dwordx4 v15, s[16:19], s42 offen offset:3072 lds
    s_add_u32 s42, s42, 128
    s_and_b32 s42, s42, 2047
    s_waitcnt vmcnt(24)
    s_barrier
    s_add_u32 m0, s48, 98304
    s_mul_i32 s44, s43, 3584
    buffer_load_dwordx4 v16, s[20:23], s44 offen offset:0 lds
    buffer_load_dwordx4 v17, s[20:23], s44 offen offset:1024 lds
    buffer_load_dwordx4 v18, s[20:23], s44 offen offset:2048 lds
    buffer_load_dwordx4 v19, s[20:23], s44 offen offset:3072 lds
    s_add_u32 s43, s43, 128
    s_and_b32 s43, s43, 2047
    s_add_u32 m0, s48, 114688
    s_nop 0
    buffer_load_dwordx4 v8, s[16:19], s41 offen offset:0 lds
    buffer_load_dwordx4 v9, s[16:19], s41 offen offset:1024 lds
    buffer_load_dwordx4 v10, s[16:19], s41 offen offset:2048 lds
    buffer_load_dwordx4 v11, s[16:19], s41 offen offset:3072 lds
    s_add_u32 s41, s41, 128
    s_and_b32 s41, s41, 2047
    s_waitcnt vmcnt(28)
    s_waitcnt vmcnt(24)
    s_barrier
    s_add_u32 m0, s48, 131072
    s_nop 0
    buffer_load_dwordx4 v12, s[16:19], s42 offen offset:0 lds
    buffer_load_dwordx4 v13, s[16:19], s42 offen offset:1024 lds
    buffer_load_dwordx4 v14, s[16:19], s42 offen offset:2048 lds
    buffer_load_dwordx4 v15, s[16:19], s42 offen offset:3072 lds
    s_add_u32 s42, s42, 128
    s_and_b32 s42, s42, 2047
    s_lshl2_add_u32 s88, s35, s40
    s_lshl1_add_u32 s88, s88, s34
    s_lshl_b32 s88, s88, 13
    s_mul_i32 s38, s33, 7168
    s_add_u32 s38, s38, s36
    s_lshl_b32 s38, s38, 8
    s_add_u32 s88, s88, s38
    s_sub_u32 s89, s36, 1
    s_lshl_b32 s89, s89, 18
    s_lshl2_add_u32 s38, s36, s40
    s_lshl_b32 s39, s35, 7
    s_add_u32 s38, s38, s39
    s_sub_u32 s38, s38, 4
    s_lshl1_add_u32 s38, s38, s34
    s_lshl_b32 s38, s38, 12
    s_and_b32 s39, s54, 0x300
    s_add_u32 s91, s38, s39
    s_sub_u32 s94, s39, s38
    s_add_u32 s94, s94, 7471104
    s_waitcnt vmcnt(24)
    s_barrier
    s_add_u32 m0, s48, 0
    s_mul_i32 s44, s43, 3584
    buffer_load_dwordx4 v16, s[20:23], s44 offen offset:0 lds
    buffer_load_dwordx4 v17, s[20:23], s44 offen offset:1024 lds
    buffer_load_dwordx4 v18, s[20:23], s44 offen offset:2048 lds
    buffer_load_dwordx4 v19, s[20:23], s44 offen offset:3072 lds
    s_add_u32 s43, s43, 128
    s_and_b32 s43, s43, 2047
    s_add_u32 m0, s48, 16384
    s_nop 0
    buffer_load_dwordx4 v8, s[16:19], s41 offen offset:0 lds
    buffer_load_dwordx4 v9, s[16:19], s41 offen offset:1024 lds
    buffer_load_dwordx4 v10, s[16:19], s41 offen offset:2048 lds
    buffer_load_dwordx4 v11, s[16:19], s41 offen offset:3072 lds
    s_add_u32 s41, s41, 128
    s_and_b32 s41, s41, 2047
    s_buffer_load_dwordx2 s[92:93], s[76:79], s91 offset:60
    s_buffer_load_dwordx2 s[92:93], s[76:79], s91 offset:229436
    s_buffer_load_dwordx2 s[92:93], s[76:79], s91 offset:458812
    s_waitcnt vmcnt(28)
    s_waitcnt vmcnt(24)
    s_barrier
    s_add_u32 m0, s48, 32768
    s_nop 0
    buffer_load_dwordx4 v12, s[16:19], s42 offen offset:0 lds
    buffer_load_dwordx4 v13, s[16:19], s42 offen offset:1024 lds
    buffer_load_dwordx4 v14, s[16:19], s42 offen offset:2048 lds
    buffer_load_dwordx4 v15, s[16:19], s42 offen offset:3072 lds
    s_add_u32 s42, s42, 128
    s_and_b32 s42, s42, 2047
    s_buffer_load_dwordx2 s[92:93], s[76:79], s91 offset:688188
    s_buffer_load_dwordx2 s[92:93], s[76:79], s91 offset:917564
    s_mul_i32 s53, s2, 49152
    s_add_u32 s53, s53, 25165824
    v_mov_b32 v80, -1
    v_mov_b32 v81, -1
    v_mov_b32 v82, -1
    v_mov_b32 v83, -1
    buffer_store_dwordx4 v[80:83], v30, s[24:27], s53 offen offset:0 sc1
    buffer_store_dwordx4 v[80:83], v30, s[24:27], s53 offen offset:1024 sc1
    s_waitcnt vmcnt(26)
    s_barrier
    s_add_u32 m0, s48, 49152
    s_mul_i32 s44, s43, 3584
    buffer_load_dwordx4 v16, s[20:23], s44 offen offset:0 lds
    buffer_load_dwordx4 v17, s[20:23], s44 offen offset:1024 lds
    buffer_load_dwordx4 v18, s[20:23], s44 offen offset:2048 lds
    buffer_load_dwordx4 v19, s[20:23], s44 offen offset:3072 lds
    s_add_u32 s43, s43, 128
    s_and_b32 s43, s43, 2047
    s_add_u32 m0, s48, 65536
    s_nop 0
    buffer_load_dwordx4 v8, s[16:19], s41 offen offset:0 lds
    buffer_load_dwordx4 v9, s[16:19], s41 offen offset:1024 lds
    buffer_load_dwordx4 v10, s[16:19], s41 offen offset:2048 lds
    buffer_load_dwordx4 v11, s[16:19], s41 offen offset:3072 lds
    s_add_u32 s41, s41, 128
    s_and_b32 s41, s41, 2047
    s_buffer_load_dwordx2 s[92:93], s[76:79], s91 offset:188
    s_buffer_load_dwordx2 s[92:93], s[76:79], s91 offset:229564
    s_buffer_load_dwordx2 s[92:93], s[76:79], s91 offset:458940
    s_waitcnt vmcnt(30)
    s_waitcnt vmcnt(26)
    s_barrier
    s_add_u32 m0, s48, 81920
    s_nop 0
    buffer_load_dwordx4 v12, s[16:19], s42 offen offset:0 lds
    buffer_load_dwordx4 v13, s[16:19], s42 offen offset:1024 lds
    buffer_load_dwordx4 v14, s[16:19], s42 offen offset:2048 lds
    buffer_load_dwordx4 v15, s[16:19], s42 offen offset:3072 lds
    s_add_u32 s42, s42, 128
    s_and_b32 s42, s42, 2047
    s_buffer_load_dwordx2 s[92:93], s[76:79], s91 offset:688316
    s_buffer_load_dwordx2 s[92:93], s[76:79], s91 offset:917692
    buffer_store_dwordx4 v[80:83], v30, s[24:27], s53 offen offset:2048 sc1
    buffer_store_dwordx4 v[80:83], v30, s[24:27], s53 offen offset:3072 sc1
    s_add_u32 s53, s53, 16384
    s_waitcnt vmcnt(28)
    s_barrier
    s_add_u32 m0, s48, 98304
    s_mul_i32 s44, s43, 3584
    buffer_load_dwordx4 v16, s[20:23], s44 offen offset:0 lds
    buffer_load_dwordx4 v17, s[20:23], s44 offen offset:1024 lds
    buffer_load_dwordx4 v18, s[20:23], s44 offen offset:2048 lds
    buffer_load_dwordx4 v19, s[20:23], s44 offen offset:3072 lds
    s_add_u32 s43, s43, 128
    s_and_b32 s43, s43, 2047
    s_add_u32 m0, s48, 114688
    s_nop 0
    buffer_load_dwordx4 v8, s[16:19], s41 offen offset:0 lds
    buffer_load_dwordx4 v9, s[16:19], s41 offen offset:1024 lds
    buffer_load_dwordx4 v10, s[16:19], s41 offen offset:2048 lds
    buffer_load_dwordx4 v11, s[16:19], s41 offen offset:3072 lds
    s_add_u32 s41, s41, 128
    s_and_b32 s41, s41, 2047
    s_buffer_load_dwordx2 s[92:93], s[80:83], s91 offset:60
    s_buffer_load_dwordx2 s[92:93], s[80:83], s91 offset:229436
    s_buffer_load_dwordx2 s[92:93], s[80:83], s91 offset:458812
    s_waitcnt vmcnt(32)
    s_waitcnt vmcnt(28)
    s_barrier
    s_add_u32 m0, s48, 131072
    s_nop 0
    buffer_load_dwordx4 v12, s[16:19], s42 offen offset:0 lds
    buffer_load_dwordx4 v13, s[16:19], s42 offen offset:1024 lds
    buffer_load_dwordx4 v14, s[16:19], s42 offen offset:2048 lds
    buffer_load_dwordx4 v15, s[16:19], s42 offen offset:3072 lds
    s_add_u32 s42, s42, 128
    s_and_b32 s42, s42, 2047
    s_buffer_load_dwordx2 s[92:93], s[80:83], s91 offset:688188
    s_buffer_load_dwordx2 s[92:93], s[80:83], s91 offset:917564
    buffer_store_dwordx4 v[80:83], v30, s[24:27], s53 offen offset:0 sc1
    buffer_store_dwordx4 v[80:83], v30, s[24:27], s53 offen offset:1024 sc1
    s_waitcnt vmcnt(30)
    s_barrier
    s_add_u32 m0, s48, 0
    s_mul_i32 s44, s43, 3584
    buffer_load_dwordx4 v16, s[20:23], s44 offen offset:0 lds
    buffer_load_dwordx4 v17, s[20:23], s44 offen offset:1024 lds
    buffer_load_dwordx4 v18, s[20:23], s44 offen offset:2048 lds
    buffer_load_dwordx4 v19, s[20:23], s44 offen offset:3072 lds
    s_add_u32 s43, s43, 128
    s_and_b32 s43, s43, 2047
    s_add_u32 m0, s48, 16384
    s_nop 0
    buffer_load_dwordx4 v8, s[16:19], s41 offen offset:0 lds
    buffer_load_dwordx4 v9, s[16:19], s41 offen offset:1024 lds
    buffer_load_dwordx4 v10, s[16:19], s41 offen offset:2048 lds
    buffer_load_dwordx4 v11, s[16:19], s41 offen offset:3072 lds
    s_add_u32 s41, s41, 128
    s_and_b32 s41, s41, 2047
    s_buffer_load_dwordx2 s[92:93], s[80:83], s94 offset:60
    s_buffer_load_dwordx2 s[92:93], s[80:83], s94 offset:229436
    s_buffer_load_dwordx2 s[92:93], s[80:83], s94 offset:458812
    s_waitcnt vmcnt(32)
    s_waitcnt vmcnt(28)
    s_barrier
    s_add_u32 m0, s48, 32768
    s_nop 0
    buffer_load_dwordx4 v12, s[16:19], s42 offen offset:0 lds
    buffer_load_dwordx4 v13, s[16:19], s42 offen offset:1024 lds
    buffer_load_dwordx4 v14, s[16:19], s42 offen offset:2048 lds
    buffer_load_dwordx4 v15, s[16:19], s42 offen offset:3072 lds
    s_add_u32 s42, s42, 128
    s_and_b32 s42, s42, 2047
    s_buffer_load_dwordx2 s[92:93], s[80:83], s94 offset:688188
    s_buffer_load_dwordx2 s[92:93], s[80:83], s94 offset:917564
    buffer_store_dwordx4 v[80:83], v30, s[24:27], s53 offen offset:2048 sc1
    buffer_store_dwordx4 v[80:83], v30, s[24:27], s53 offen offset:3072 sc1
    s_add_u32 s53, s53, 16384
    s_waitcnt vmcnt(30)
    s_barrier
    s_add_u32 m0, s48, 49152
    s_mul_i32 s44, s43, 3584
    buffer_load_dwordx4 v16, s[20:23], s44 offen offset:0 lds
    buffer_load_dwordx4 v17, s[20:23], s44 offen offset:1024 lds
    buffer_load_dwordx4 v18, s[20:23], s44 offen offset:2048 lds
    buffer_load_dwordx4 v19, s[20:23], s44 offen offset:3072 lds
    s_add_u32 s43, s43, 128
    s_and_b32 s43, s43, 2047
    s_add_u32 m0, s48, 65536
    s_nop 0
    buffer_load_dwordx4 v8, s[16:19], s41 offen offset:0 lds
    buffer_load_dwordx4 v9, s[16:19], s41 offen offset:1024 lds
    buffer_load_dwordx4 v10, s[16:19], s41 offen offset:2048 lds
    buffer_load_dwordx4 v11, s[16:19], s41 offen offset:3072 lds
    s_add_u32 s41, s41, 128
    s_and_b32 s41, s41, 2047
    s_buffer_load_dwordx2 s[92:93], s[80:83], s91 offset:188
    s_buffer_load_dwordx2 s[92:93], s[80:83], s91 offset:229564
    s_buffer_load_dwordx2 s[92:93], s[80:83], s91 offset:458940
    s_waitcnt vmcnt(32)
    s_waitcnt vmcnt(28)
    s_barrier
    s_add_u32 m0, s48, 81920
    s_nop 0
    buffer_load_dwordx4 v12, s[16:19], s42 offen offset:0 lds
    buffer_load_dwordx4 v13, s[16:19], s42 offen offset:1024 lds
    buffer_load_dwordx4 v14, s[16:19], s42 offen offset:2048 lds
    buffer_load_dwordx4 v15, s[16:19], s42 offen offset:3072 lds
    s_add_u32 s42, s42, 128
    s_and_b32 s42, s42, 2047
    s_buffer_load_dwordx2 s[92:93], s[80:83], s91 offset:688316
    s_buffer_load_dwordx2 s[92:93], s[80:83], s91 offset:917692
    buffer_store_dwordx4 v[80:83], v30, s[24:27], s53 offen offset:0 sc1
    buffer_store_dwordx4 v[80:83], v30, s[24:27], s53 offen offset:1024 sc1
    s_waitcnt vmcnt(30)
    s_barrier
    s_add_u32 m0, s48, 98304
    s_mul_i32 s44, s43, 3584
    buffer_load_dwordx4 v16, s[20:23], s44 offen offset:0 lds
    buffer_load_dwordx4 v17, s[20:23], s44 offen offset:1024 lds
    buffer_load_dwordx4 v18, s[20:23], s44 offen offset:2048 lds
    buffer_load_dwordx4 v19, s[20:23], s44 offen offset:3072 lds
    s_add_u32 s43, s43, 128
    s_and_b32 s43, s43, 2047
    s_add_u32 m0, s48, 114688
    s_nop 0
    buffer_load_dwordx4 v8, s[16:19], s41 offen offset:0 lds
    buffer_load_dwordx4 v9, s[16:19], s41 offen offset:1024 lds
    buffer_load_dwordx4 v10, s[16:19], s41 offen offset:2048 lds
    buffer_load_dwordx4 v11, s[16:19], s41 offen offset:3072 lds
    s_add_u32 s41, s41, 128
    s_and_b32 s41, s41, 2047
    s_buffer_load_dwordx2 s[92:93], s[80:83], s94 offset:188
    s_buffer_load_dwordx2 s[92:93], s[80:83], s94 offset:229564
    s_buffer_load_dwordx2 s[92:93], s[80:83], s94 offset:458940
    s_waitcnt vmcnt(32)
    s_waitcnt vmcnt(28)
    s_barrier
    s_add_u32 m0, s48, 131072
    s_nop 0
    buffer_load_dwordx4 v12, s[16:19], s42 offen offset:0 lds
    buffer_load_dwordx4 v13, s[16:19], s42 offen offset:1024 lds
    buffer_load_dwordx4 v14, s[16:19], s42 offen offset:2048 lds
    buffer_load_dwordx4 v15, s[16:19], s42 offen offset:3072 lds
    s_add_u32 s42, s42, 128
    s_and_b32 s42, s42, 2047
    s_buffer_load_dwordx2 s[92:93], s[80:83], s94 offset:688316
    s_buffer_load_dwordx2 s[92:93], s[80:83], s94 offset:917692
    buffer_store_dwordx4 v[80:83], v30, s[24:27], s53 offen offset:2048 sc1
    buffer_store_dwordx4 v[80:83], v30, s[24:27], s53 offen offset:3072 sc1
    s_add_u32 s53, s53, 16384
    s_waitcnt vmcnt(30)
    s_barrier
    s_add_u32 m0, s48, 0
    s_mul_i32 s44, s43, 3584
    buffer_load_dwordx4 v16, s[20:23], s44 offen offset:0 lds
    buffer_load_dwordx4 v17, s[20:23], s44 offen offset:1024 lds
    buffer_load_dwordx4 v18, s[20:23], s44 offen offset:2048 lds
    buffer_load_dwordx4 v19, s[20:23], s44 offen offset:3072 lds
    s_add_u32 s43, s43, 128
    s_and_b32 s43, s43, 2047
    s_add_u32 m0, s48, 16384
    s_nop 0
    buffer_load_dwordx4 v8, s[16:19], s41 offen offset:0 lds
    buffer_load_dwordx4 v9, s[16:19], s41 offen offset:1024 lds
    buffer_load_dwordx4 v10, s[16:19], s41 offen offset:2048 lds
    buffer_load_dwordx4 v11, s[16:19], s41 offen offset:3072 lds
    s_add_u32 s41, s41, 128
    s_and_b32 s41, s41, 2047
    s_add_u32 s90, s88, s89
    s_add_u32 s89, s89, 262144
    s_cmp_eq_u32 s89, 1835008
    s_cselect_b32 s89, 0, s89
    s_buffer_load_dwordx2 s[92:93], s[68:71], s90 offset:60
    s_buffer_load_dwordx2 s[92:93], s[68:71], s90 offset:188
    s_buffer_load_dwordx2 s[92:93], s[68:71], s90 offset:2108
    s_waitcnt vmcnt(32)
    s_waitcnt vmcnt(28)
    s_barrier
    s_add_u32 m0, s48, 32768
    s_mul_i32 s44, s43, 3584
    buffer_load_dwordx4 v16, s[20:23], s44 offen offset:0 lds
    buffer_load_dwordx4 v17, s[20:23], s44 offen offset:1024 lds
    buffer_load_dwordx4 v18, s[20:23], s44 offen offset:2048 lds
    buffer_load_dwordx4 v19, s[20:23], s44 offen offset:3072 lds
    s_add_u32 s43, s43, 128
    s_and_b32 s43, s43, 2047
    s_buffer_load_dwordx2 s[92:93], s[68:71], s90 offset:2236
    s_buffer_load_dwordx2 s[92:93], s[68:71], s90 offset:4156
    buffer_load_dword v50, v49, s[64:67], 0 offen sc1
    s_waitcnt vmcnt(29)
    s_barrier
    s_add_u32 m0, s48, 49152
    s_nop 0
    buffer_load_dwordx4 v8, s[16:19], s41 offen offset:0 lds
    buffer_load_dwordx4 v9, s[16:19], s41 offen offset:1024 lds
    buffer_load_dwordx4 v10, s[16:19], s41 offen offset:2048 lds
    buffer_load_dwordx4 v11, s[16:19], s41 offen offset:3072 lds
    s_add_u32 s41, s41, 128
    s_and_b32 s41, s41, 2047
    s_add_u32 m0, s48, 65536
    s_mul_i32 s44, s43, 3584
    buffer_load_dwordx4 v16, s[20:23], s44 offen offset:0 lds
    buffer_load_dwordx4 v17, s[20:23], s44 offen offset:1024 lds
    buffer_load_dwordx4 v18, s[20:23], s44 offen offset:2048 lds
    buffer_load_dwordx4 v19, s[20:23], s44 offen offset:3072 lds
    s_add_u32 s43, s43, 128
    s_and_b32 s43, s43, 2047
    s_buffer_load_dwordx2 s[92:93], s[68:71], s90 offset:4284
    s_buffer_load_dwordx2 s[92:93], s[68:71], s90 offset:6204
    s_buffer_load_dwordx2 s[92:93], s[68:71], s90 offset:6332
    s_waitcnt vmcnt(31)
    s_waitcnt vmcnt(27)
    s_barrier
    s_add_u32 m0, s48, 81920
    s_nop 0
    buffer_load_dwordx4 v8, s[16:19], s41 offen offset:0 lds
    buffer_load_dwordx4 v9, s[16:19], s41 offen offset:1024 lds
    buffer_load_dwordx4 v10, s[16:19], s41 offen offset:2048 lds
    buffer_load_dwordx4 v11, s[16:19], s41 offen offset:3072 lds
    s_add_u32 s41, s41, 128
    s_and_b32 s41, s41, 2047
    s_add_u32 s90, s88, s89
    s_add_u32 s89, s89, 262144
    s_cmp_eq_u32 s89, 1835008
    s_cselect_b32 s89, 0, s89
    s_buffer_load_dwordx2 s[92:93], s[68:71], s90 offset:60
    s_buffer_load_dwordx2 s[92:93], s[68:71], s90 offset:188
    s_waitcnt vmcnt(27)
    s_barrier
    s_add_u32 m0, s48, 98304
    s_mul_i32 s44, s43, 3584
    buffer_load_dwordx4 v16, s[20:23], s44 offen offset:0 lds
    buffer_load_dwordx4 v17, s[20:23], s44 offen offset:1024 lds
    buffer_load_dwordx4 v18, s[20:23], s44 offen offset:2048 lds
    buffer_load_dwordx4 v19, s[20:23], s44 offen offset:3072 lds
    s_add_u32 s43, s43, 128
    s_and_b32 s43, s43, 2047
    s_add_u32 m0, s48, 114688
    s_nop 0
    buffer_load_dwordx4 v8, s[16:19], s41 offen offset:0 lds
    buffer_load_dwordx4 v9, s[16:19], s41 offen offset:1024 lds
    buffer_load_dwordx4 v10, s[16:19], s41 offen offset:2048 lds
    buffer_load_dwordx4 v11, s[16:19], s41 offen offset:3072 lds
    s_add_u32 s41, s41, 128
    s_and_b32 s41, s41, 2047
    s_buffer_load_dwordx2 s[92:93], s[68:71], s90 offset:2108
    s_buffer_load_dwordx2 s[92:93], s[68:71], s90 offset:2236
    s_buffer_load_dwordx2 s[92:93], s[68:71], s90 offset:4156
    s_mov_b32 s87, 0x40000
    s_waitcnt vmcnt(20)
L_pl_2:
    v_cmp_ne_u32 vcc, 0, v50
    s_cmp_eq_u64 vcc, -1
    s_cbranch_scc1 L_ok_2
    buffer_load_dword v50, v49, s[64:67], 0 offen sc1
    s_waitcnt vmcnt(0)
    s_sub_u32 s87, s87, 1
    s_cbranch_scc0 L_pl_2
L_ok_2:
    s_mov_b32 s38, 20971520
    s_lshl_b32 s39, s40, 8
    s_add_u32 m0, s39, 147456
    s_nop 0
    buffer_load_dword v51, s[24:27], s38 offen sc1 lds
    s_mov_b32 s38, 20971524
    s_add_u32 m0, s39, 148480
    s_nop 0
    buffer_load_dword v51, s[24:27], s38 offen sc1 lds
    s_barrier
    s_add_u32 m0, s48, 131072
    s_nop 0
    buffer_load_dwordx4 v12, s[16:19], s42 offen offset:0 lds
    buffer_load_dwordx4 v13, s[16:19], s42 offen offset:1024 lds
    buffer_load_dwordx4 v14, s[16:19], s42 offen offset:2048 lds
    buffer_load_dwordx4 v15, s[16:19], s42 offen offset:3072 lds
    s_add_u32 s42, s42, 128
    s_and_b32 s42, s42, 2047
    s_buffer_load_dwordx2 s[92:93], s[68:71], s90 offset:4284
    s_buffer_load_dwordx2 s[92:93], s[68:71], s90 offset:6204
    s_waitcnt vmcnt(22)
    s_barrier
    s_add_u32 m0, s48, 16384
    s_nop 0
    buffer_load_dwordx4 v12, s[16:19], s42 offen offset:0 lds
    buffer_load_dwordx4 v13, s[16:19], s42 offen offset:1024 lds
    buffer_load_dwordx4 v14, s[16:19], s42 offen offset:2048 lds
    buffer_load_dwordx4 v15, s[16:19], s42 offen offset:3072 lds
    s_add_u32 s42, s42, 128
    s_and_b32 s42, s42, 2047
    s_buffer_load_dwordx2 s[92:93], s[68:71], s90 offset:6332
    s_add_u32 s90, s88, s89
    s_add_u32 s89, s89, 262144
    s_cmp_eq_u32 s89, 1835008
    s_cselect_b32 s89, 0, s89
    s_buffer_load_dwordx2 s[92:93], s[68:71], s90 offset:60
    s_buffer_load_dwordx2 s[92:93], s[68:71], s90 offset:188
    s_waitcnt vmcnt(22)
    s_waitcnt vmcnt(18)
    s_barrier
    s_add_u32 m0, s48, 49152
    s_nop 0
    buffer_load_dwordx4 v12, s[16:19], s42 offen offset:0 lds
    buffer_load_dwordx4 v13, s[16:19], s42 offen offset:1024 lds
    buffer_load_dwordx4 v14, s[16:19], s42 offen offset:2048 lds
    buffer_load_dwordx4 v15, s[16:19], s42 offen offset:3072 lds
    s_add_u32 s42, s42, 128
    s_and_b32 s42, s42, 2047
    s_buffer_load_dwordx2 s[92:93], s[68:71], s90 offset:2108
    s_buffer_load_dwordx2 s[92:93], s[68:71], s90 offset:2236
    s_waitcnt vmcnt(12)
    s_barrier
    s_add_u32 m0, s48, 81920
    s_nop 0
    buffer_load_dwordx4 v12, s[16:19], s42 offen offset:0 lds
    buffer_load_dwordx4 v13, s[16:19], s42 offen offset:1024 lds
    buffer_load_dwordx4 v14, s[16:19], s42 offen offset:2048 lds
    buffer_load_dwordx4 v15, s[16:19], s42 offen offset:3072 lds
    s_add_u32 s42, s42, 128
    s_and_b32 s42, s42, 2047
    s_buffer_load_dwordx2 s[92:93], s[68:71], s90 offset:4156
    s_buffer_load_dwordx2 s[92:93], s[68:71], s90 offset:4284
    s_buffer_load_dwordx2 s[92:93], s[68:71], s90 offset:6204
    s_waitcnt vmcnt(12)
    s_barrier
    s_buffer_load_dwordx2 s[92:93], s[68:71], s90 offset:6332
    s_add_u32 s90, s88, s89
    s_add_u32 s89, s89, 262144
    s_cmp_eq_u32 s89, 1835008
    s_cselect_b32 s89, 0, s89
    s_buffer_load_dwordx2 s[92:93], s[68:71], s90 offset:60
    s_waitcnt vmcnt(8)
    s_barrier
    s_add_u32 m0, s48, 0
    s_xor_b32 s49, s54, 0
    buffer_load_dwordx4 v24, s[76:79], s49 offen offset:0 lds
    buffer_load_dwordx4 v25, s[76:79], s49 offen offset:1024 lds
    buffer_load_dwordx4 v26, s[76:79], s49 offen offset:2048 lds
    buffer_load_dwordx4 v27, s[76:79], s49 offen offset:3072 lds
    s_buffer_load_dwordx2 s[92:93], s[68:71], s90 offset:188
    s_buffer_load_dwordx2 s[92:93], s[68:71], s90 offset:2108
    s_buffer_load_dwordx2 s[92:93], s[68:71], s90 offset:2236
    s_waitcnt vmcnt(8)
    s_barrier
    buffer_load_dword v40, v36, s[24:27], 0 offen offset:96 sc1
    s_add_u32 m0, s48, 32768
    s_xor_b32 s49, s54, 128
    buffer_load_dwordx4 v24, s[76:79], s49 offen offset:0 lds
    buffer_load_dwordx4 v25, s[76:79], s49 offen offset:1024 lds
    buffer_load_dwordx4 v26, s[76:79], s49 offen offset:2048 lds
    buffer_load_dwordx4 v27, s[76:79], s49 offen offset:3072 lds
    s_add_u32 m0, s48, 16384
    s_lshl_b32 s44, s47, 3
    buffer_load_dwordx4 v20, s[68:71], s44 offen offset:0 lds
    buffer_load_dwordx4 v21, s[68:71], s44 offen offset:1024 lds
    buffer_load_dwordx4 v22, s[68:71], s44 offen offset:2048 lds
    buffer_load_dwordx4 v23, s[68:71], s44 offen offset:3072 lds
    s_add_u32 s47, s47, 16384
    s_cmp_eq_u32 s47, 229376
    s_cselect_b32 s47, 0, s47
    s_buffer_load_dwordx2 s[92:93], s[68:71], s90 offset:4156
    s_buffer_load_dwordx2 s[92:93], s[68:71], s90 offset:4284
    s_waitcnt vmcnt(13)
    s_barrier
    s_mov_b32 s87, 0x40000
    s_waitcnt vmcnt(8)
L_pl_3:
    v_cmp_ne_u32 vcc, 0, v40
    s_cmp_eq_u64 vcc, -1
    s_cbranch_scc1 L_ok_3
    buffer_load_dword v40, v36, s[24:27], 0 offen offset:96 sc1
    s_waitcnt vmcnt(0)
    s_sub_u32 s87, s87, 1
    s_cbranch_scc0 L_pl_3
L_ok_3:
    s_add_u32 m0, s48, 114688
    s_lshl_b32 s52, s54, 5
    s_xor_b32 s52, s52, 0
    buffer_load_dwordx4 v74, s[24:27], s52 offen offset:0 sc1 lds
    buffer_load_dwordx4 v75, s[24:27], s52 offen offset:1024 sc1 lds
    buffer_load_dwordx4 v76, s[24:27], s52 offen offset:2048 sc1 lds
    buffer_load_dwordx4 v77, s[24:27], s52 offen offset:3072 sc1 lds
    s_add_u32 m0, s48, 131072
    s_lshl_b32 s52, s54, 5
    s_xor_b32 s52, s52, 4096
    buffer_load_dwordx4 v74, s[24:27], s52 offen offset:0 sc1 lds
    buffer_load_dwordx4 v75, s[24:27], s52 offen offset:1024 sc1 lds
    buffer_load_dwordx4 v76, s[24:27], s52 offen offset:2048 sc1 lds
    buffer_load_dwordx4 v77, s[24:27], s52 offen offset:3072 sc1 lds
    s_buffer_load_dwordx2 s[92:93], s[68:71], s90 offset:6204
    s_buffer_load_dwordx2 s[92:93], s[68:71], s90 offset:6332
    s_add_u32 s90, s88, s89
    s_add_u32 s89, s89, 262144
    s_cmp_eq_u32 s89, 1835008
    s_cselect_b32 s89, 0, s89
    s_buffer_load_dwordx2 s[92:93], s[68:71], s90 offset:60
    s_waitcnt vmcnt(4)
    s_barrier
    s_add_u32 m0, s48, 49152
    s_lshl_b32 s44, s47, 3
    buffer_load_dwordx4 v20, s[68:71], s44 offen offset:0 lds
    buffer_load_dwordx4 v21, s[68:71], s44 offen offset:1024 lds
    buffer_load_dwordx4 v22, s[68:71], s44 offen offset:2048 lds
    buffer_load_dwordx4 v23, s[68:71], s44 offen offset:3072 lds
    s_add_u32 s47, s47, 16384
    s_cmp_eq_u32 s47, 229376
    s_cselect_b32 s47, 0, s47
    s_add_u32 m0, s48, 81920
    s_lshl_b32 s52, s54, 5
    s_xor_b32 s52, s52, 2097152
    buffer_load_dwordx4 v74, s[24:27], s52 offen offset:0 sc1 lds
    buffer_load_dwordx4 v75, s[24:27], s52 offen offset:1024 sc1 lds
    buffer_load_dwordx4 v76, s[24:27], s52 offen offset:2048 sc1 lds
    buffer_load_dwordx4 v77, s[24:27], s52 offen offset:3072 sc1 lds
    s_buffer_load_dwordx2 s[92:93], s[68:71], s90 offset:188
    s_buffer_load_dwordx2 s[92:93], s[68:71], s90 offset:2108
    s_waitcnt vmcnt(8)
    s_barrier
    buffer_store_dword v57, v56, s[24:27], s51 offen offset:0 sc1
    buffer_store_dword v57, v56, s[24:27], s51 offen offset:64 sc1
    s_add_u32 m0, s48, 65536
    s_nop 0
    buffer_load_dwordx4 v28, s[24:27], s45 offen offset:0 sc1 lds
    buffer_load_dwordx4 v28, s[24:27], s45 offen offset:1024 sc1 lds
    buffer_load_dwordx4 v28, s[24:27], s45 offen offset:2048 sc1 lds
    buffer_load_dwordx4 v28, s[24:27], s45 offen offset:3072 sc1 lds
    s_add_u32 s45, s45, 16384
    s_cmp_eq_u32 s45, 229376
    s_cselect_b32 s45, 0, s45
    s_add_u32 m0, s48, 98304
    s_nop 0
    buffer_load_dwordx4 v28, s[24:27], s45 offen offset:0 sc1 lds
    buffer_load_dwordx4 v28, s[24:27], s45 offen offset:1024 sc1 lds
    buffer_load_dwordx4 v28, s[24:27], s45 offen offset:2048 sc1 lds
    buffer_load_dwordx4 v28, s[24:27], s45 offen offset:3072 sc1 lds
    s_add_u32 s45, s45, 16384
    s_cmp_eq_u32 s45, 229376
    s_cselect_b32 s45, 0, s45
    s_buffer_load_dwordx2 s[92:93], s[68:71], s90 offset:2236
    s_buffer_load_dwordx2 s[92:93], s[68:71], s90 offset:4156
    s_buffer_load_dwordx2 s[92:93], s[68:71], s90 offset:4284
    s_waitcnt vmcnt(4)
    s_barrier
    s_buffer_load_dwordx2 s[92:93], s[68:71], s90 offset:6204
    s_buffer_load_dwordx2 s[92:93], s[68:71], s90 offset:6332
    s_waitcnt vmcnt(0)
    s_barrier
    s_add_u32 m0, s48, 65536
    s_xor_b32 s49, s54, 0
    buffer_load_dwordx4 v84, s[80:83], s49 offen offset:0 lds
    buffer_load_dwordx4 v85, s[80:83], s49 offen offset:1024 lds
    buffer_load_dwordx4 v86, s[80:83], s49 offen offset:2048 lds
    buffer_load_dwordx4 v87, s[80:83], s49 offen offset:3072 lds
    s_add_u32 s90, s88, s89
    s_add_u32 s89, s89, 262144
    s_cmp_eq_u32 s89, 1835008
    s_cselect_b32 s89, 0, s89
    s_buffer_load_dwordx2 s[92:93], s[68:71], s90 offset:60
    s_buffer_load_dwordx2 s[92:93], s[68:71], s90 offset:188
    s_buffer_load_dwordx2 s[92:93], s[68:71], s90 offset:2108
    s_barrier
    s_add_u32 m0, s48, 98304
    s_lshl_b32 s52, s54, 5
    s_xor_b32 s52, s52, 2101248
    buffer_load_dwordx4 v74, s[24:27], s52 offen offset:0 sc1 lds
    buffer_load_dwordx4 v75, s[24:27], s52 offen offset:1024 sc1 lds
    buffer_load_dwordx4 v76, s[24:27], s52 offen offset:2048 sc1 lds
    buffer_load_dwordx4 v77, s[24:27], s52 offen offset:3072 sc1 lds
    s_buffer_load_dwordx2 s[92:93], s[68:71], s90 offset:2236
    s_buffer_load_dwordx2 s[92:93], s[68:71], s90 offset:4156
    s_barrier
    s_add_u32 m0, s48, 114688
    s_xor_b32 s49, s54, 128
    buffer_load_dwordx4 v84, s[80:83], s49 offen offset:0 lds
    buffer_load_dwordx4 v85, s[80:83], s49 offen offset:1024 lds
    buffer_load_dwordx4 v86, s[80:83], s49 offen offset:2048 lds
    buffer_load_dwordx4 v87, s[80:83], s49 offen offset:3072 lds
    s_buffer_load_dwordx2 s[92:93], s[68:71], s90 offset:4284
    s_buffer_load_dwordx2 s[92:93], s[68:71], s90 offset:6204
    s_buffer_load_dwordx2 s[92:93], s[68:71], s90 offset:6332
    s_waitcnt vmcnt(8)
    s_barrier
    buffer_store_dword v57, v56, s[24:27], s51 offen offset:32 sc1
    s_add_u32 m0, s48, 0
    s_nop 0
    buffer_load_dwordx4 v29, s[24:27], s46 offen offset:0 sc1 lds
    buffer_load_dwordx4 v29, s[24:27], s46 offen offset:1024 sc1 lds
    buffer_load_dwordx4 v29, s[24:27], s46 offen offset:2048 sc1 lds
    buffer_load_dwordx4 v29, s[24:27], s46 offen offset:3072 sc1 lds
    s_add_u32 s46, s46, 16384
    s_cmp_eq_u32 s46, 229376
    s_cselect_b32 s46, 0, s46
    s_add_u32 m0, s48, 131072
    s_nop 0
    buffer_load_dwordx4 v29, s[24:27], s46 offen offset:0 sc1 lds
    buffer_load_dwordx4 v29, s[24:27], s46 offen offset:1024 sc1 lds
    buffer_load_dwordx4 v29, s[24:27], s46 offen offset:2048 sc1 lds
    buffer_load_dwordx4 v29, s[24:27], s46 offen offset:3072 sc1 lds
    s_add_u32 s46, s46, 16384
    s_cmp_eq_u32 s46, 229376
    s_cselect_b32 s46, 0, s46
    s_add_u32 s90, s88, s89
    s_add_u32 s89, s89, 262144
    s_cmp_eq_u32 s89, 1835008
    s_cselect_b32 s89, 0, s89
    s_buffer_load_dwordx2 s[92:93], s[68:71], s90 offset:60
    s_buffer_load_dwordx2 s[92:93], s[68:71], s90 offset:188
    s_barrier
    s_add_u32 m0, s48, 32768
    s_lshl_b32 s44, s47, 3
    buffer_load_dwordx4 v20, s[68:71], s44 offen offset:0 lds
    buffer_load_dwordx4 v21, s[68:71], s44 offen offset:1024 lds
    buffer_load_dwordx4 v22, s[68:71], s44 offen offset:2048 lds
    buffer_load_dwordx4 v23, s[68:71], s44 offen offset:3072 lds
    s_add_u32 s47, s47, 16384
    s_cmp_eq_u32 s47, 229376
    s_cselect_b32 s47, 0, s47
    s_buffer_load_dwordx2 s[92:93], s[68:71], s90 offset:2108
    s_buffer_load_dwordx2 s[92:93], s[68:71], s90 offset:2236
    s_buffer_load_dwordx2 s[92:93], s[68:71], s90 offset:4156
    s_waitcnt vmcnt(17)
    s_waitcnt vmcnt(13)
    s_barrier
    s_buffer_load_dwordx2 s[92:93], s[68:71], s90 offset:4284
    s_buffer_load_dwordx2 s[92:93], s[68:71], s90 offset:6204
    s_barrier
    buffer_load_dword v37, v35, s[24:27], s56 offen sc1
    s_add_u32 m0, s48, 98304
    s_lshl_b32 s44, s47, 3
    buffer_load_dwordx4 v20, s[68:71], s44 offen offset:0 lds
    buffer_load_dwordx4 v21, s[68:71], s44 offen offset:1024 lds
    buffer_load_dwordx4 v22, s[68:71], s44 offen offset:2048 lds
    buffer_load_dwordx4 v23, s[68:71], s44 offen offset:3072 lds
    s_add_u32 s47, s47, 16384
    s_cmp_eq_u32 s47, 229376
    s_cselect_b32 s47, 0, s47
    s_buffer_load_dwordx2 s[92:93], s[68:71], s90 offset:6332
    s_waitcnt vmcnt(13)
    s_barrier
    s_waitcnt vmcnt(4)
    v_cmp_ne_u32 vcc, 0, v37
    s_or_b32 s57, s57, vcc_lo
    s_add_u32 m0, s48, 81920
    s_lshr_b32 s58, s45, 15
    s_add_u32 s58, s58, 1
    s_bitcmp1_b32 s57, s58
    s_cbranch_scc1 L_tk_1
    s_mov_b32 s87, 0x40000
L_tl_1:
    buffer_load_dword v38, v35, s[24:27], s56 offen sc1
    s_waitcnt vmcnt(0)
    v_cmp_ne_u32 vcc, 0, v38
    s_or_b32 s57, s57, vcc_lo
    s_bitcmp1_b32 s57, s58
    s_cbranch_scc1 L_tj_1
    s_sub_u32 s87, s87, 1
    s_cbranch_scc0 L_tl_1
L_tj_1:
L_tk_1:
    buffer_load_dwordx4 v28, s[24:27], s45 offen offset:0 sc1 lds
    buffer_load_dwordx4 v28, s[24:27], s45 offen offset:1024 sc1 lds
    buffer_load_dwordx4 v28, s[24:27], s45 offen offset:2048 sc1 lds
    buffer_load_dwordx4 v28, s[24:27], s45 offen offset:3072 sc1 lds
    s_add_u32 s45, s45, 16384
    s_cmp_eq_u32 s45, 229376
    s_cselect_b32 s45, 0, s45
    s_add_u32 m0, s48, 65536
    s_lshr_b32 s58, s46, 15
    s_add_u32 s58, s58, 9
    s_bitcmp1_b32 s57, s58
    s_cbranch_scc1 L_tk_2
    s_mov_b32 s87, 0x40000
L_tl_2:
    buffer_load_dword v38, v35, s[24:27], s56 offen sc1
    s_waitcnt vmcnt(0)
    v_cmp_ne_u32 vcc, 0, v38
    s_or_b32 s57, s57, vcc_lo
    s_bitcmp1_b32 s57, s58
    s_cbranch_scc1 L_tj_2
    s_sub_u32 s87, s87, 1
    s_cbranch_scc0 L_tl_2
L_tj_2:
L_tk_2:
    buffer_load_dwordx4 v29, s[24:27], s46 offen offset:0 sc1 lds
    buffer_load_dwordx4 v29, s[24:27], s46 offen offset:1024 sc1 lds
    buffer_load_dwordx4 v29, s[24:27], s46 offen offset:2048 sc1 lds
    buffer_load_dwordx4 v29, s[24:27], s46 offen offset:3072 sc1 lds
    s_add_u32 s46, s46, 16384
    s_cmp_eq_u32 s46, 229376
    s_cselect_b32 s46, 0, s46
    s_barrier
    buffer_load_dword v37, v35, s[24:27], s56 offen sc1
    s_add_u32 m0, s48, 114688
    s_nop 0
    buffer_load_dwordx4 v28, s[24:27], s45 offen offset:0 sc1 lds
    buffer_load_dwordx4 v28, s[24:27], s45 offen offset:1024 sc1 lds
    buffer_load_dwordx4 v28, s[24:27], s45 offen offset:2048 sc1 lds
    buffer_load_dwordx4 v28, s[24:27], s45 offen offset:3072 sc1 lds
    s_add_u32 s45, s45, 16384
    s_cmp_eq_u32 s45, 229376
    s_cselect_b32 s45, 0, s45
    s_add_u32 m0, s48, 16384
    s_nop 0
    buffer_load_dwordx4 v29, s[24:27], s46 offen offset:0 sc1 lds
    buffer_load_dwordx4 v29, s[24:27], s46 offen offset:1024 sc1 lds
    buffer_load_dwordx4 v29, s[24:27], s46 offen offset:2048 sc1 lds
    buffer_load_dwordx4 v29, s[24:27], s46 offen offset:3072 sc1 lds
    s_add_u32 s46, s46, 16384
    s_cmp_eq_u32 s46, 229376
    s_cselect_b32 s46, 0, s46
    s_waitcnt vmcnt(13)
    s_barrier
    s_waitcnt vmcnt(8)
    v_cmp_ne_u32 vcc, 0, v37
    s_or_b32 s57, s57, vcc_lo
    s_add_u32 m0, s48, 0
    s_lshl_b32 s44, s47, 3
    buffer_load_dwordx4 v20, s[68:71], s44 offen offset:0 lds
    buffer_load_dwordx4 v21, s[68:71], s44 offen offset:1024 lds
    buffer_load_dwordx4 v22, s[68:71], s44 offen offset:2048 lds
    buffer_load_dwordx4 v23, s[68:71], s44 offen offset:3072 lds
    s_add_u32 s47, s47, 16384
    s_cmp_eq_u32 s47, 229376
    s_cselect_b32 s47, 0, s47
    s_add_u32 m0, s48, 49152
    s_lshr_b32 s58, s45, 15
    s_add_u32 s58, s58, 1
    s_bitcmp1_b32 s57, s58
    s_cbranch_scc1 L_tk_3
    s_mov_b32 s87, 0x40000
L_tl_3:
    buffer_load_dword v38, v35, s[24:27], s56 offen sc1
    s_waitcnt vmcnt(0)
    v_cmp_ne_u32 vcc, 0, v38
    s_or_b32 s57, s57, vcc_lo
    s_bitcmp1_b32 s57, s58
    s_cbranch_scc1 L_tj_3
    s_sub_u32 s87, s87, 1
    s_cbranch_scc0 L_tl_3
L_tj_3:
L_tk_3:
    buffer_load_dwordx4 v28, s[24:27], s45 offen offset:0 sc1 lds
    buffer_load_dwordx4 v28, s[24:27], s45 offen offset:1024 sc1 lds
    buffer_load_dwordx4 v28, s[24:27], s45 offen offset:2048 sc1 lds
    buffer_load_dwordx4 v28, s[24:27], s45 offen offset:3072 sc1 lds
    s_add_u32 s45, s45, 16384
    s_cmp_eq_u32 s45, 229376
    s_cselect_b32 s45, 0, s45
    s_barrier
    buffer_load_dword v37, v35, s[24:27], s56 offen sc1
    s_add_u32 m0, s48, 131072
    s_lshr_b32 s58, s46, 15
    s_add_u32 s58, s58, 9
    s_bitcmp1_b32 s57, s58
    s_cbranch_scc1 L_tk_4
    s_mov_b32 s87, 0x40000
L_tl_4:
    buffer_load_dword v38, v35, s[24:27], s56 offen sc1
    s_waitcnt vmcnt(0)
    v_cmp_ne_u32 vcc, 0, v38
    s_or_b32 s57, s57, vcc_lo
    s_bitcmp1_b32 s57, s58
    s_cbranch_scc1 L_tj_4
    s_sub_u32 s87, s87, 1
    s_cbranch_scc0 L_tl_4
L_tj_4:
L_tk_4:
    buffer_load_dwordx4 v29, s[24:27], s46 offen offset:0 sc1 lds
    buffer_load_dwordx4 v29, s[24:27], s46 offen offset:1024 sc1 lds
    buffer_load_dwordx4 v29, s[24:27], s46 offen offset:2048 sc1 lds
    buffer_load_dwordx4 v29, s[24:27], s46 offen offset:3072 sc1 lds
    s_add_u32 s46, s46, 16384
    s_cmp_eq_u32 s46, 229376
    s_cselect_b32 s46, 0, s46
    s_add_u32 m0, s48, 32768
    s_lshl_b32 s44, s47, 3
    buffer_load_dwordx4 v20, s[68:71], s44 offen offset:0 lds
    buffer_load_dwordx4 v21, s[68:71], s44 offen offset:1024 lds
    buffer_load_dwordx4 v22, s[68:71], s44 offen offset:2048 lds
    buffer_load_dwordx4 v23, s[68:71], s44 offen offset:3072 lds
    s_add_u32 s47, s47, 16384
    s_cmp_eq_u32 s47, 229376
    s_cselect_b32 s47, 0, s47
    s_waitcnt vmcnt(21)
    s_barrier
    s_waitcnt vmcnt(8)
    v_cmp_ne_u32 vcc, 0, v37
    s_or_b32 s57, s57, vcc_lo
    s_add_u32 m0, s48, 81920
    s_nop 0
    buffer_load_dwordx4 v28, s[24:27], s45 offen offset:0 sc1 lds
    buffer_load_dwordx4 v28, s[24:27], s45 offen offset:1024 sc1 lds
    buffer_load_dwordx4 v28, s[24:27], s45 offen offset:2048 sc1 lds
    buffer_load_dwordx4 v28, s[24:27], s45 offen offset:3072 sc1 lds
    s_add_u32 s45, s45, 16384
    s_cmp_eq_u32 s45, 229376
    s_cselect_b32 s45, 0, s45
    s_add_u32 m0, s48, 65536
    s_nop 0
    buffer_load_dwordx4 v29, s[24:27], s46 offen offset:0 sc1 lds
    buffer_load_dwordx4 v29, s[24:27], s46 offen offset:1024 sc1 lds
    buffer_load_dwordx4 v29, s[24:27], s46 offen offset:2048 sc1 lds
    buffer_load_dwordx4 v29, s[24:27], s46 offen offset:3072 sc1 lds
    s_add_u32 s46, s46, 16384
    s_cmp_eq_u32 s46, 229376
    s_cselect_b32 s46, 0, s46
    s_barrier
    s_add_u32 m0, s48, 98304
    s_lshl_b32 s44, s47, 3
    buffer_load_dwordx4 v20, s[68:71], s44 offen offset:0 lds
    buffer_load_dwordx4 v21, s[68:71], s44 offen offset:1024 lds
    buffer_load_dwordx4 v22, s[68:71], s44 offen offset:2048 lds
    buffer_load_dwordx4 v23, s[68:71], s44 offen offset:3072 lds
    s_add_u32 s47, s47, 16384
    s_cmp_eq_u32 s47, 229376
    s_cselect_b32 s47, 0, s47
    s_add_u32 m0, s48, 114688
    s_lshr_b32 s58, s45, 15
    s_add_u32 s58, s58, 1
    s_bitcmp1_b32 s57, s58
    s_cbranch_scc1 L_tk_5
    s_mov_b32 s87, 0x40000
L_tl_5:
    buffer_load_dword v38, v35, s[24:27], s56 offen sc1
    s_waitcnt vmcnt(0)
    v_cmp_ne_u32 vcc, 0, v38
    s_or_b32 s57, s57, vcc_lo
    s_bitcmp1_b32 s57, s58
    s_cbranch_scc1 L_tj_5
    s_sub_u32 s87, s87, 1
    s_cbranch_scc0 L_tl_5
L_tj_5:
L_tk_5:
    buffer_load_dwordx4 v28, s[24:27], s45 offen offset:0 sc1 lds
    buffer_load_dwordx4 v28, s[24:27], s45 offen offset:1024 sc1 lds
    buffer_load_dwordx4 v28, s[24:27], s45 offen offset:2048 sc1 lds
    buffer_load_dwordx4 v28, s[24:27], s45 offen offset:3072 sc1 lds
    s_add_u32 s45, s45, 16384
    s_cmp_eq_u32 s45, 229376
    s_cselect_b32 s45, 0, s45
    s_barrier
    s_add_u32 m0, s48, 16384
    s_lshr_b32 s58, s46, 15
    s_add_u32 s58, s58, 9
    s_bitcmp1_b32 s57, s58
    s_cbranch_scc1 L_tk_6
    s_mov_b32 s87, 0x40000
L_tl_6:
    buffer_load_dword v38, v35, s[24:27], s56 offen sc1
    s_waitcnt vmcnt(0)
    v_cmp_ne_u32 vcc, 0, v38
    s_or_b32 s57, s57, vcc_lo
    s_bitcmp1_b32 s57, s58
    s_cbranch_scc1 L_tj_6
    s_sub_u32 s87, s87, 1
    s_cbranch_scc0 L_tl_6
L_tj_6:
L_tk_6:
    buffer_load_dwordx4 v29, s[24:27], s46 offen offset:0 sc1 lds
    buffer_load_dwordx4 v29, s[24:27], s46 offen offset:1024 sc1 lds
    buffer_load_dwordx4 v29, s[24:27], s46 offen offset:2048 sc1 lds
    buffer_load_dwordx4 v29, s[24:27], s46 offen offset:3072 sc1 lds
    s_add_u32 s46, s46, 16384
    s_cmp_eq_u32 s46, 229376
    s_cselect_b32 s46, 0, s46
    s_waitcnt vmcnt(24)
    s_barrier
    s_add_u32 m0, s48, 0
    s_lshl_b32 s44, s47, 3
    buffer_load_dwordx4 v20, s[68:71], s44 offen offset:0 lds
    buffer_load_dwordx4 v21, s[68:71], s44 offen offset:1024 lds
    buffer_load_dwordx4 v22, s[68:71], s44 offen offset:2048 lds
    buffer_load_dwordx4 v23, s[68:71], s44 offen offset:3072 lds
    s_add_u32 s47, s47, 16384
    s_cmp_eq_u32 s47, 229376
    s_cselect_b32 s47, 0, s47
    s_add_u32 m0, s48, 49152
    s_nop 0
    buffer_load_dwordx4 v28, s[24:27], s45 offen offset:0 sc1 lds
    buffer_load_dwordx4 v28, s[24:27], s45 offen offset:1024 sc1 lds
    buffer_load_dwordx4 v28, s[24:27], s45 offen offset:2048 sc1 lds
    buffer_load_dwordx4 v28, s[24:27], s45 offen offset:3072 sc1 lds
    s_add_u32 s45, s45, 16384
    s_cmp_eq_u32 s45, 229376
    s_cselect_b32 s45, 0, s45
    s_waitcnt vmcnt(28)
    s_waitcnt vmcnt(24)
    s_barrier
    s_add_u32 m0, s48, 131072
    s_nop 0
    buffer_load_dwordx4 v29, s[24:27], s46 offen offset:0 sc1 lds
    buffer_load_dwordx4 v29, s[24:27], s46 offen offset:1024 sc1 lds
    buffer_load_dwordx4 v29, s[24:27], s46 offen offset:2048 sc1 lds
    buffer_load_dwordx4 v29, s[24:27], s46 offen offset:3072 sc1 lds
    s_add_u32 s46, s46, 16384
    s_cmp_eq_u32 s46, 229376
    s_cselect_b32 s46, 0, s46
    s_waitcnt vmcnt(24)
    s_barrier
    s_add_u32 m0, s48, 32768
    s_lshl_b32 s44, s47, 3
    buffer_load_dwordx4 v20, s[68:71], s44 offen offset:0 lds
    buffer_load_dwordx4 v21, s[68:71], s44 offen offset:1024 lds
    buffer_load_dwordx4 v22, s[68:71], s44 offen offset:2048 lds
    buffer_load_dwordx4 v23, s[68:71], s44 offen offset:3072 lds
    s_add_u32 s47, s47, 16384
    s_cmp_eq_u32 s47, 229376
    s_cselect_b32 s47, 0, s47
    s_add_u32 m0, s48, 81920
    s_lshr_b32 s58, s45, 15
    s_add_u32 s58, s58, 1
    s_bitcmp1_b32 s57, s58
    s_cbranch_scc1 L_tk_7
    s_mov_b32 s87, 0x40000
L_tl_7:
    buffer_load_dword v38, v35, s[24:27], s56 offen sc1
    s_waitcnt vmcnt(0)
    v_cmp_ne_u32 vcc, 0, v38
    s_or_b32 s57, s57, vcc_lo
    s_bitcmp1_b32 s57, s58
    s_cbranch_scc1 L_tj_7
    s_sub_u32 s87, s87, 1
    s_cbranch_scc0 L_tl_7
L_tj_7:
L_tk_7:
    buffer_load_dwordx4 v28, s[24:27], s45 offen offset:0 sc1 lds
    buffer_load_dwordx4 v28, s[24:27], s45 offen offset:1024 sc1 lds
    buffer_load_dwordx4 v28, s[24:27], s45 offen offset:2048 sc1 lds
    buffer_load_dwordx4 v28, s[24:27], s45 offen offset:3072 sc1 lds
    s_add_u32 s45, s45, 16384
    s_cmp_eq_u32 s45, 229376
    s_cselect_b32 s45, 0, s45
    s_waitcnt vmcnt(28)
    s_waitcnt vmcnt(24)
    s_barrier
    s_add_u32 m0, s48, 65536
    s_lshr_b32 s58, s46, 15
    s_add_u32 s58, s58, 9
    s_bitcmp1_b32 s57, s58
    s_cbranch_scc1 L_tk_8
    s_mov_b32 s87, 0x40000
L_tl_8:
    buffer_load_dword v38, v35, s[24:27], s56 offen sc1
    s_waitcnt vmcnt(0)
    v_cmp_ne_u32 vcc, 0, v38
    s_or_b32 s57, s57, vcc_lo
    s_bitcmp1_b32 s57, s58
    s_cbranch_scc1 L_tj_8
    s_sub_u32 s87, s87, 1
    s_cbranch_scc0 L_tl_8
L_tj_8:
L_tk_8:
    buffer_load_dwordx4 v29, s[24:27], s46 offen offset:0 sc1 lds
    buffer_load_dwordx4 v29, s[24:27], s46 offen offset:1024 sc1 lds
    buffer_load_dwordx4 v29, s[24:27], s46 offen offset:2048 sc1 lds
    buffer_load_dwordx4 v29, s[24:27], s46 offen offset:3072 sc1 lds
    s_add_u32 s46, s46, 16384
    s_cmp_eq_u32 s46, 229376
    s_cselect_b32 s46, 0, s46
    s_waitcnt vmcnt(24)
    s_barrier
    s_add_u32 m0, s48, 98304
    s_lshl_b32 s44, s47, 3
    buffer_load_dwordx4 v20, s[68:71], s44 offen offset:0 lds
    buffer_load_dwordx4 v21, s[68:71], s44 offen offset:1024 lds
    buffer_load_dwordx4 v22, s[68:71], s44 offen offset:2048 lds
    buffer_load_dwordx4 v23, s[68:71], s44 offen offset:3072 lds
    s_add_u32 s47, s47, 16384
    s_cmp_eq_u32 s47, 229376
    s_cselect_b32 s47, 0, s47
    s_add_u32 m0, s48, 114688
    s_nop 0
    buffer_load_dwordx4 v28, s[24:27], s45 offen offset:0 sc1 lds
    buffer_load_dwordx4 v28, s[24:27], s45 offen offset:1024 sc1 lds
    buffer_load_dwordx4 v28, s[24:27], s45 offen offset:2048 sc1 lds
    buffer_load_dwordx4 v28, s[24:27], s45 offen offset:3072 sc1 lds
    s_add_u32 s45, s45, 16384
    s_cmp_eq_u32 s45, 229376
    s_cselect_b32 s45, 0, s45
    s_waitcnt vmcnt(28)
    s_waitcnt vmcnt(24)
    s_barrier
    s_add_u32 m0, s48, 16384
    s_nop 0
    buffer_load_dwordx4 v29, s[24:27], s46 offen offset:0 sc1 lds
    buffer_load_dwordx4 v29, s[24:27], s46 offen offset:1024 sc1 lds
    buffer_load_dwordx4 v29, s[24:27], s46 offen offset:2048 sc1 lds
    buffer_load_dwordx4 v29, s[24:27], s46 offen offset:3072 sc1 lds
    s_add_u32 s46, s46, 16384
    s_cmp_eq_u32 s46, 229376
    s_cselect_b32 s46, 0, s46
    s_waitcnt vmcnt(24)
L_p_join:
    s_barrier
    s_add_u32 m0, s48, 0
    s_lshl_b32 s44, s47, 3
    buffer_load_dwordx4 v20, s[68:71], s44 offen offset:0 lds
    buffer_load_dwordx4 v21, s[68:71], s44 offen offset:1024 lds
    buffer_load_dwordx4 v22, s[68:71], s44 offen offset:2048 lds
    buffer_load_dwordx4 v23, s[68:71], s44 offen offset:3072 lds
    s_add_u32 s47, s47, 16384
    s_cmp_eq_u32 s47, 229376
    s_cselect_b32 s47, 0, s47
    s_add_u32 m0, s48, 49152
    s_lshr_b32 s58, s45, 15
    s_add_u32 s58, s58, 1
    s_bitcmp1_b32 s57, s58
    s_cbranch_scc1 L_tk_9
    s_mov_b32 s87, 0x40000
L_tl_9:
    buffer_load_dword v38, v35, s[24:27], s56 offen sc1
    s_waitcnt vmcnt(0)
    v_cmp_ne_u32 vcc, 0, v38
    s_or_b32 s57, s57, vcc_lo
    s_bitcmp1_b32 s57, s58
    s_cbranch_scc1 L_tj_9
    s_sub_u32 s87, s87, 1
    s_cbranch_scc0 L_tl_9
L_tj_9:
L_tk_9:
    buffer_load_dwordx4 v28, s[24:27], s45 offen offset:0 sc1 lds
    buffer_load_dwordx4 v28, s[24:27], s45 offen offset:1024 sc1 lds
    buffer_load_dwordx4 v28, s[24:27], s45 offen offset:2048 sc1 lds
    buffer_load_dwordx4 v28, s[24:27], s45 offen offset:3072 sc1 lds
    s_add_u32 s45, s45, 16384
    s_cmp_eq_u32 s45, 229376
    s_cselect_b32 s45, 0, s45
    s_waitcnt vmcnt(28)
    s_waitcnt vmcnt(24)
    s_barrier
    s_add_u32 m0, s48, 131072
    s_lshl_b32 s44, s47, 3
    buffer_load_dwordx4 v20, s[68:71], s44 offen offset:0 lds
    buffer_load_dwordx4 v21, s[68:71], s44 offen offset:1024 lds
    buffer_load_dwordx4 v22, s[68:71], s44 offen offset:2048 lds
    buffer_load_dwordx4 v23, s[68:71], s44 offen offset:3072 lds
    s_add_u32 s47, s47, 16384
    s_cmp_eq_u32 s47, 229376
    s_cselect_b32 s47, 0, s47
    s_waitcnt vmcnt(24)
    s_barrier
    s_add_u32 m0, s48, 32768
    s_nop 0
    buffer_load_dwordx4 v28, s[24:27], s45 offen offset:0 sc1 lds
    buffer_load_dwordx4 v28, s[24:27], s45 offen offset:1024 sc1 lds
    buffer_load_dwordx4 v28, s[24:27], s45 offen offset:2048 sc1 lds
    buffer_load_dwordx4 v28, s[24:27], s45 offen offset:3072 sc1 lds
    s_add_u32 s45, s45, 16384
    s_cmp_eq_u32 s45, 229376
    s_cselect_b32 s45, 0, s45
    s_add_u32 m0, s48, 81920
    s_lshl_b32 s44, s47, 3
    buffer_load_dwordx4 v20, s[68:71], s44 offen offset:0 lds
    buffer_load_dwordx4 v21, s[68:71], s44 offen offset:1024 lds
    buffer_load_dwordx4 v22, s[68:71], s44 offen offset:2048 lds
    buffer_load_dwordx4 v23, s[68:71], s44 offen offset:3072 lds
    s_add_u32 s47, s47, 16384
    s_cmp_eq_u32 s47, 229376
    s_cselect_b32 s47, 0, s47
    s_waitcnt vmcnt(28)
    s_waitcnt vmcnt(24)
    s_barrier
    s_add_u32 m0, s48, 65536
    s_lshr_b32 s58, s45, 15
    s_add_u32 s58, s58, 1
    s_bitcmp1_b32 s57, s58
    s_cbranch_scc1 L_tk_10
    s_mov_b32 s87, 0x40000
L_tl_10:
    buffer_load_dword v38, v35, s[24:27], s56 offen sc1
    s_waitcnt vmcnt(0)
    v_cmp_ne_u32 vcc, 0, v38
    s_or_b32 s57, s57, vcc_lo
    s_bitcmp1_b32 s57, s58
    s_cbranch_scc1 L_tj_10
    s_sub_u32 s87, s87, 1
    s_cbranch_scc0 L_tl_10
L_tj_10:
L_tk_10:
    buffer_load_dwordx4 v28, s[24:27], s45 offen offset:0 sc1 lds
    buffer_load_dwordx4 v28, s[24:27], s45 offen offset:1024 sc1 lds
    buffer_load_dwordx4 v28, s[24:27], s45 offen offset:2048 sc1 lds
    buffer_load_dwordx4 v28, s[24:27], s45 offen offset:3072 sc1 lds
    s_add_u32 s45, s45, 16384
    s_cmp_eq_u32 s45, 229376
    s_cselect_b32 s45, 0, s45
    s_waitcnt vmcnt(24)
    s_barrier
    s_add_u32 m0, s48, 98304
    s_lshl_b32 s44, s47, 3
    buffer_load_dwordx4 v20, s[68:71], s44 offen offset:0 lds
    buffer_load_dwordx4 v21, s[68:71], s44 offen offset:1024 lds
    buffer_load_dwordx4 v22, s[68:71], s44 offen offset:2048 lds
    buffer_load_dwordx4 v23, s[68:71], s44 offen offset:3072 lds
    s_add_u32 s47, s47, 16384
    s_cmp_eq_u32 s47, 229376
    s_cselect_b32 s47, 0, s47
    s_add_u32 m0, s48, 114688
    s_nop 0
    buffer_load_dwordx4 v28, s[24:27], s45 offen offset:0 sc1 lds
    buffer_load_dwordx4 v28, s[24:27], s45 offen offset:1024 sc1 lds
    buffer_load_dwordx4 v28, s[24:27], s45 offen offset:2048 sc1 lds
    buffer_load_dwordx4 v28, s[24:27], s45 offen offset:3072 sc1 lds
    s_add_u32 s45, s45, 16384
    s_cmp_eq_u32 s45, 229376
    s_cselect_b32 s45, 0, s45
    s_waitcnt vmcnt(28)
    s_waitcnt vmcnt(24)
    s_barrier
    s_add_u32 m0, s48, 16384
    s_lshr_b32 s58, s46, 15
    s_add_u32 s58, s58, 9
    s_bitcmp1_b32 s57, s58
    s_cbranch_scc1 L_tk_11
    s_mov_b32 s87, 0x40000
L_tl_11:
    buffer_load_dword v38, v35, s[24:27], s56 offen sc1
    s_waitcnt vmcnt(0)
    v_cmp_ne_u32 vcc, 0, v38
    s_or_b32 s57, s57, vcc_lo
    s_bitcmp1_b32 s57, s58
    s_cbranch_scc1 L_tj_11
    s_sub_u32 s87, s87, 1
    s_cbranch_scc0 L_tl_11
L_tj_11:
L_tk_11:
    buffer_load_dwordx4 v29, s[24:27], s46 offen offset:0 sc1 lds
    buffer_load_dwordx4 v29, s[24:27], s46 offen offset:1024 sc1 lds
    buffer_load_dwordx4 v29, s[24:27], s46 offen offset:2048 sc1 lds
    buffer_load_dwordx4 v29, s[24:27], s46 offen offset:3072 sc1 lds
    s_add_u32 s46, s46, 16384
    s_cmp_eq_u32 s46, 229376
    s_cselect_b32 s46, 0, s46
    s_waitcnt vmcnt(24)
    s_waitcnt vmcnt(20)
    s_barrier
    s_add_u32 m0, s48, 49152
    s_nop 0
    buffer_load_dwordx4 v29, s[24:27], s46 offen offset:0 sc1 lds
    buffer_load_dwordx4 v29, s[24:27], s46 offen offset:1024 sc1 lds
    buffer_load_dwordx4 v29, s[24:27], s46 offen offset:2048 sc1 lds
    buffer_load_dwordx4 v29, s[24:27], s46 offen offset:3072 sc1 lds
    s_add_u32 s46, s46, 16384
    s_cmp_eq_u32 s46, 229376
    s_cselect_b32 s46, 0, s46
    s_waitcnt vmcnt(20)
    s_waitcnt vmcnt(16)
    s_barrier
    s_add_u32 m0, s48, 32768
    s_lshr_b32 s58, s46, 15
    s_add_u32 s58, s58, 9
    s_bitcmp1_b32 s57, s58
    s_cbranch_scc1 L_tk_12
    s_mov_b32 s87, 0x40000
L_tl_12:
    buffer_load_dword v38, v35, s[24:27], s56 offen sc1
    s_waitcnt vmcnt(0)
    v_cmp_ne_u32 vcc, 0, v38
    s_or_b32 s57, s57, vcc_lo
    s_bitcmp1_b32 s57, s58
    s_cbranch_scc1 L_tj_12
    s_sub_u32 s87, s87, 1
    s_cbranch_scc0 L_tl_12
L_tj_12:
L_tk_12:
    buffer_load_dwordx4 v29, s[24:27], s46 offen offset:0 sc1 lds
    buffer_load_dwordx4 v29, s[24:27], s46 offen offset:1024 sc1 lds
    buffer_load_dwordx4 v29, s[24:27], s46 offen offset:2048 sc1 lds
    buffer_load_dwordx4 v29, s[24:27], s46 offen offset:3072 sc1 lds
    s_add_u32 s46, s46, 16384
    s_cmp_eq_u32 s46, 229376
    s_cselect_b32 s46, 0, s46
    s_waitcnt vmcnt(16)
    s_waitcnt vmcnt(12)
    s_barrier
    s_add_u32 m0, s48, 65536
    s_nop 0
    buffer_load_dwordx4 v29, s[24:27], s46 offen offset:0 sc1 lds
    buffer_load_dwordx4 v29, s[24:27], s46 offen offset:1024 sc1 lds
    buffer_load_dwordx4 v29, s[24:27], s46 offen offset:2048 sc1 lds
    buffer_load_dwordx4 v29, s[24:27], s46 offen offset:3072 sc1 lds
    s_add_u32 s46, s46, 16384
    s_cmp_eq_u32 s46, 229376
    s_cselect_b32 s46, 0, s46
    s_waitcnt vmcnt(12)
    s_barrier
    s_waitcnt vmcnt(8)
    s_barrier
    s_waitcnt vmcnt(4)
    s_barrier
    s_waitcnt vmcnt(0)
    s_barrier
    s_barrier
    s_branch L_fin
L_special:
    v_and_b32 v2, 0x17, v1
    v_cmp_eq_u32 vcc, 0, v2
    s_nop 1
    v_cndmask_b32 v2, 0, 1, vcc
    v_lshrrev_b32 v4, 5, v0
    v_min_u32 v4, 1, v4
    v_lshlrev_b32 v3, 2, v1
    v_lshl_add_u32 v3, v4, 30, v3
    s_lshl_b32 s38, s37, 7
    s_add_u32 s38, s38, 21037056
    buffer_store_dword v2, v3, s[24:27], s38 offen sc1
    s_mov_b32 s40, s2
    s_lshr_b32 s41, s32, 1
    s_and_b32 s42, s41, 1
    s_and_b32 s43, s32, 1
    s_cmp_ge_u32 s32, 4
    s_cselect_b32 s12, s14, s12
    s_cselect_b32 s13, s15, s13
    s_mov_b32 s28, s12
    s_and_b32 s29, s13, 0xffff
    s_mov_b32 s30, 2097152
    s_mov_b32 s31, 0x00020000
    v_and_b32 v6, 31, v1
    v_lshrrev_b32 v2, 5, v1
    s_lshl_b32 s44, s40, 4
    s_lshl_b32 s45, s32, 1
    s_add_u32 s44, s44, s45
    v_add_u32 v2, s44, v2
    v_lshlrev_b32 v8, 11, v2
    v_cmp_eq_u32 s[56:57], 0, v2
    v_sub_u32 v9, 4194304, v8
    v_sub_u32 v10, 2097152, v8
    v_add_u32 v11, 2097152, v8
    v_mov_b32 v3, 1048576
    v_mov_b32 v4, 3145728
    v_cndmask_b32 v9, v9, v3, s[56:57]
    v_cndmask_b32 v11, v11, v4, s[56:57]
    v_lshlrev_b32 v2, 4, v6
    v_sub_u32 v3, 1008, v2
    v_cmp_eq_u32 s[58:59], 0, v6
    v_mov_b32 v4, 1073741824
    s_nop 0
    v_cndmask_b32 v4, v3, v4, s[58:59]
    v_mov_b32 v12, 0
    v_mov_b32 v13, 0
    v_mov_b32 v14, 0
    v_mov_b32 v15, 0
    v_mov_b32 v16, 0
    v_mov_b32 v17, 0
    v_mov_b32 v18, 0
    v_mov_b32 v19, 0
    v_add_u32 v22, v8, v2
    v_add_u32 v23, v8, v3
    buffer_load_dwordx4 v[64:67], v22, s[16:19], 0 offen
    buffer_load_dwordx4 v[72:75], v23, s[16:19], 0 offen
    buffer_load_dwordx4 v[76:79], v22, s[16:19], 0 offen offset:1024
    buffer_load_dwordx4 v[68:71], v23, s[16:19], 0 offen offset:1024
    v_add_u32 v24, v9, v2
    v_add_u32 v25, v9, v3
    buffer_load_dwordx4 v[80:83], v24, s[16:19], 0 offen
    buffer_load_dwordx4 v[88:91], v25, s[16:19], 0 offen
    buffer_load_dwordx4 v[92:95], v24, s[16:19], 0 offen offset:1024
    buffer_load_dwordx4 v[84:87], v25, s[16:19], 0 offen offset:1024
    v_add_u32 v22, v10, v2
    v_add_u32 v23, v10, v3
    buffer_load_dwordx4 v[96:99], v22, s[16:19], 0 offen
    buffer_load_dwordx4 v[104:107], v23, s[16:19], 0 offen
    buffer_load_dwordx4 v[108:111], v22, s[16:19], 0 offen offset:1024
    buffer_load_dwordx4 v[100:103], v23, s[16:19], 0 offen offset:1024
    v_add_u32 v24, v11, v2
    v_add_u32 v25, v11, v3
    buffer_load_dwordx4 v[112:115], v24, s[16:19], 0 offen
    buffer_load_dwordx4 v[120:123], v25, s[16:19], 0 offen
    buffer_load_dwordx4 v[124:127], v24, s[16:19], 0 offen offset:1024
    buffer_load_dwordx4 v[116:119], v25, s[16:19], 0 offen offset:1024
    v_add_u32 v22, v8, v4
    buffer_load_short_d16_hi v12, v22, s[16:19], 0 offen offset:1040
    buffer_load_short_d16_hi v13, v22, s[16:19], 0 offen offset:16
    v_add_u32 v23, v9, v4
    buffer_load_short_d16_hi v14, v23, s[16:19], 0 offen offset:1040
    buffer_load_short_d16_hi v15, v23, s[16:19], 0 offen offset:16
    v_add_u32 v22, v10, v4
    buffer_load_short_d16_hi v16, v22, s[16:19], 0 offen offset:1040
    buffer_load_short_d16_hi v17, v22, s[16:19], 0 offen offset:16
    v_add_u32 v23, v11, v4
    buffer_load_short_d16_hi v18, v23, s[16:19], 0 offen offset:1040
    buffer_load_short_d16_hi v19, v23, s[16:19], 0 offen offset:16
    v_lshrrev_b32 v2, 3, v1
    v_lshlrev_b32 v2, 12, v2
    v_and_b32 v3, 7, v1
    v_lshrrev_b32 v4, 4, v1
    v_xor_b32 v3, v3, v4
    v_lshl_add_u32 v20, v3, 4, v2
    v_xor_b32 v21, 64, v20
    v_add_u32 v21, 32768, v21
    s_bfe_u32 s62, s40, 0x10003
    s_lshl1_add_u32 s62, s43, s62
    s_lshl_b32 s47, s62, 6
    s_add_u32 s47, s47, s42
    s_lshl_b32 s47, s47, 11
    s_lshl_b32 s44, s32, 13
    s_add_u32 s50, s44, 69888
    s_add_u32 s51, s44, 73984
    s_mov_b32 s52, s44
    s_add_u32 s53, s44, 4096
    v_lshlrev_b32 v2, 12, v6
    v_lshrrev_b32 v3, 5, v1
    v_lshl_add_u32 v2, v3, 30, v2
    s_lshl_b32 s44, s42, 11
    buffer_load_ushort v28, v2, s[28:31], s44 offen offset:512
    v_mov_b32 v29, 0
    v_mov_b32 v30, 0
    v_mov_b32 v31, 0
    s_lshl_b32 s44, s32, 10
    s_add_u32 m0, s44, 135424
    v_lshlrev_b32 v2, 4, v1
    s_mov_b32 s44, 524288
    buffer_load_dwordx4 v2, s[28:31], s44 offen lds
    s_mov_b32 s54, 0x3f803f80
    v_mov_b32 v32, 0
    v_mov_b32 v33, 0
    v_mov_b32 v34, 0
    v_mov_b32 v35, 0
    v_mov_b32 v36, 0
    v_mov_b32 v37, 0
    v_mov_b32 v38, 0
    v_mov_b32 v39, 0
    s_waitcnt vmcnt(18)
    s_add_u32 m0, s50, 0
    s_add_u32 s44, s47, 0
    buffer_load_dwordx4 v20, s[28:31], s44 offen lds
    s_add_u32 m0, s50, 1024
    s_add_u32 s44, s47, 0
    buffer_load_dwordx4 v21, s[28:31], s44 offen lds
    s_add_u32 m0, s50, 2048
    s_add_u32 s44, s47, 65536
    buffer_load_dwordx4 v20, s[28:31], s44 offen lds
    s_add_u32 m0, s50, 3072
    s_add_u32 s44, s47, 65536
    buffer_load_dwordx4 v21, s[28:31], s44 offen lds
    v_dot2c_f32_bf16 v32, s54, v64
    v_dot2c_f32_bf16 v33, v64, v64
    v_dot2c_f32_bf16 v34, s54, v80
    v_dot2c_f32_bf16 v35, v80, v80
    v_dot2c_f32_bf16 v32, s54, v65
    v_dot2c_f32_bf16 v33, v65, v65
    v_dot2c_f32_bf16 v34, s54, v81
    v_dot2c_f32_bf16 v35, v81, v81
    v_dot2c_f32_bf16 v32, s54, v66
    v_dot2c_f32_bf16 v33, v66, v66
    v_dot2c_f32_bf16 v34, s54, v82
    v_dot2c_f32_bf16 v35, v82, v82
    v_dot2c_f32_bf16 v32, s54, v67
    v_dot2c_f32_bf16 v33, v67, v67
    v_dot2c_f32_bf16 v34, s54, v83
    v_dot2c_f32_bf16 v35, v83, v83
    v_dot2c_f32_bf16 v32, s54, v68
    v_dot2c_f32_bf16 v33, v68, v68
    v_dot2c_f32_bf16 v34, s54, v84
    v_dot2c_f32_bf16 v35, v84, v84
    v_dot2c_f32_bf16 v32, s54, v69
    v_dot2c_f32_bf16 v33, v69, v69
    v_dot2c_f32_bf16 v34, s54, v85
    v_dot2c_f32_bf16 v35, v85, v85
    v_dot2c_f32_bf16 v32, s54, v70
    v_dot2c_f32_bf16 v33, v70, v70
    v_dot2c_f32_bf16 v34, s54, v86
    v_dot2c_f32_bf16 v35, v86, v86
    v_dot2c_f32_bf16 v32, s54, v71
    v_dot2c_f32_bf16 v33, v71, v71
    v_dot2c_f32_bf16 v34, s54, v87
    v_dot2c_f32_bf16 v35, v87, v87
    v_dot2c_f32_bf16 v32, s54, v72
    v_dot2c_f32_bf16 v33, v72, v72
    v_dot2c_f32_bf16 v34, s54, v88
    v_dot2c_f32_bf16 v35, v88, v88
    v_dot2c_f32_bf16 v32, s54, v73
    v_dot2c_f32_bf16 v33, v73, v73
    v_dot2c_f32_bf16 v34, s54, v89
    v_dot2c_f32_bf16 v35, v89, v89
    v_dot2c_f32_bf16 v32, s54, v74
    v_dot2c_f32_bf16 v33, v74, v74
    v_dot2c_f32_bf16 v34, s54, v90
    v_dot2c_f32_bf16 v35, v90, v90
    v_dot2c_f32_bf16 v32, s54, v75
    v_dot2c_f32_bf16 v33, v75, v75
    v_dot2c_f32_bf16 v34, s54, v91
    v_dot2c_f32_bf16 v35, v91, v91
    v_dot2c_f32_bf16 v32, s54, v76
    v_dot2c_f32_bf16 v33, v76, v76
    v_dot2c_f32_bf16 v34, s54, v92
    v_dot2c_f32_bf16 v35, v92, v92
    v_dot2c_f32_bf16 v32, s54, v77
    v_dot2c_f32_bf16 v33, v77, v77
    v_dot2c_f32_bf16 v34, s54, v93
    v_dot2c_f32_bf16 v35, v93, v93
    v_dot2c_f32_bf16 v32, s54, v78
    v_dot2c_f32_bf16 v33, v78, v78
    v_dot2c_f32_bf16 v34, s54, v94
    v_dot2c_f32_bf16 v35, v94, v94
    v_dot2c_f32_bf16 v32, s54, v79
    v_dot2c_f32_bf16 v33, v79, v79
    v_dot2c_f32_bf16 v34, s54, v95
    v_dot2c_f32_bf16 v35, v95, v95
    s_waitcnt vmcnt(14)
    s_add_u32 m0, s51, 0
    s_add_u32 s44, s47, 128
    buffer_load_dwordx4 v20, s[28:31], s44 offen lds
    s_add_u32 m0, s51, 1024
    s_add_u32 s44, s47, 128
    buffer_load_dwordx4 v21, s[28:31], s44 offen lds
    s_add_u32 m0, s51, 2048
    s_add_u32 s44, s47, 65664
    buffer_load_dwordx4 v20, s[28:31], s44 offen lds
    s_add_u32 m0, s51, 3072
    s_add_u32 s44, s47, 65664
    buffer_load_dwordx4 v21, s[28:31], s44 offen lds
    v_dot2c_f32_bf16 v36, s54, v96
    v_dot2c_f32_bf16 v37, v96, v96
    v_dot2c_f32_bf16 v38, s54, v112
    v_dot2c_f32_bf16 v39, v112, v112
    v_dot2c_f32_bf16 v36, s54, v97
    v_dot2c_f32_bf16 v37, v97, v97
    v_dot2c_f32_bf16 v38, s54, v113
    v_dot2c_f32_bf16 v39, v113, v113
    v_dot2c_f32_bf16 v36, s54, v98
    v_dot2c_f32_bf16 v37, v98, v98
    v_dot2c_f32_bf16 v38, s54, v114
    v_dot2c_f32_bf16 v39, v114, v114
    v_dot2c_f32_bf16 v36, s54, v99
    v_dot2c_f32_bf16 v37, v99, v99
    v_dot2c_f32_bf16 v38, s54, v115
    v_dot2c_f32_bf16 v39, v115, v115
    v_dot2c_f32_bf16 v36, s54, v100
    v_dot2c_f32_bf16 v37, v100, v100
    v_dot2c_f32_bf16 v38, s54, v116
    v_dot2c_f32_bf16 v39, v116, v116
    v_dot2c_f32_bf16 v36, s54, v101
    v_dot2c_f32_bf16 v37, v101, v101
    v_dot2c_f32_bf16 v38, s54, v117
    v_dot2c_f32_bf16 v39, v117, v117
    v_dot2c_f32_bf16 v36, s54, v102
    v_dot2c_f32_bf16 v37, v102, v102
    v_dot2c_f32_bf16 v38, s54, v118
    v_dot2c_f32_bf16 v39, v118, v118
    v_dot2c_f32_bf16 v36, s54, v103
    v_dot2c_f32_bf16 v37, v103, v103
    v_dot2c_f32_bf16 v38, s54, v119
    v_dot2c_f32_bf16 v39, v119, v119
    v_dot2c_f32_bf16 v36, s54, v104
    v_dot2c_f32_bf16 v37, v104, v104
    v_dot2c_f32_bf16 v38, s54, v120
    v_dot2c_f32_bf16 v39, v120, v120
    v_dot2c_f32_bf16 v36, s54, v105
    v_dot2c_f32_bf16 v37, v105, v105
    v_dot2c_f32_bf16 v38, s54, v121
    v_dot2c_f32_bf16 v39, v121, v121
    v_dot2c_f32_bf16 v36, s54, v106
    v_dot2c_f32_bf16 v37, v106, v106
    v_dot2c_f32_bf16 v38, s54, v122
    v_dot2c_f32_bf16 v39, v122, v122
    v_dot2c_f32_bf16 v36, s54, v107
    v_dot2c_f32_bf16 v37, v107, v107
    v_dot2c_f32_bf16 v38, s54, v123
    v_dot2c_f32_bf16 v39, v123, v123
    v_dot2c_f32_bf16 v36, s54, v108
    v_dot2c_f32_bf16 v37, v108, v108
    v_dot2c_f32_bf16 v38, s54, v124
    v_dot2c_f32_bf16 v39, v124, v124
    v_dot2c_f32_bf16 v36, s54, v109
    v_dot2c_f32_bf16 v37, v109, v109
    v_dot2c_f32_bf16 v38, s54, v125
    v_dot2c_f32_bf16 v39, v125, v125
    v_dot2c_f32_bf16 v36, s54, v110
    v_dot2c_f32_bf16 v37, v110, v110
    v_dot2c_f32_bf16 v38, s54, v126
    v_dot2c_f32_bf16 v39, v126, v126
    v_dot2c_f32_bf16 v36, s54, v111
    v_dot2c_f32_bf16 v37, v111, v111
    v_dot2c_f32_bf16 v38, s54, v127
    v_dot2c_f32_bf16 v39, v127, v127
    v_add_f32_dpp v32, v32, v32 row_ror:8 row_mask:0xf bank_mask:0xf
    v_add_f32_dpp v33, v33, v33 row_ror:8 row_mask:0xf bank_mask:0xf
    v_add_f32_dpp v34, v34, v34 row_ror:8 row_mask:0xf bank_mask:0xf
    v_add_f32_dpp v35, v35, v35 row_ror:8 row_mask:0xf bank_mask:0xf
    v_add_f32_dpp v36, v36, v36 row_ror:8 row_mask:0xf bank_mask:0xf
    v_add_f32_dpp v37, v37, v37 row_ror:8 row_mask:0xf bank_mask:0xf
    v_add_f32_dpp v38, v38, v38 row_ror:8 row_mask:0xf bank_mask:0xf
    v_add_f32_dpp v39, v39, v39 row_ror:8 row_mask:0xf bank_mask:0xf
    v_add_f32_dpp v32, v32, v32 row_ror:4 row_mask:0xf bank_mask:0xf
    v_add_f32_dpp v33, v33, v33 row_ror:4 row_mask:0xf bank_mask:0xf
    v_add_f32_dpp v34, v34, v34 row_ror:4 row_mask:0xf bank_mask:0xf
    v_add_f32_dpp v35, v35, v35 row_ror:4 row_mask:0xf bank_mask:0xf
    v_add_f32_dpp v36, v36, v36 row_ror:4 row_mask:0xf bank_mask:0xf
    v_add_f32_dpp v37, v37, v37 row_ror:4 row_mask:0xf bank_mask:0xf
    v_add_f32_dpp v38, v38, v38 row_ror:4 row_mask:0xf bank_mask:0xf
    v_add_f32_dpp v39, v39, v39 row_ror:4 row_mask:0xf bank_mask:0xf
    v_add_f32_dpp v32, v32, v32 row_ror:2 row_mask:0xf bank_mask:0xf
    v_add_f32_dpp v33, v33, v33 row_ror:2 row_mask:0xf bank_mask:0xf
    v_add_f32_dpp v34, v34, v34 row_ror:2 row_mask:0xf bank_mask:0xf
    v_add_f32_dpp v35, v35, v35 row_ror:2 row_mask:0xf bank_mask:0xf
    v_add_f32_dpp v36, v36, v36 row_ror:2 row_mask:0xf bank_mask:0xf
    v_add_f32_dpp v37, v37, v37 row_ror:2 row_mask:0xf bank_mask:0xf
    v_add_f32_dpp v38, v38, v38 row_ror:2 row_mask:0xf bank_mask:0xf
    v_add_f32_dpp v39, v39, v39 row_ror:2 row_mask:0xf bank_mask:0xf
    v_add_f32_dpp v32, v32, v32 row_ror:1 row_mask:0xf bank_mask:0xf
    v_add_f32_dpp v33, v33, v33 row_ror:1 row_mask:0xf bank_mask:0xf
    v_add_f32_dpp v34, v34, v34 row_ror:1 row_mask:0xf bank_mask:0xf
    v_add_f32_dpp v35, v35, v35 row_ror:1 row_mask:0xf bank_mask:0xf
    v_add_f32_dpp v36, v36, v36 row_ror:1 row_mask:0xf bank_mask:0xf
    v_add_f32_dpp v37, v37, v37 row_ror:1 row_mask:0xf bank_mask:0xf
    v_add_f32_dpp v38, v38, v38 row_ror:1 row_mask:0xf bank_mask:0xf
    v_add_f32_dpp v39, v39, v39 row_ror:1 row_mask:0xf bank_mask:0xf
    v_mov_b32 v40, v32
    v_mov_b32 v41, v33
    v_mov_b32 v42, v34
    v_mov_b32 v43, v35
    v_mov_b32 v44, v36
    v_mov_b32 v45, v37
    v_mov_b32 v46, v38
    v_mov_b32 v47, v39
    v_permlane16_swap_b32 v32, v40
    v_permlane16_swap_b32 v33, v41
    v_permlane16_swap_b32 v34, v42
    v_permlane16_swap_b32 v35, v43
    v_permlane16_swap_b32 v36, v44
    v_permlane16_swap_b32 v37, v45
    v_permlane16_swap_b32 v38, v46
    v_permlane16_swap_b32 v39, v47
    v_add_f32 v32, v32, v40
    v_add_f32 v33, v33, v41
    v_add_f32 v34, v34, v42
    v_add_f32 v35, v35, v43
    v_add_f32 v36, v36, v44
    v_add_f32 v37, v37, v45
    v_add_f32 v38, v38, v46
    v_add_f32 v39, v39, v47
    v_mul_f32 v32, 0.0009765625, v32
    v_mul_f32 v33, 0.0009765625, v33
    v_mul_f32 v34, 0.0009765625, v34
    v_mul_f32 v35, 0.0009765625, v35
    v_mul_f32 v36, 0.0009765625, v36
    v_mul_f32 v37, 0.0009765625, v37
    v_mul_f32 v38, 0.0009765625, v38
    v_mul_f32 v39, 0.0009765625, v39
    v_fma_f32 v33, -v32, v32, v33
    v_fma_f32 v35, -v34, v34, v35
    v_fma_f32 v37, -v36, v36, v37
    v_fma_f32 v39, -v38, v38, v39
    v_max_f32 v33, 0, v33
    v_max_f32 v35, 0, v35
    v_max_f32 v37, 0, v37
    v_max_f32 v39, 0, v39
    v_cvt_pk_bf16_f32 v33, v33, v33
    v_cvt_pk_bf16_f32 v35, v35, v35
    v_cvt_pk_bf16_f32 v37, v37, v37
    v_cvt_pk_bf16_f32 v39, v39, v39
    v_and_b32 v33, 0xffff0000, v33
    v_and_b32 v35, 0xffff0000, v35
    v_and_b32 v37, 0xffff0000, v37
    v_and_b32 v39, 0xffff0000, v39
    v_add_f32 v33, 0x3727c5ac, v33
    v_add_f32 v35, 0x3727c5ac, v35
    v_add_f32 v37, 0x3727c5ac, v37
    v_add_f32 v39, 0x3727c5ac, v39
    v_cvt_pk_bf16_f32 v33, v33, v33
    v_cvt_pk_bf16_f32 v35, v35, v35
    v_cvt_pk_bf16_f32 v37, v37, v37
    v_cvt_pk_bf16_f32 v39, v39, v39
    v_and_b32 v33, 0xffff0000, v33
    v_and_b32 v35, 0xffff0000, v35
    v_and_b32 v37, 0xffff0000, v37
    v_and_b32 v39, 0xffff0000, v39
    v_sqrt_f32 v33, v33
    v_sqrt_f32 v35, v35
    v_sqrt_f32 v37, v37
    v_sqrt_f32 v39, v39
    v_cvt_pk_bf16_f32 v40, v32, v32
    v_cvt_pk_bf16_f32 v42, v34, v34
    v_cvt_pk_bf16_f32 v44, v36, v36
    v_cvt_pk_bf16_f32 v46, v38, v38
    v_cvt_pk_bf16_f32 v33, v33, v33
    v_cvt_pk_bf16_f32 v35, v35, v35
    v_cvt_pk_bf16_f32 v37, v37, v37
    v_cvt_pk_bf16_f32 v39, v39, v39
    v_and_b32 v33, 0xffff0000, v33
    v_and_b32 v35, 0xffff0000, v35
    v_and_b32 v37, 0xffff0000, v37
    v_and_b32 v39, 0xffff0000, v39
    v_rcp_f32 v41, v33
    v_rcp_f32 v43, v35
    v_rcp_f32 v45, v37
    v_rcp_f32 v47, v39
    v_and_b32 v48, 0xffff0000, v40
    v_lshrrev_b32 v8, 8, v8
    v_and_b32 v49, 0xffff0000, v42
    v_lshrrev_b32 v9, 8, v9
    v_and_b32 v50, 0xffff0000, v44
    v_lshrrev_b32 v10, 8, v10
    v_and_b32 v51, 0xffff0000, v46
    v_lshrrev_b32 v11, 8, v11
    s_mov_b32 s45, 20971520
    s_mov_b64 exec, s[58:59]
    buffer_store_dwordx2 v[40:41], v8, s[24:27], s45 offen sc1
    buffer_store_dwordx2 v[42:43], v9, s[24:27], s45 offen sc1
    buffer_store_dwordx2 v[44:45], v10, s[24:27], s45 offen sc1
    buffer_store_dwordx2 v[46:47], v11, s[24:27], s45 offen sc1
    s_mov_b64 exec, -1
    v_mov_b32 v52, v41
    v_cndmask_b32 v53, v43, 0, s[56:57]
    v_mov_b32 v54, v45
    v_cndmask_b32 v55, v47, 0, s[56:57]
    v_cndmask_b32 v56, v41, 0, s[56:57]
    v_cndmask_b32 v57, -v43, v43, s[56:57]
    v_cndmask_b32 v58, v45, 0, s[56:57]
    v_xor_b32 v59, 0x80000000, v47
    v_mul_f32 v33, v52, v48
    v_mul_f32 v35, v54, v50
    v_mul_f32 v37, v43, v49
    v_fmac_f32 v33, v53, v49
    v_fmac_f32 v35, v55, v51
    v_fmac_f32 v37, v47, v51
    v_mul_f32 v60, -2.0, v33
    v_mul_f32 v61, -2.0, v35
    v_mul_f32 v62, -2.0, v37
    v_mov_b32 v38, 0
    v_mov_b32 v39, 0
    v_mul_f32 v33, -4.0, v33
    v_mul_f32 v35, -4.0, v35
    v_mul_f32 v37, -4.0, v37
    v_cndmask_b32 v32, v33, v60, s[58:59]
    v_cndmask_b32 v34, v35, v61, s[58:59]
    v_cndmask_b32 v36, v37, v62, s[58:59]
    s_waitcnt vmcnt(20)
    v_lshlrev_b32 v128, 16, v64
    v_lshlrev_b32 v156, 16, v76
    v_lshlrev_b32 v144, 16, v68
    v_lshlrev_b32 v154, 16, v72
    v_and_b32 v129, 0xffff0000, v64
    v_and_b32 v157, 0xffff0000, v76
    v_and_b32 v143, 0xffff0000, v68
    v_and_b32 v153, 0xffff0000, v72
    v_lshlrev_b32 v130, 16, v65
    v_lshlrev_b32 v158, 16, v77
    v_lshlrev_b32 v142, 16, v69
    v_lshlrev_b32 v152, 16, v73
    v_and_b32 v131, 0xffff0000, v65
    v_and_b32 v159, 0xffff0000, v77
    v_and_b32 v141, 0xffff0000, v69
    v_and_b32 v151, 0xffff0000, v73
    v_lshlrev_b32 v132, 16, v66
    v_lshlrev_b32 v160, 16, v78
    v_lshlrev_b32 v140, 16, v70
    v_lshlrev_b32 v150, 16, v74
    v_and_b32 v133, 0xffff0000, v66
    v_and_b32 v161, 0xffff0000, v78
    v_and_b32 v139, 0xffff0000, v70
    v_and_b32 v149, 0xffff0000, v74
    v_lshlrev_b32 v134, 16, v67
    v_lshlrev_b32 v162, 16, v79
    v_lshlrev_b32 v138, 16, v71
    v_lshlrev_b32 v148, 16, v75
    v_and_b32 v135, 0xffff0000, v67
    v_and_b32 v163, 0xffff0000, v79
    v_and_b32 v137, 0xffff0000, v71
    v_and_b32 v147, 0xffff0000, v75
    v_mov_b32 v136, v12
    v_mov_b32 v146, v13
    v_pk_add_f32 v[244:245], v[128:129], v[136:137]
    v_pk_add_f32 v[246:247], v[146:147], v[156:157]
    v_pk_add_f32 v[248:249], v[128:129], v[136:137] neg_lo:[0,1] neg_hi:[0,1]
    v_pk_add_f32 v[250:251], v[146:147], v[156:157] neg_lo:[0,1] neg_hi:[0,1]
    v_pk_add_f32 v[128:129], v[244:245], v[246:247]
    v_pk_add_f32 v[136:137], v[244:245], v[246:247] neg_lo:[0,1] neg_hi:[0,1]
    v_pk_add_f32 v[146:147], v[248:249], v[250:251] neg_lo:[0,1] neg_hi:[0,1]
    v_pk_add_f32 v[156:157], v[248:249], v[250:251]
    v_pk_fma_f32 v[164:165], v[128:129], v[52:53], v[32:33] op_sel:[0,0,0] op_sel_hi:[1,0,1]
    v_pk_mul_f32 v[172:173], v[136:137], v[52:53] op_sel:[0,0] op_sel_hi:[1,0]
    v_pk_mul_f32 v[180:181], v[146:147], v[56:57] op_sel:[0,0] op_sel_hi:[1,0]
    v_pk_mul_f32 v[188:189], v[156:157], v[56:57] op_sel:[0,0] op_sel_hi:[1,0]
    v_pk_add_f32 v[244:245], v[130:131], v[138:139]
    v_pk_add_f32 v[246:247], v[148:149], v[158:159]
    v_pk_add_f32 v[248:249], v[130:131], v[138:139] neg_lo:[0,1] neg_hi:[0,1]
    v_pk_add_f32 v[250:251], v[148:149], v[158:159] neg_lo:[0,1] neg_hi:[0,1]
    v_pk_add_f32 v[130:131], v[244:245], v[246:247]
    v_pk_add_f32 v[138:139], v[244:245], v[246:247] neg_lo:[0,1] neg_hi:[0,1]
    v_pk_add_f32 v[148:149], v[248:249], v[250:251] neg_lo:[0,1] neg_hi:[0,1]
    v_pk_add_f32 v[158:159], v[248:249], v[250:251]
    v_pk_fma_f32 v[166:167], v[130:131], v[52:53], v[32:33] op_sel:[0,0,1] op_sel_hi:[1,0,1]
    v_pk_mul_f32 v[174:175], v[138:139], v[52:53] op_sel:[0,0] op_sel_hi:[1,0]
    v_pk_mul_f32 v[182:183], v[148:149], v[56:57] op_sel:[0,0] op_sel_hi:[1,0]
    v_pk_mul_f32 v[190:191], v[158:159], v[56:57] op_sel:[0,0] op_sel_hi:[1,0]
    v_pk_add_f32 v[244:245], v[132:133], v[140:141]
    v_pk_add_f32 v[246:247], v[150:151], v[160:161]
    v_pk_add_f32 v[248:249], v[132:133], v[140:141] neg_lo:[0,1] neg_hi:[0,1]
    v_pk_add_f32 v[250:251], v[150:151], v[160:161] neg_lo:[0,1] neg_hi:[0,1]
    v_pk_add_f32 v[132:133], v[244:245], v[246:247]
    v_pk_add_f32 v[140:141], v[244:245], v[246:247] neg_lo:[0,1] neg_hi:[0,1]
    v_pk_add_f32 v[150:151], v[248:249], v[250:251] neg_lo:[0,1] neg_hi:[0,1]
    v_pk_add_f32 v[160:161], v[248:249], v[250:251]
    v_pk_fma_f32 v[168:169], v[132:133], v[52:53], v[32:33] op_sel:[0,0,1] op_sel_hi:[1,0,1]
    v_pk_mul_f32 v[176:177], v[140:141], v[52:53] op_sel:[0,0] op_sel_hi:[1,0]
    v_pk_mul_f32 v[184:185], v[150:151], v[56:57] op_sel:[0,0] op_sel_hi:[1,0]
    v_pk_mul_f32 v[192:193], v[160:161], v[56:57] op_sel:[0,0] op_sel_hi:[1,0]
    v_pk_add_f32 v[244:245], v[134:135], v[142:143]
    v_pk_add_f32 v[246:247], v[152:153], v[162:163]
    v_pk_add_f32 v[248:249], v[134:135], v[142:143] neg_lo:[0,1] neg_hi:[0,1]
    v_pk_add_f32 v[250:251], v[152:153], v[162:163] neg_lo:[0,1] neg_hi:[0,1]
    v_pk_add_f32 v[134:135], v[244:245], v[246:247]
    v_pk_add_f32 v[142:143], v[244:245], v[246:247] neg_lo:[0,1] neg_hi:[0,1]
    v_pk_add_f32 v[152:153], v[248:249], v[250:251] neg_lo:[0,1] neg_hi:[0,1]
    v_pk_add_f32 v[162:163], v[248:249], v[250:251]
    v_pk_fma_f32 v[170:171], v[134:135], v[52:53], v[32:33] op_sel:[0,0,1] op_sel_hi:[1,0,1]
    v_pk_mul_f32 v[178:179], v[142:143], v[52:53] op_sel:[0,0] op_sel_hi:[1,0]
    v_pk_mul_f32 v[186:187], v[152:153], v[56:57] op_sel:[0,0] op_sel_hi:[1,0]
    v_pk_mul_f32 v[194:195], v[162:163], v[56:57] op_sel:[0,0] op_sel_hi:[1,0]
    v_add_f32 v244, v154, v144
    v_sub_f32 v245, v154, v144
    v_fmac_f32 v60, v52, v244
    v_fmac_f32 v38, v56, v245
    s_waitcnt vmcnt(0)
    s_barrier
    s_cmp_lg_u32 s32, 0
    s_cbranch_scc1 L_k1s_noflag
    s_lshl_b32 s44, s40, 2
    v_mov_b32 v2, s44
    v_mov_b32 v3, 1
    s_mov_b64 exec, 1
    buffer_store_dword v3, v2, s[64:67], 0 offen sc1
    s_mov_b64 exec, -1
L_k1s_noflag:
    s_and_b32 s84, s32, 3
    s_lshl2_add_u32 s84, s35, s84
    s_lshl1_add_u32 s84, s84, s34
    s_mul_i32 s84, s84, 28
    v_lshrrev_b32 v2, 1, v1
    v_add_u32 v2, s84, v2
    v_mul_u32_u24 v2, 2048, v2
    v_and_b32 v3, 1, v1
    v_lshl_add_u32 v2, v3, 7, v2
    v_add_u32 v3, 8, v1
    v_lshrrev_b32 v3, 6, v3
    v_lshl_add_u32 v253, v3, 30, v2
    s_mul_i32 s85, s33, 7168
    s_add_u32 s85, s85, s36
    s_lshl_b32 s85, s85, 8
    s_cmp_ge_u32 s32, 4
    s_cbranch_scc1 L_nopf
    buffer_load_dword v252, v253, s[68:71], s85 offen
L_nopf:
    v_lshlrev_b32 v128, 16, v80
    v_lshlrev_b32 v156, 16, v92
    v_lshlrev_b32 v144, 16, v84
    v_lshlrev_b32 v154, 16, v88
    v_and_b32 v129, 0xffff0000, v80
    v_and_b32 v157, 0xffff0000, v92
    v_and_b32 v143, 0xffff0000, v84
    v_and_b32 v153, 0xffff0000, v88
    v_lshlrev_b32 v130, 16, v81
    v_lshlrev_b32 v158, 16, v93
    v_lshlrev_b32 v142, 16, v85
    v_lshlrev_b32 v152, 16, v89
    v_and_b32 v131, 0xffff0000, v81
    v_and_b32 v159, 0xffff0000, v93
    v_and_b32 v141, 0xffff0000, v85
    v_and_b32 v151, 0xffff0000, v89
    v_lshlrev_b32 v132, 16, v82
    v_lshlrev_b32 v160, 16, v94
    v_lshlrev_b32 v140, 16, v86
    v_lshlrev_b32 v150, 16, v90
    v_and_b32 v133, 0xffff0000, v82
    v_and_b32 v161, 0xffff0000, v94
    v_and_b32 v139, 0xffff0000, v86
    v_and_b32 v149, 0xffff0000, v90
    v_lshlrev_b32 v134, 16, v83
    v_lshlrev_b32 v162, 16, v95
    v_lshlrev_b32 v138, 16, v87
    v_lshlrev_b32 v148, 16, v91
    v_and_b32 v135, 0xffff0000, v83
    v_and_b32 v163, 0xffff0000, v95
    v_and_b32 v137, 0xffff0000, v87
    v_and_b32 v147, 0xffff0000, v91
    v_mov_b32 v136, v14
    v_mov_b32 v146, v15
    v_pk_add_f32 v[244:245], v[128:129], v[136:137]
    v_pk_add_f32 v[246:247], v[146:147], v[156:157]
    v_pk_add_f32 v[248:249], v[128:129], v[136:137] neg_lo:[0,1] neg_hi:[0,1]
    v_pk_add_f32 v[250:251], v[146:147], v[156:157] neg_lo:[0,1] neg_hi:[0,1]
    v_pk_add_f32 v[128:129], v[244:245], v[246:247]
    v_pk_add_f32 v[136:137], v[244:245], v[246:247] neg_lo:[0,1] neg_hi:[0,1]
    v_pk_add_f32 v[146:147], v[248:249], v[250:251] neg_lo:[0,1] neg_hi:[0,1]
    v_pk_add_f32 v[156:157], v[248:249], v[250:251]
    v_pk_fma_f32 v[164:165], v[128:129], v[52:53], v[164:165] op_sel:[0,1,0] op_sel_hi:[1,1,1]
    v_pk_fma_f32 v[172:173], v[136:137], v[52:53], v[172:173] op_sel:[0,1,0] op_sel_hi:[1,1,1]
    v_pk_fma_f32 v[180:181], v[146:147], v[56:57], v[180:181] op_sel:[0,1,0] op_sel_hi:[1,1,1]
    v_pk_fma_f32 v[188:189], v[156:157], v[56:57], v[188:189] op_sel:[0,1,0] op_sel_hi:[1,1,1]
    v_pk_fma_f32 v[228:229], v[128:129], v[42:43], v[36:37] op_sel:[0,1,0] op_sel_hi:[1,1,1]
    v_pk_mul_f32 v[236:237], v[136:137], v[42:43] op_sel:[0,1] op_sel_hi:[1,1]
    v_pk_add_f32 v[244:245], v[130:131], v[138:139]
    v_pk_add_f32 v[246:247], v[148:149], v[158:159]
    v_pk_add_f32 v[248:249], v[130:131], v[138:139] neg_lo:[0,1] neg_hi:[0,1]
    v_pk_add_f32 v[250:251], v[148:149], v[158:159] neg_lo:[0,1] neg_hi:[0,1]
    v_pk_add_f32 v[130:131], v[244:245], v[246:247]
    v_pk_add_f32 v[138:139], v[244:245], v[246:247] neg_lo:[0,1] neg_hi:[0,1]
    v_pk_add_f32 v[148:149], v[248:249], v[250:251] neg_lo:[0,1] neg_hi:[0,1]
    v_pk_add_f32 v[158:159], v[248:249], v[250:251]
    v_pk_fma_f32 v[166:167], v[130:131], v[52:53], v[166:167] op_sel:[0,1,0] op_sel_hi:[1,1,1]
    v_pk_fma_f32 v[174:175], v[138:139], v[52:53], v[174:175] op_sel:[0,1,0] op_sel_hi:[1,1,1]
    v_pk_fma_f32 v[182:183], v[148:149], v[56:57], v[182:183] op_sel:[0,1,0] op_sel_hi:[1,1,1]
    v_pk_fma_f32 v[190:191], v[158:159], v[56:57], v[190:191] op_sel:[0,1,0] op_sel_hi:[1,1,1]
    v_pk_fma_f32 v[230:231], v[130:131], v[42:43], v[36:37] op_sel:[0,1,1] op_sel_hi:[1,1,1]
    v_pk_mul_f32 v[238:239], v[138:139], v[42:43] op_sel:[0,1] op_sel_hi:[1,1]
    v_pk_add_f32 v[244:245], v[132:133], v[140:141]
    v_pk_add_f32 v[246:247], v[150:151], v[160:161]
    v_pk_add_f32 v[248:249], v[132:133], v[140:141] neg_lo:[0,1] neg_hi:[0,1]
    v_pk_add_f32 v[250:251], v[150:151], v[160:161] neg_lo:[0,1] neg_hi:[0,1]
    v_pk_add_f32 v[132:133], v[244:245], v[246:247]
    v_pk_add_f32 v[140:141], v[244:245], v[246:247] neg_lo:[0,1] neg_hi:[0,1]
    v_pk_add_f32 v[150:151], v[248:249], v[250:251] neg_lo:[0,1] neg_hi:[0,1]
    v_pk_add_f32 v[160:161], v[248:249], v[250:251]
    v_pk_fma_f32 v[168:169], v[132:133], v[52:53], v[168:169] op_sel:[0,1,0] op_sel_hi:[1,1,1]
    v_pk_fma_f32 v[176:177], v[140:141], v[52:53], v[176:177] op_sel:[0,1,0] op_sel_hi:[1,1,1]
    v_pk_fma_f32 v[184:185], v[150:151], v[56:57], v[184:185] op_sel:[0,1,0] op_sel_hi:[1,1,1]
    v_pk_fma_f32 v[192:193], v[160:161], v[56:57], v[192:193] op_sel:[0,1,0] op_sel_hi:[1,1,1]
    v_pk_fma_f32 v[232:233], v[132:133], v[42:43], v[36:37] op_sel:[0,1,1] op_sel_hi:[1,1,1]
    v_pk_mul_f32 v[240:241], v[140:141], v[42:43] op_sel:[0,1] op_sel_hi:[1,1]
    v_pk_add_f32 v[244:245], v[134:135], v[142:143]
    v_pk_add_f32 v[246:247], v[152:153], v[162:163]
    v_pk_add_f32 v[248:249], v[134:135], v[142:143] neg_lo:[0,1] neg_hi:[0,1]
    v_pk_add_f32 v[250:251], v[152:153], v[162:163] neg_lo:[0,1] neg_hi:[0,1]
    v_pk_add_f32 v[134:135], v[244:245], v[246:247]
    v_pk_add_f32 v[142:143], v[244:245], v[246:247] neg_lo:[0,1] neg_hi:[0,1]
    v_pk_add_f32 v[152:153], v[248:249], v[250:251] neg_lo:[0,1] neg_hi:[0,1]
    v_pk_add_f32 v[162:163], v[248:249], v[250:251]
    v_pk_fma_f32 v[170:171], v[134:135], v[52:53], v[170:171] op_sel:[0,1,0] op_sel_hi:[1,1,1]
    v_pk_fma_f32 v[178:179], v[142:143], v[52:53], v[178:179] op_sel:[0,1,0] op_sel_hi:[1,1,1]
    v_pk_fma_f32 v[186:187], v[152:153], v[56:57], v[186:187] op_sel:[0,1,0] op_sel_hi:[1,1,1]
    v_pk_fma_f32 v[194:195], v[162:163], v[56:57], v[194:195] op_sel:[0,1,0] op_sel_hi:[1,1,1]
    v_pk_fma_f32 v[234:235], v[134:135], v[42:43], v[36:37] op_sel:[0,1,1] op_sel_hi:[1,1,1]
    v_pk_mul_f32 v[242:243], v[142:143], v[42:43] op_sel:[0,1] op_sel_hi:[1,1]
    v_add_f32 v244, v154, v144
    v_sub_f32 v245, v154, v144
    v_fmac_f32 v60, v53, v244
    v_fmac_f32 v38, v57, v245
    v_fmac_f32 v62, v43, v244
    v_lshlrev_b32 v128, 16, v96
    v_lshlrev_b32 v156, 16, v108
    v_lshlrev_b32 v144, 16, v100
    v_lshlrev_b32 v154, 16, v104
    v_and_b32 v129, 0xffff0000, v96
    v_and_b32 v157, 0xffff0000, v108
    v_and_b32 v143, 0xffff0000, v100
    v_and_b32 v153, 0xffff0000, v104
    v_lshlrev_b32 v130, 16, v97
    v_lshlrev_b32 v158, 16, v109
    v_lshlrev_b32 v142, 16, v101
    v_lshlrev_b32 v152, 16, v105
    v_and_b32 v131, 0xffff0000, v97
    v_and_b32 v159, 0xffff0000, v109
    v_and_b32 v141, 0xffff0000, v101
    v_and_b32 v151, 0xffff0000, v105
    v_lshlrev_b32 v132, 16, v98
    v_lshlrev_b32 v160, 16, v110
    v_lshlrev_b32 v140, 16, v102
    v_lshlrev_b32 v150, 16, v106
    v_and_b32 v133, 0xffff0000, v98
    v_and_b32 v161, 0xffff0000, v110
    v_and_b32 v139, 0xffff0000, v102
    v_and_b32 v149, 0xffff0000, v106
    v_lshlrev_b32 v134, 16, v99
    v_lshlrev_b32 v162, 16, v111
    v_lshlrev_b32 v138, 16, v103
    v_lshlrev_b32 v148, 16, v107
    v_and_b32 v135, 0xffff0000, v99
    v_and_b32 v163, 0xffff0000, v111
    v_and_b32 v137, 0xffff0000, v103
    v_and_b32 v147, 0xffff0000, v107
    v_mov_b32 v136, v16
    v_mov_b32 v146, v17
    v_pk_add_f32 v[244:245], v[128:129], v[136:137]
    v_pk_add_f32 v[246:247], v[146:147], v[156:157]
    v_pk_add_f32 v[248:249], v[128:129], v[136:137] neg_lo:[0,1] neg_hi:[0,1]
    v_pk_add_f32 v[250:251], v[146:147], v[156:157] neg_lo:[0,1] neg_hi:[0,1]
    v_pk_add_f32 v[128:129], v[244:245], v[246:247]
    v_pk_add_f32 v[136:137], v[244:245], v[246:247] neg_lo:[0,1] neg_hi:[0,1]
    v_pk_add_f32 v[146:147], v[248:249], v[250:251] neg_lo:[0,1] neg_hi:[0,1]
    v_pk_add_f32 v[156:157], v[248:249], v[250:251]
    v_pk_fma_f32 v[196:197], v[128:129], v[54:55], v[34:35] op_sel:[0,0,0] op_sel_hi:[1,0,1]
    v_pk_mul_f32 v[204:205], v[136:137], v[54:55] op_sel:[0,0] op_sel_hi:[1,0]
    v_pk_mul_f32 v[212:213], v[146:147], v[58:59] op_sel:[0,0] op_sel_hi:[1,0]
    v_pk_mul_f32 v[220:221], v[156:157], v[58:59] op_sel:[0,0] op_sel_hi:[1,0]
    v_pk_add_f32 v[244:245], v[130:131], v[138:139]
    v_pk_add_f32 v[246:247], v[148:149], v[158:159]
    v_pk_add_f32 v[248:249], v[130:131], v[138:139] neg_lo:[0,1] neg_hi:[0,1]
    v_pk_add_f32 v[250:251], v[148:149], v[158:159] neg_lo:[0,1] neg_hi:[0,1]
    v_pk_add_f32 v[130:131], v[244:245], v[246:247]
    v_pk_add_f32 v[138:139], v[244:245], v[246:247] neg_lo:[0,1] neg_hi:[0,1]
    v_pk_add_f32 v[148:149], v[248:249], v[250:251] neg_lo:[0,1] neg_hi:[0,1]
    v_pk_add_f32 v[158:159], v[248:249], v[250:251]
    v_pk_fma_f32 v[198:199], v[130:131], v[54:55], v[34:35] op_sel:[0,0,1] op_sel_hi:[1,0,1]
    v_pk_mul_f32 v[206:207], v[138:139], v[54:55] op_sel:[0,0] op_sel_hi:[1,0]
    v_pk_mul_f32 v[214:215], v[148:149], v[58:59] op_sel:[0,0] op_sel_hi:[1,0]
    v_pk_mul_f32 v[222:223], v[158:159], v[58:59] op_sel:[0,0] op_sel_hi:[1,0]
    v_pk_add_f32 v[244:245], v[132:133], v[140:141]
    v_pk_add_f32 v[246:247], v[150:151], v[160:161]
    v_pk_add_f32 v[248:249], v[132:133], v[140:141] neg_lo:[0,1] neg_hi:[0,1]
    v_pk_add_f32 v[250:251], v[150:151], v[160:161] neg_lo:[0,1] neg_hi:[0,1]
    v_pk_add_f32 v[132:133], v[244:245], v[246:247]
    v_pk_add_f32 v[140:141], v[244:245], v[246:247] neg_lo:[0,1] neg_hi:[0,1]
    v_pk_add_f32 v[150:151], v[248:249], v[250:251] neg_lo:[0,1] neg_hi:[0,1]
    v_pk_add_f32 v[160:161], v[248:249], v[250:251]
    v_pk_fma_f32 v[200:201], v[132:133], v[54:55], v[34:35] op_sel:[0,0,1] op_sel_hi:[1,0,1]
    v_pk_mul_f32 v[208:209], v[140:141], v[54:55] op_sel:[0,0] op_sel_hi:[1,0]
    v_pk_mul_f32 v[216:217], v[150:151], v[58:59] op_sel:[0,0] op_sel_hi:[1,0]
    v_pk_mul_f32 v[224:225], v[160:161], v[58:59] op_sel:[0,0] op_sel_hi:[1,0]
    v_pk_add_f32 v[244:245], v[134:135], v[142:143]
    v_pk_add_f32 v[246:247], v[152:153], v[162:163]
    v_pk_add_f32 v[248:249], v[134:135], v[142:143] neg_lo:[0,1] neg_hi:[0,1]
    v_pk_add_f32 v[250:251], v[152:153], v[162:163] neg_lo:[0,1] neg_hi:[0,1]
    v_pk_add_f32 v[134:135], v[244:245], v[246:247]
    v_pk_add_f32 v[142:143], v[244:245], v[246:247] neg_lo:[0,1] neg_hi:[0,1]
    v_pk_add_f32 v[152:153], v[248:249], v[250:251] neg_lo:[0,1] neg_hi:[0,1]
    v_pk_add_f32 v[162:163], v[248:249], v[250:251]
    v_pk_fma_f32 v[202:203], v[134:135], v[54:55], v[34:35] op_sel:[0,0,1] op_sel_hi:[1,0,1]
    v_pk_mul_f32 v[210:211], v[142:143], v[54:55] op_sel:[0,0] op_sel_hi:[1,0]
    v_pk_mul_f32 v[218:219], v[152:153], v[58:59] op_sel:[0,0] op_sel_hi:[1,0]
    v_pk_mul_f32 v[226:227], v[162:163], v[58:59] op_sel:[0,0] op_sel_hi:[1,0]
    v_add_f32 v244, v154, v144
    v_sub_f32 v245, v154, v144
    v_fmac_f32 v61, v54, v244
    v_fmac_f32 v39, v58, v245
    v_lshlrev_b32 v128, 16, v112
    v_lshlrev_b32 v156, 16, v124
    v_lshlrev_b32 v144, 16, v116
    v_lshlrev_b32 v154, 16, v120
    v_and_b32 v129, 0xffff0000, v112
    v_and_b32 v157, 0xffff0000, v124
    v_and_b32 v143, 0xffff0000, v116
    v_and_b32 v153, 0xffff0000, v120
    v_lshlrev_b32 v130, 16, v113
    v_lshlrev_b32 v158, 16, v125
    v_lshlrev_b32 v142, 16, v117
    v_lshlrev_b32 v152, 16, v121
    v_and_b32 v131, 0xffff0000, v113
    v_and_b32 v159, 0xffff0000, v125
    v_and_b32 v141, 0xffff0000, v117
    v_and_b32 v151, 0xffff0000, v121
    v_lshlrev_b32 v132, 16, v114
    v_lshlrev_b32 v160, 16, v126
    v_lshlrev_b32 v140, 16, v118
    v_lshlrev_b32 v150, 16, v122
    v_and_b32 v133, 0xffff0000, v114
    v_and_b32 v161, 0xffff0000, v126
    v_and_b32 v139, 0xffff0000, v118
    v_and_b32 v149, 0xffff0000, v122
    v_lshlrev_b32 v134, 16, v115
    v_lshlrev_b32 v162, 16, v127
    v_lshlrev_b32 v138, 16, v119
    v_lshlrev_b32 v148, 16, v123
    v_and_b32 v135, 0xffff0000, v115
    v_and_b32 v163, 0xffff0000, v127
    v_and_b32 v137, 0xffff0000, v119
    v_and_b32 v147, 0xffff0000, v123
    v_mov_b32 v136, v18
    v_mov_b32 v146, v19
    v_pk_add_f32 v[244:245], v[128:129], v[136:137]
    v_pk_add_f32 v[246:247], v[146:147], v[156:157]
    v_pk_add_f32 v[248:249], v[128:129], v[136:137] neg_lo:[0,1] neg_hi:[0,1]
    v_pk_add_f32 v[250:251], v[146:147], v[156:157] neg_lo:[0,1] neg_hi:[0,1]
    v_pk_add_f32 v[128:129], v[244:245], v[246:247]
    v_pk_add_f32 v[136:137], v[244:245], v[246:247] neg_lo:[0,1] neg_hi:[0,1]
    v_pk_add_f32 v[146:147], v[248:249], v[250:251] neg_lo:[0,1] neg_hi:[0,1]
    v_pk_add_f32 v[156:157], v[248:249], v[250:251]
    v_pk_fma_f32 v[196:197], v[128:129], v[54:55], v[196:197] op_sel:[0,1,0] op_sel_hi:[1,1,1]
    v_pk_fma_f32 v[204:205], v[136:137], v[54:55], v[204:205] op_sel:[0,1,0] op_sel_hi:[1,1,1]
    v_pk_fma_f32 v[212:213], v[146:147], v[58:59], v[212:213] op_sel:[0,1,0] op_sel_hi:[1,1,1]
    v_pk_fma_f32 v[220:221], v[156:157], v[58:59], v[220:221] op_sel:[0,1,0] op_sel_hi:[1,1,1]
    v_pk_fma_f32 v[228:229], v[128:129], v[46:47], v[228:229] op_sel:[0,1,0] op_sel_hi:[1,1,1]
    v_pk_fma_f32 v[236:237], v[136:137], v[46:47], v[236:237] op_sel:[0,1,0] op_sel_hi:[1,1,1]
    v_pk_add_f32 v[244:245], v[130:131], v[138:139]
    v_pk_add_f32 v[246:247], v[148:149], v[158:159]
    v_pk_add_f32 v[248:249], v[130:131], v[138:139] neg_lo:[0,1] neg_hi:[0,1]
    v_pk_add_f32 v[250:251], v[148:149], v[158:159] neg_lo:[0,1] neg_hi:[0,1]
    v_pk_add_f32 v[130:131], v[244:245], v[246:247]
    v_pk_add_f32 v[138:139], v[244:245], v[246:247] neg_lo:[0,1] neg_hi:[0,1]
    v_pk_add_f32 v[148:149], v[248:249], v[250:251] neg_lo:[0,1] neg_hi:[0,1]
    v_pk_add_f32 v[158:159], v[248:249], v[250:251]
    v_pk_fma_f32 v[198:199], v[130:131], v[54:55], v[198:199] op_sel:[0,1,0] op_sel_hi:[1,1,1]
    v_pk_fma_f32 v[206:207], v[138:139], v[54:55], v[206:207] op_sel:[0,1,0] op_sel_hi:[1,1,1]
    v_pk_fma_f32 v[214:215], v[148:149], v[58:59], v[214:215] op_sel:[0,1,0] op_sel_hi:[1,1,1]
    v_pk_fma_f32 v[222:223], v[158:159], v[58:59], v[222:223] op_sel:[0,1,0] op_sel_hi:[1,1,1]
    v_pk_fma_f32 v[230:231], v[130:131], v[46:47], v[230:231] op_sel:[0,1,0] op_sel_hi:[1,1,1]
    v_pk_fma_f32 v[238:239], v[138:139], v[46:47], v[238:239] op_sel:[0,1,0] op_sel_hi:[1,1,1]
    v_pk_add_f32 v[244:245], v[132:133], v[140:141]
    v_pk_add_f32 v[246:247], v[150:151], v[160:161]
    v_pk_add_f32 v[248:249], v[132:133], v[140:141] neg_lo:[0,1] neg_hi:[0,1]
    v_pk_add_f32 v[250:251], v[150:151], v[160:161] neg_lo:[0,1] neg_hi:[0,1]
    v_pk_add_f32 v[132:133], v[244:245], v[246:247]
    v_pk_add_f32 v[140:141], v[244:245], v[246:247] neg_lo:[0,1] neg_hi:[0,1]
    v_pk_add_f32 v[150:151], v[248:249], v[250:251] neg_lo:[0,1] neg_hi:[0,1]
    v_pk_add_f32 v[160:161], v[248:249], v[250:251]
    v_pk_fma_f32 v[200:201], v[132:133], v[54:55], v[200:201] op_sel:[0,1,0] op_sel_hi:[1,1,1]
    v_pk_fma_f32 v[208:209], v[140:141], v[54:55], v[208:209] op_sel:[0,1,0] op_sel_hi:[1,1,1]
    v_pk_fma_f32 v[216:217], v[150:151], v[58:59], v[216:217] op_sel:[0,1,0] op_sel_hi:[1,1,1]
    v_pk_fma_f32 v[224:225], v[160:161], v[58:59], v[224:225] op_sel:[0,1,0] op_sel_hi:[1,1,1]
    v_pk_fma_f32 v[232:233], v[132:133], v[46:47], v[232:233] op_sel:[0,1,0] op_sel_hi:[1,1,1]
    v_pk_fma_f32 v[240:241], v[140:141], v[46:47], v[240:241] op_sel:[0,1,0] op_sel_hi:[1,1,1]
    v_pk_add_f32 v[244:245], v[134:135], v[142:143]
    v_pk_add_f32 v[246:247], v[152:153], v[162:163]
    v_pk_add_f32 v[248:249], v[134:135], v[142:143] neg_lo:[0,1] neg_hi:[0,1]
    v_pk_add_f32 v[250:251], v[152:153], v[162:163] neg_lo:[0,1] neg_hi:[0,1]
    v_pk_add_f32 v[134:135], v[244:245], v[246:247]
    v_pk_add_f32 v[142:143], v[244:245], v[246:247] neg_lo:[0,1] neg_hi:[0,1]
    v_pk_add_f32 v[152:153], v[248:249], v[250:251] neg_lo:[0,1] neg_hi:[0,1]
    v_pk_add_f32 v[162:163], v[248:249], v[250:251]
    v_pk_fma_f32 v[202:203], v[134:135], v[54:55], v[202:203] op_sel:[0,1,0] op_sel_hi:[1,1,1]
    v_pk_fma_f32 v[210:211], v[142:143], v[54:55], v[210:211] op_sel:[0,1,0] op_sel_hi:[1,1,1]
    v_pk_fma_f32 v[218:219], v[152:153], v[58:59], v[218:219] op_sel:[0,1,0] op_sel_hi:[1,1,1]
    v_pk_fma_f32 v[226:227], v[162:163], v[58:59], v[226:227] op_sel:[0,1,0] op_sel_hi:[1,1,1]
    v_pk_fma_f32 v[234:235], v[134:135], v[46:47], v[234:235] op_sel:[0,1,0] op_sel_hi:[1,1,1]
    v_pk_fma_f32 v[242:243], v[142:143], v[46:47], v[242:243] op_sel:[0,1,0] op_sel_hi:[1,1,1]
    v_add_f32 v244, v154, v144
    v_sub_f32 v245, v154, v144
    v_fmac_f32 v61, v55, v244
    v_fmac_f32 v39, v59, v245
    v_fmac_f32 v62, v47, v244
    v_lshrrev_b32 v2, 5, v1
    s_lshl_b32 s44, s32, 1
    v_add_u32 v3, s44, v2
    v_mul_u32_u24 v3, 528, v3
    v_lshl_add_u32 v22, v6, 4, v3
    v_mul_u32_u24 v2, 528, v2
    v_lshl_add_u32 v23, v6, 4, v2
    v_add_u32 v23, 67584, v23
    v_pk_add_f32 v[128:129], v[164:165], v[196:197]
    v_pk_add_f32 v[130:131], v[166:167], v[198:199]
    v_pk_add_f32 v[132:133], v[168:169], v[200:201]
    v_pk_add_f32 v[134:135], v[170:171], v[202:203]
    v_cvt_pk_bf16_f32 v64, v128, v129
    v_cvt_pk_bf16_f32 v65, v130, v131
    v_cvt_pk_bf16_f32 v66, v132, v133
    v_cvt_pk_bf16_f32 v67, v134, v135
    ds_write_b128 v22, v[64:67] offset:0
    v_pk_add_f32 v[136:137], v[164:165], v[196:197] neg_lo:[0,1] neg_hi:[0,1]
    v_pk_add_f32 v[138:139], v[166:167], v[198:199] neg_lo:[0,1] neg_hi:[0,1]
    v_pk_add_f32 v[140:141], v[168:169], v[200:201] neg_lo:[0,1] neg_hi:[0,1]
    v_pk_add_f32 v[142:143], v[170:171], v[202:203] neg_lo:[0,1] neg_hi:[0,1]
    v_cvt_pk_bf16_f32 v68, v136, v137
    v_cvt_pk_bf16_f32 v69, v138, v139
    v_cvt_pk_bf16_f32 v70, v140, v141
    v_cvt_pk_bf16_f32 v71, v142, v143
    ds_write_b128 v22, v[68:71] offset:8448
    v_pk_add_f32 v[128:129], v[172:173], v[204:205]
    v_pk_add_f32 v[130:131], v[174:175], v[206:207]
    v_pk_add_f32 v[132:133], v[176:177], v[208:209]
    v_pk_add_f32 v[134:135], v[178:179], v[210:211]
    v_cvt_pk_bf16_f32 v72, v128, v129
    v_cvt_pk_bf16_f32 v73, v130, v131
    v_cvt_pk_bf16_f32 v74, v132, v133
    v_cvt_pk_bf16_f32 v75, v134, v135
    ds_write_b128 v22, v[72:75] offset:16896
    v_pk_add_f32 v[136:137], v[172:173], v[204:205] neg_lo:[0,1] neg_hi:[0,1]
    v_pk_add_f32 v[138:139], v[174:175], v[206:207] neg_lo:[0,1] neg_hi:[0,1]
    v_pk_add_f32 v[140:141], v[176:177], v[208:209] neg_lo:[0,1] neg_hi:[0,1]
    v_pk_add_f32 v[142:143], v[178:179], v[210:211] neg_lo:[0,1] neg_hi:[0,1]
    v_cvt_pk_bf16_f32 v76, v136, v137
    v_cvt_pk_bf16_f32 v77, v138, v139
    v_cvt_pk_bf16_f32 v78, v140, v141
    v_cvt_pk_bf16_f32 v79, v142, v143
    ds_write_b128 v22, v[76:79] offset:25344
    v_pk_add_f32 v[128:129], v[180:181], v[212:213] neg_lo:[0,1] neg_hi:[0,1]
    v_pk_add_f32 v[130:131], v[182:183], v[214:215] neg_lo:[0,1] neg_hi:[0,1]
    v_pk_add_f32 v[132:133], v[184:185], v[216:217] neg_lo:[0,1] neg_hi:[0,1]
    v_pk_add_f32 v[134:135], v[186:187], v[218:219] neg_lo:[0,1] neg_hi:[0,1]
    v_cvt_pk_bf16_f32 v80, v128, v129
    v_cvt_pk_bf16_f32 v81, v130, v131
    v_cvt_pk_bf16_f32 v82, v132, v133
    v_cvt_pk_bf16_f32 v83, v134, v135
    ds_write_b128 v22, v[80:83] offset:33792
    v_pk_add_f32 v[136:137], v[180:181], v[212:213]
    v_pk_add_f32 v[138:139], v[182:183], v[214:215]
    v_pk_add_f32 v[140:141], v[184:185], v[216:217]
    v_pk_add_f32 v[142:143], v[186:187], v[218:219]
    v_cvt_pk_bf16_f32 v84, v136, v137
    v_cvt_pk_bf16_f32 v85, v138, v139
    v_cvt_pk_bf16_f32 v86, v140, v141
    v_cvt_pk_bf16_f32 v87, v142, v143
    ds_write_b128 v22, v[84:87] offset:42240
    v_pk_add_f32 v[128:129], v[188:189], v[220:221] neg_lo:[0,1] neg_hi:[0,1]
    v_pk_add_f32 v[130:131], v[190:191], v[222:223] neg_lo:[0,1] neg_hi:[0,1]
    v_pk_add_f32 v[132:133], v[192:193], v[224:225] neg_lo:[0,1] neg_hi:[0,1]
    v_pk_add_f32 v[134:135], v[194:195], v[226:227] neg_lo:[0,1] neg_hi:[0,1]
    v_cvt_pk_bf16_f32 v88, v128, v129
    v_cvt_pk_bf16_f32 v89, v130, v131
    v_cvt_pk_bf16_f32 v90, v132, v133
    v_cvt_pk_bf16_f32 v91, v134, v135
    ds_write_b128 v22, v[88:91] offset:50688
    v_pk_add_f32 v[136:137], v[188:189], v[220:221]
    v_pk_add_f32 v[138:139], v[190:191], v[222:223]
    v_pk_add_f32 v[140:141], v[192:193], v[224:225]
    v_pk_add_f32 v[142:143], v[194:195], v[226:227]
    v_cvt_pk_bf16_f32 v92, v136, v137
    v_cvt_pk_bf16_f32 v93, v138, v139
    v_cvt_pk_bf16_f32 v94, v140, v141
    v_cvt_pk_bf16_f32 v95, v142, v143
    ds_write_b128 v22, v[92:95] offset:59136
    v_mov_b32 v97, 0
    v_mov_b32 v98, 0
    v_mov_b32 v99, 0
    v_mov_b32 v101, 0
    v_mov_b32 v102, 0
    v_mov_b32 v103, 0
    v_mov_b32 v105, 0
    v_mov_b32 v106, 0
    v_mov_b32 v107, 0
    v_mov_b32 v109, 0
    v_mov_b32 v110, 0
    v_mov_b32 v111, 0
    v_mov_b32 v113, 0
    v_mov_b32 v114, 0
    v_mov_b32 v115, 0
    v_add_f32 v244, v60, v61
    v_sub_f32 v245, v60, v61
    v_sub_f32 v246, v38, v39
    v_add_f32 v247, v38, v39
    v_cvt_pk_bf16_f32 v96, v244, 0
    v_cvt_pk_bf16_f32 v100, v245, 0
    v_cvt_pk_bf16_f32 v104, v246, 0
    v_cvt_pk_bf16_f32 v108, v247, 0
    v_cvt_pk_bf16_f32 v112, v62, 0
    v_cvt_pk_bf16_f32 v116, v228, v229
    v_cvt_pk_bf16_f32 v117, v230, v231
    v_cvt_pk_bf16_f32 v118, v232, v233
    v_cvt_pk_bf16_f32 v119, v234, v235
    v_cvt_pk_bf16_f32 v120, v236, v237
    v_cvt_pk_bf16_f32 v121, v238, v239
    v_cvt_pk_bf16_f32 v122, v240, v241
    v_cvt_pk_bf16_f32 v123, v242, v243
    s_mov_b32 s60, 0x80000000
    s_mov_b32 s61, 0x80000000
    s_cmp_lg_u32 s32, 0
    s_cbranch_scc1 L_k1s_not2
    ds_write_b128 v23, v[116:119] offset:0
    ds_write_b128 v23, v[120:123] offset:1056
    s_mov_b64 exec, s[60:61]
    ds_write_b128 v23, v[112:115] offset:16
    ds_write_b128 v23, v[112:115] offset:1072
L_k1s_not2:
    s_mov_b64 exec, s[60:61]
    ds_write_b128 v22, v[96:99] offset:16
    ds_write_b128 v22, v[100:103] offset:8464
    ds_write_b128 v22, v[96:99] offset:16912
    ds_write_b128 v22, v[100:103] offset:25360
    ds_write_b128 v22, v[104:107] offset:33808
    ds_write_b128 v22, v[108:111] offset:42256
    ds_write_b128 v22, v[104:107] offset:50704
    ds_write_b128 v22, v[108:111] offset:59152
    s_mov_b64 exec, -1
    v_and_b32 v2, 19, v1
    v_bfe_u32 v3, v1, 2, 1
    v_lshl_add_u32 v2, v3, 3, v2
    v_bfe_u32 v3, v1, 3, 1
    v_lshl_add_u32 v2, v3, 2, v2
    v_mul_u32_u24 v2, 528, v2
    s_mul_i32 s44, s41, 16896
    v_lshrrev_b32 v3, 5, v1
    s_mul_i32 s45, s42, 1056
    s_add_u32 s45, s45, 67584
    s_waitcnt lgkmcnt(0)
    v_add_u32 v23, s44, v2
    v_lshl_add_u32 v22, v3, 4, v23
    v_lshlrev_b32 v24, 4, v3
    v_add_u32 v24, s45, v24
    v_mov_b32 v25, s45
    s_waitcnt vmcnt(0)
    s_barrier
    ds_read_b128 v[64:67], v22 offset:0
    ds_read_b128 v[68:71], v22 offset:32
    ds_read_b128 v[72:75], v22 offset:64
    ds_read_b128 v[76:79], v22 offset:96
    ds_read_b128 v[80:83], v22 offset:128
    ds_read_b128 v[84:87], v22 offset:160
    ds_read_b128 v[88:91], v22 offset:192
    ds_read_b128 v[92:95], v22 offset:224
    ds_read_b128 v[96:99], v22 offset:256
    ds_read_b128 v[100:103], v22 offset:288
    ds_read_b128 v[104:107], v22 offset:320
    ds_read_b128 v[108:111], v22 offset:352
    ds_read_b128 v[112:115], v22 offset:384
    ds_read_b128 v[116:119], v22 offset:416
    ds_read_b128 v[120:123], v22 offset:448
    ds_read_b128 v[124:127], v22 offset:480
    ds_read_b128 v[128:131], v23 offset:512
    v_lshlrev_b32 v2, 7, v6
    v_lshrrev_b32 v3, 5, v1
    v_bfe_u32 v4, v1, 1, 3
    v_xor_b32 v4, v3, v4
    v_lshl_add_u32 v2, v4, 4, v2
    v_add_u32 v8, s50, v2
    v_add_u32 v12, s52, v2
    v_xor_b32 v9, 32, v8
    v_xor_b32 v13, 32, v12
    v_xor_b32 v10, 64, v8
    v_xor_b32 v14, 64, v12
    v_xor_b32 v11, 96, v8
    v_xor_b32 v15, 96, v12
    s_cmp_ge_u32 s32, 4
    s_cselect_b32 s55, 18, 16
    s_cselect_b32 s49, 15, 31
    s_lshl_b32 s49, 1, s49
    s_lshl_b32 s55, s55, 20
    s_mul_i32 s44, s42, 304128
    s_add_u32 s55, s55, s44
    s_lshl_b32 s44, s40, 10
    s_add_u32 s55, s55, s44
    v_lshlrev_b32 v16, 4, v1
    s_sub_u32 s44, 256, s42
    v_sub_u32 v2, s44, v6
    v_lshrrev_b32 v4, 5, v2
    v_mul_u32_u24 v4, 33792, v4
    v_and_b32 v2, 31, v2
    v_lshl_add_u32 v2, v2, 4, v4
    v_lshl_add_u32 v17, v3, 9, v2
    v_mov_b32 v2, 1073741824
    v_add_u32 v4, 135168, v16
    v_cndmask_b32 v18, v2, v4, s[58:59]
    s_lshl_b32 s44, s32, 10
    s_add_u32 s44, s44, 135424
    v_lshl_add_u32 v19, v3, 4, s44
    s_waitcnt lgkmcnt(0)
    s_barrier
    s_add_u32 m0, s52, 0
    s_add_u32 s44, s47, 256
    buffer_load_dwordx4 v20, s[28:31], s44 offen lds
    s_add_u32 m0, s52, 1024
    s_add_u32 s44, s47, 256
    buffer_load_dwordx4 v21, s[28:31], s44 offen lds
    s_add_u32 m0, s52, 2048
    s_add_u32 s44, s47, 65792
    buffer_load_dwordx4 v20, s[28:31], s44 offen lds
    s_add_u32 m0, s52, 3072
    s_add_u32 s44, s47, 65792
    buffer_load_dwordx4 v21, s[28:31], s44 offen lds
    s_add_u32 m0, s53, 0
    s_add_u32 s44, s47, 384
    buffer_load_dwordx4 v20, s[28:31], s44 offen lds
    s_add_u32 m0, s53, 1024
    s_add_u32 s44, s47, 384
    buffer_load_dwordx4 v21, s[28:31], s44 offen lds
    s_add_u32 m0, s53, 2048
    s_add_u32 s44, s47, 65920
    buffer_load_dwordx4 v20, s[28:31], s44 offen lds
    s_add_u32 m0, s53, 3072
    s_add_u32 s44, s47, 65920
    buffer_load_dwordx4 v21, s[28:31], s44 offen lds
    s_xor_b32 s47, s47, 131072
    s_lshl_b32 s44, s40, 2
    s_add_u32 s44, s44, s32
    s_cmp_lt_u32 s44, 4
    s_cbranch_scc1 L_k1s_dual
    s_and_b32 s44, s32, 3
    s_cmp_lg_u32 s44, 1
    s_cbranch_scc1 L_k1s_noxs
    v_mfma_f32_32x32x16_bf16 v[200:215], v[128:131], v[28:31], 0
    ds_read_b128 v[48:51], v19 offset:0
    ds_read_b128 v[52:55], v19 offset:32
    ds_read_b128 v[56:59], v19 offset:64
    ds_read_b128 v[60:63], v19 offset:96
    s_waitcnt lgkmcnt(3)
    v_mfma_f32_32x32x16_bf16 v[200:215], v[64:67], v[48:51], v[200:215]
    s_waitcnt lgkmcnt(2)
    v_mfma_f32_32x32x16_bf16 v[200:215], v[68:71], v[52:55], v[200:215]
    s_waitcnt lgkmcnt(1)
    v_mfma_f32_32x32x16_bf16 v[200:215], v[72:75], v[56:59], v[200:215]
    s_waitcnt lgkmcnt(0)
    v_mfma_f32_32x32x16_bf16 v[200:215], v[76:79], v[60:63], v[200:215]
    ds_read_b128 v[48:51], v19 offset:128
    ds_read_b128 v[52:55], v19 offset:160
    ds_read_b128 v[56:59], v19 offset:192
    ds_read_b128 v[60:63], v19 offset:224
    s_waitcnt lgkmcnt(3)
    v_mfma_f32_32x32x16_bf16 v[200:215], v[80:83], v[48:51], v[200:215]
    s_waitcnt lgkmcnt(2)
    v_mfma_f32_32x32x16_bf16 v[200:215], v[84:87], v[52:55], v[200:215]
    s_waitcnt lgkmcnt(1)
    v_mfma_f32_32x32x16_bf16 v[200:215], v[88:91], v[56:59], v[200:215]
    s_waitcnt lgkmcnt(0)
    v_mfma_f32_32x32x16_bf16 v[200:215], v[92:95], v[60:63], v[200:215]
    ds_read_b128 v[48:51], v19 offset:256
    ds_read_b128 v[52:55], v19 offset:288
    ds_read_b128 v[56:59], v19 offset:320
    ds_read_b128 v[60:63], v19 offset:352
    s_waitcnt lgkmcnt(3)
    v_mfma_f32_32x32x16_bf16 v[200:215], v[96:99], v[48:51], v[200:215]
    s_waitcnt lgkmcnt(2)
    v_mfma_f32_32x32x16_bf16 v[200:215], v[100:103], v[52:55], v[200:215]
    s_waitcnt lgkmcnt(1)
    v_mfma_f32_32x32x16_bf16 v[200:215], v[104:107], v[56:59], v[200:215]
    s_waitcnt lgkmcnt(0)
    v_mfma_f32_32x32x16_bf16 v[200:215], v[108:111], v[60:63], v[200:215]
    ds_read_b128 v[48:51], v19 offset:384
    ds_read_b128 v[52:55], v19 offset:416
    ds_read_b128 v[56:59], v19 offset:448
    ds_read_b128 v[60:63], v19 offset:480
    s_waitcnt lgkmcnt(3)
    v_mfma_f32_32x32x16_bf16 v[200:215], v[112:115], v[48:51], v[200:215]
    s_waitcnt lgkmcnt(2)
    v_mfma_f32_32x32x16_bf16 v[200:215], v[116:119], v[52:55], v[200:215]
    s_waitcnt lgkmcnt(1)
    v_mfma_f32_32x32x16_bf16 v[200:215], v[120:123], v[56:59], v[200:215]
    s_waitcnt lgkmcnt(0)
    v_mfma_f32_32x32x16_bf16 v[200:215], v[124:127], v[60:63], v[200:215]
    s_nop 11
    v_cvt_pk_bf16_f32 v248, v200, v201
    v_cvt_pk_bf16_f32 v249, v202, v203
    v_cvt_pk_bf16_f32 v250, v204, v205
    v_cvt_pk_bf16_f32 v251, v206, v207
    v_cvt_pk_bf16_f32 v252, v208, v209
    v_cvt_pk_bf16_f32 v253, v210, v211
    v_cvt_pk_bf16_f32 v254, v212, v213
    v_cvt_pk_bf16_f32 v255, v214, v215
    s_add_u32 s44, s55, 608256
    buffer_store_dwordx4 v[248:251], v18, s[24:27], s55 offen sc1
    buffer_store_dwordx4 v[252:255], v18, s[24:27], s44 offen sc1
L_k1s_noxs:
    s_mul_i32 s44, s62, 33792
    s_add_u32 s48, s55, s44
    s_sub_u32 s63, s55, s44
    s_xor_b32 s62, s62, 1
    v_xor_b32 v32, s49, v28
    v_xor_b32 v33, s49, v29
    v_xor_b32 v34, s49, v30
    v_xor_b32 v35, s49, v31
    v_mfma_f32_32x32x16_bf16 v[200:215], v[128:131], v[28:31], 0
    s_nop 0
    v_mfma_f32_32x32x16_bf16 v[216:231], v[128:131], v[32:35], 0
    ds_read_b128 v[48:51], v8 offset:0
    ds_read_b128 v[52:55], v9 offset:0
    ds_read_b128 v[56:59], v10 offset:0
    ds_read_b128 v[60:63], v11 offset:0
    s_waitcnt lgkmcnt(3)
    v_mfma_f32_32x32x16_bf16 v[200:215], v[64:67], v[48:51], v[200:215]
    v_xor_b32 v32, s49, v48
    v_xor_b32 v33, s49, v49
    v_xor_b32 v34, s49, v50
    v_xor_b32 v35, s49, v51
    s_nop 1
    v_mfma_f32_32x32x16_bf16 v[216:231], v[64:67], v[32:35], v[216:231]
    s_waitcnt lgkmcnt(2)
    v_mfma_f32_32x32x16_bf16 v[200:215], v[68:71], v[52:55], v[200:215]
    v_xor_b32 v36, s49, v52
    v_xor_b32 v37, s49, v53
    v_xor_b32 v38, s49, v54
    v_xor_b32 v39, s49, v55
    s_nop 1
    v_mfma_f32_32x32x16_bf16 v[216:231], v[68:71], v[36:39], v[216:231]
    s_waitcnt lgkmcnt(1)
    v_mfma_f32_32x32x16_bf16 v[200:215], v[72:75], v[56:59], v[200:215]
    v_xor_b32 v40, s49, v56
    v_xor_b32 v41, s49, v57
    v_xor_b32 v42, s49, v58
    v_xor_b32 v43, s49, v59
    s_nop 1
    v_mfma_f32_32x32x16_bf16 v[216:231], v[72:75], v[40:43], v[216:231]
    s_waitcnt lgkmcnt(0)
    s_add_u32 m0, s50, 0
    s_add_u32 s44, s47, 0
    buffer_load_dwordx4 v20, s[28:31], s44 offen lds
    s_add_u32 m0, s50, 1024
    s_add_u32 s44, s47, 0
    buffer_load_dwordx4 v21, s[28:31], s44 offen lds
    s_add_u32 m0, s50, 2048
    s_add_u32 s44, s47, 65536
    buffer_load_dwordx4 v20, s[28:31], s44 offen lds
    s_add_u32 m0, s50, 3072
    s_add_u32 s44, s47, 65536
    buffer_load_dwordx4 v21, s[28:31], s44 offen lds
    v_mfma_f32_32x32x16_bf16 v[200:215], v[76:79], v[60:63], v[200:215]
    v_xor_b32 v44, s49, v60
    v_xor_b32 v45, s49, v61
    v_xor_b32 v46, s49, v62
    v_xor_b32 v47, s49, v63
    s_nop 1
    v_mfma_f32_32x32x16_bf16 v[216:231], v[76:79], v[44:47], v[216:231]
    ds_read_b128 v[48:51], v8 offset:4096
    ds_read_b128 v[52:55], v9 offset:4096
    ds_read_b128 v[56:59], v10 offset:4096
    ds_read_b128 v[60:63], v11 offset:4096
    s_waitcnt lgkmcnt(3)
    v_mfma_f32_32x32x16_bf16 v[200:215], v[80:83], v[48:51], v[200:215]
    v_xor_b32 v32, s49, v48
    v_xor_b32 v33, s49, v49
    v_xor_b32 v34, s49, v50
    v_xor_b32 v35, s49, v51
    s_nop 1
    v_mfma_f32_32x32x16_bf16 v[216:231], v[80:83], v[32:35], v[216:231]
    s_waitcnt lgkmcnt(2)
    v_mfma_f32_32x32x16_bf16 v[200:215], v[84:87], v[52:55], v[200:215]
    v_xor_b32 v36, s49, v52
    v_xor_b32 v37, s49, v53
    v_xor_b32 v38, s49, v54
    v_xor_b32 v39, s49, v55
    s_nop 1
    v_mfma_f32_32x32x16_bf16 v[216:231], v[84:87], v[36:39], v[216:231]
    s_waitcnt lgkmcnt(1)
    v_mfma_f32_32x32x16_bf16 v[200:215], v[88:91], v[56:59], v[200:215]
    v_xor_b32 v40, s49, v56
    v_xor_b32 v41, s49, v57
    v_xor_b32 v42, s49, v58
    v_xor_b32 v43, s49, v59
    s_nop 1
    v_mfma_f32_32x32x16_bf16 v[216:231], v[88:91], v[40:43], v[216:231]
    s_waitcnt lgkmcnt(0)
    s_add_u32 m0, s51, 0
    s_add_u32 s44, s47, 128
    buffer_load_dwordx4 v20, s[28:31], s44 offen lds
    s_add_u32 m0, s51, 1024
    s_add_u32 s44, s47, 128
    buffer_load_dwordx4 v21, s[28:31], s44 offen lds
    s_add_u32 m0, s51, 2048
    s_add_u32 s44, s47, 65664
    buffer_load_dwordx4 v20, s[28:31], s44 offen lds
    s_add_u32 m0, s51, 3072
    s_add_u32 s44, s47, 65664
    buffer_load_dwordx4 v21, s[28:31], s44 offen lds
    v_mfma_f32_32x32x16_bf16 v[200:215], v[92:95], v[60:63], v[200:215]
    v_xor_b32 v44, s49, v60
    v_xor_b32 v45, s49, v61
    v_xor_b32 v46, s49, v62
    v_xor_b32 v47, s49, v63
    s_nop 1
    v_mfma_f32_32x32x16_bf16 v[216:231], v[92:95], v[44:47], v[216:231]
    s_waitcnt vmcnt(12)
    ds_read_b128 v[48:51], v12 offset:0
    ds_read_b128 v[52:55], v13 offset:0
    ds_read_b128 v[56:59], v14 offset:0
    ds_read_b128 v[60:63], v15 offset:0
    s_waitcnt lgkmcnt(3)
    v_mfma_f32_32x32x16_bf16 v[200:215], v[96:99], v[48:51], v[200:215]
    v_xor_b32 v32, s49, v48
    v_xor_b32 v33, s49, v49
    v_xor_b32 v34, s49, v50
    v_xor_b32 v35, s49, v51
    s_nop 1
    v_mfma_f32_32x32x16_bf16 v[216:231], v[96:99], v[32:35], v[216:231]
    s_waitcnt lgkmcnt(2)
    v_mfma_f32_32x32x16_bf16 v[200:215], v[100:103], v[52:55], v[200:215]
    v_xor_b32 v36, s49, v52
    v_xor_b32 v37, s49, v53
    v_xor_b32 v38, s49, v54
    v_xor_b32 v39, s49, v55
    s_nop 1
    v_mfma_f32_32x32x16_bf16 v[216:231], v[100:103], v[36:39], v[216:231]
    s_waitcnt lgkmcnt(1)
    v_mfma_f32_32x32x16_bf16 v[200:215], v[104:107], v[56:59], v[200:215]
    v_xor_b32 v40, s49, v56
    v_xor_b32 v41, s49, v57
    v_xor_b32 v42, s49, v58
    v_xor_b32 v43, s49, v59
    s_nop 1
    v_mfma_f32_32x32x16_bf16 v[216:231], v[104:107], v[40:43], v[216:231]
    s_waitcnt lgkmcnt(0)
    s_add_u32 m0, s52, 0
    s_add_u32 s44, s47, 256
    buffer_load_dwordx4 v20, s[28:31], s44 offen lds
    s_add_u32 m0, s52, 1024
    s_add_u32 s44, s47, 256
    buffer_load_dwordx4 v21, s[28:31], s44 offen lds
    s_add_u32 m0, s52, 2048
    s_add_u32 s44, s47, 65792
    buffer_load_dwordx4 v20, s[28:31], s44 offen lds
    s_add_u32 m0, s52, 3072
    s_add_u32 s44, s47, 65792
    buffer_load_dwordx4 v21, s[28:31], s44 offen lds
    v_mfma_f32_32x32x16_bf16 v[200:215], v[108:111], v[60:63], v[200:215]
    v_xor_b32 v44, s49, v60
    v_xor_b32 v45, s49, v61
    v_xor_b32 v46, s49, v62
    v_xor_b32 v47, s49, v63
    s_nop 1
    v_mfma_f32_32x32x16_bf16 v[216:231], v[108:111], v[44:47], v[216:231]
    s_waitcnt vmcnt(12)
    ds_read_b128 v[48:51], v12 offset:4096
    ds_read_b128 v[52:55], v13 offset:4096
    ds_read_b128 v[56:59], v14 offset:4096
    ds_read_b128 v[60:63], v15 offset:4096
    s_waitcnt lgkmcnt(3)
    v_mfma_f32_32x32x16_bf16 v[200:215], v[112:115], v[48:51], v[200:215]
    v_xor_b32 v32, s49, v48
    v_xor_b32 v33, s49, v49
    v_xor_b32 v34, s49, v50
    v_xor_b32 v35, s49, v51
    s_nop 1
    v_mfma_f32_32x32x16_bf16 v[216:231], v[112:115], v[32:35], v[216:231]
    s_waitcnt lgkmcnt(2)
    v_mfma_f32_32x32x16_bf16 v[200:215], v[116:119], v[52:55], v[200:215]
    v_xor_b32 v36, s49, v52
    v_xor_b32 v37, s49, v53
    v_xor_b32 v38, s49, v54
    v_xor_b32 v39, s49, v55
    s_nop 1
    v_mfma_f32_32x32x16_bf16 v[216:231], v[116:119], v[36:39], v[216:231]
    s_waitcnt lgkmcnt(1)
    v_mfma_f32_32x32x16_bf16 v[200:215], v[120:123], v[56:59], v[200:215]
    v_xor_b32 v40, s49, v56
    v_xor_b32 v41, s49, v57
    v_xor_b32 v42, s49, v58
    v_xor_b32 v43, s49, v59
    s_nop 1
    v_mfma_f32_32x32x16_bf16 v[216:231], v[120:123], v[40:43], v[216:231]
    s_waitcnt lgkmcnt(0)
    s_add_u32 m0, s53, 0
    s_add_u32 s44, s47, 384
    buffer_load_dwordx4 v20, s[28:31], s44 offen lds
    s_add_u32 m0, s53, 1024
    s_add_u32 s44, s47, 384
    buffer_load_dwordx4 v21, s[28:31], s44 offen lds
    s_add_u32 m0, s53, 2048
    s_add_u32 s44, s47, 65920
    buffer_load_dwordx4 v20, s[28:31], s44 offen lds
    s_add_u32 m0, s53, 3072
    s_add_u32 s44, s47, 65920
    buffer_load_dwordx4 v21, s[28:31], s44 offen lds
    v_mfma_f32_32x32x16_bf16 v[200:215], v[124:127], v[60:63], v[200:215]
    v_xor_b32 v44, s49, v60
    v_xor_b32 v45, s49, v61
    v_xor_b32 v46, s49, v62
    v_xor_b32 v47, s49, v63
    s_nop 1
    v_mfma_f32_32x32x16_bf16 v[216:231], v[124:127], v[44:47], v[216:231]
    s_nop 4
    v_cvt_pk_bf16_f32 v248, v200, v201
    v_cvt_pk_bf16_f32 v249, v202, v203
    v_cvt_pk_bf16_f32 v250, v204, v205
    v_cvt_pk_bf16_f32 v251, v206, v207
    v_cvt_pk_bf16_f32 v252, v208, v209
    v_cvt_pk_bf16_f32 v253, v210, v211
    v_cvt_pk_bf16_f32 v254, v212, v213
    v_cvt_pk_bf16_f32 v255, v214, v215
    s_add_u32 s44, s48, 608256
    buffer_store_dwordx4 v[248:251], v16, s[24:27], s48 offen sc1
    buffer_store_dwordx4 v[252:255], v16, s[24:27], s44 offen sc1
    s_nop 0
    v_cvt_pk_bf16_f32 v248, v216, v217
    v_cvt_pk_bf16_f32 v249, v218, v219
    v_cvt_pk_bf16_f32 v250, v220, v221
    v_cvt_pk_bf16_f32 v251, v222, v223
    v_cvt_pk_bf16_f32 v252, v224, v225
    v_cvt_pk_bf16_f32 v253, v226, v227
    v_cvt_pk_bf16_f32 v254, v228, v229
    v_cvt_pk_bf16_f32 v255, v230, v231
    s_add_u32 s44, s63, 608256
    buffer_store_dwordx4 v[248:251], v17, s[24:27], s63 offen sc1
    buffer_store_dwordx4 v[252:255], v17, s[24:27], s44 offen sc1
    s_mul_i32 s44, s62, 33792
    s_add_u32 s48, s55, s44
    s_sub_u32 s63, s55, s44
    s_xor_b32 s62, s62, 1
    v_xor_b32 v32, s49, v28
    v_xor_b32 v33, s49, v29
    v_xor_b32 v34, s49, v30
    v_xor_b32 v35, s49, v31
    v_mfma_f32_32x32x16_bf16 v[200:215], v[128:131], v[28:31], 0
    s_nop 0
    v_mfma_f32_32x32x16_bf16 v[216:231], v[128:131], v[32:35], 0
    s_waitcnt vmcnt(16)
    ds_read_b128 v[48:51], v8 offset:0
    ds_read_b128 v[52:55], v9 offset:0
    ds_read_b128 v[56:59], v10 offset:0
    ds_read_b128 v[60:63], v11 offset:0
    s_waitcnt lgkmcnt(3)
    v_mfma_f32_32x32x16_bf16 v[200:215], v[64:67], v[48:51], v[200:215]
    v_xor_b32 v32, s49, v48
    v_xor_b32 v33, s49, v49
    v_xor_b32 v34, s49, v50
    v_xor_b32 v35, s49, v51
    s_nop 1
    v_mfma_f32_32x32x16_bf16 v[216:231], v[64:67], v[32:35], v[216:231]
    s_waitcnt lgkmcnt(2)
    v_mfma_f32_32x32x16_bf16 v[200:215], v[68:71], v[52:55], v[200:215]
    v_xor_b32 v36, s49, v52
    v_xor_b32 v37, s49, v53
    v_xor_b32 v38, s49, v54
    v_xor_b32 v39, s49, v55
    s_nop 1
    v_mfma_f32_32x32x16_bf16 v[216:231], v[68:71], v[36:39], v[216:231]
    s_waitcnt lgkmcnt(1)
    v_mfma_f32_32x32x16_bf16 v[200:215], v[72:75], v[56:59], v[200:215]
    v_xor_b32 v40, s49, v56
    v_xor_b32 v41, s49, v57
    v_xor_b32 v42, s49, v58
    v_xor_b32 v43, s49, v59
    s_nop 1
    v_mfma_f32_32x32x16_bf16 v[216:231], v[72:75], v[40:43], v[216:231]
    s_waitcnt lgkmcnt(0)
    v_mfma_f32_32x32x16_bf16 v[200:215], v[76:79], v[60:63], v[200:215]
    v_xor_b32 v44, s49, v60
    v_xor_b32 v45, s49, v61
    v_xor_b32 v46, s49, v62
    v_xor_b32 v47, s49, v63
    s_nop 1
    v_mfma_f32_32x32x16_bf16 v[216:231], v[76:79], v[44:47], v[216:231]
    s_waitcnt vmcnt(12)
    ds_read_b128 v[48:51], v8 offset:4096
    ds_read_b128 v[52:55], v9 offset:4096
    ds_read_b128 v[56:59], v10 offset:4096
    ds_read_b128 v[60:63], v11 offset:4096
    s_waitcnt lgkmcnt(3)
    v_mfma_f32_32x32x16_bf16 v[200:215], v[80:83], v[48:51], v[200:215]
    v_xor_b32 v32, s49, v48
    v_xor_b32 v33, s49, v49
    v_xor_b32 v34, s49, v50
    v_xor_b32 v35, s49, v51
    s_nop 1
    v_mfma_f32_32x32x16_bf16 v[216:231], v[80:83], v[32:35], v[216:231]
    s_waitcnt lgkmcnt(2)
    v_mfma_f32_32x32x16_bf16 v[200:215], v[84:87], v[52:55], v[200:215]
    v_xor_b32 v36, s49, v52
    v_xor_b32 v37, s49, v53
    v_xor_b32 v38, s49, v54
    v_xor_b32 v39, s49, v55
    s_nop 1
    v_mfma_f32_32x32x16_bf16 v[216:231], v[84:87], v[36:39], v[216:231]
    s_waitcnt lgkmcnt(1)
    v_mfma_f32_32x32x16_bf16 v[200:215], v[88:91], v[56:59], v[200:215]
    v_xor_b32 v40, s49, v56
    v_xor_b32 v41, s49, v57
    v_xor_b32 v42, s49, v58
    v_xor_b32 v43, s49, v59
    s_nop 1
    v_mfma_f32_32x32x16_bf16 v[216:231], v[88:91], v[40:43], v[216:231]
    s_waitcnt lgkmcnt(0)
    v_mfma_f32_32x32x16_bf16 v[200:215], v[92:95], v[60:63], v[200:215]
    v_xor_b32 v44, s49, v60
    v_xor_b32 v45, s49, v61
    v_xor_b32 v46, s49, v62
    v_xor_b32 v47, s49, v63
    s_nop 1
    v_mfma_f32_32x32x16_bf16 v[216:231], v[92:95], v[44:47], v[216:231]
    s_waitcnt vmcnt(8)
    ds_read_b128 v[48:51], v12 offset:0
    ds_read_b128 v[52:55], v13 offset:0
    ds_read_b128 v[56:59], v14 offset:0
    ds_read_b128 v[60:63], v15 offset:0
    s_waitcnt lgkmcnt(3)
    v_mfma_f32_32x32x16_bf16 v[200:215], v[96:99], v[48:51], v[200:215]
    v_xor_b32 v32, s49, v48
    v_xor_b32 v33, s49, v49
    v_xor_b32 v34, s49, v50
    v_xor_b32 v35, s49, v51
    s_nop 1
    v_mfma_f32_32x32x16_bf16 v[216:231], v[96:99], v[32:35], v[216:231]
    s_waitcnt lgkmcnt(2)
    v_mfma_f32_32x32x16_bf16 v[200:215], v[100:103], v[52:55], v[200:215]
    v_xor_b32 v36, s49, v52
    v_xor_b32 v37, s49, v53
    v_xor_b32 v38, s49, v54
    v_xor_b32 v39, s49, v55
    s_nop 1
    v_mfma_f32_32x32x16_bf16 v[216:231], v[100:103], v[36:39], v[216:231]
    s_waitcnt lgkmcnt(1)
    v_mfma_f32_32x32x16_bf16 v[200:215], v[104:107], v[56:59], v[200:215]
    v_xor_b32 v40, s49, v56
    v_xor_b32 v41, s49, v57
    v_xor_b32 v42, s49, v58
    v_xor_b32 v43, s49, v59
    s_nop 1
    v_mfma_f32_32x32x16_bf16 v[216:231], v[104:107], v[40:43], v[216:231]
    s_waitcnt lgkmcnt(0)
    v_mfma_f32_32x32x16_bf16 v[200:215], v[108:111], v[60:63], v[200:215]
    v_xor_b32 v44, s49, v60
    v_xor_b32 v45, s49, v61
    v_xor_b32 v46, s49, v62
    v_xor_b32 v47, s49, v63
    s_nop 1
    v_mfma_f32_32x32x16_bf16 v[216:231], v[108:111], v[44:47], v[216:231]
    s_waitcnt vmcnt(4)
    ds_read_b128 v[48:51], v12 offset:4096
    ds_read_b128 v[52:55], v13 offset:4096
    ds_read_b128 v[56:59], v14 offset:4096
    ds_read_b128 v[60:63], v15 offset:4096
    s_waitcnt lgkmcnt(3)
    v_mfma_f32_32x32x16_bf16 v[200:215], v[112:115], v[48:51], v[200:215]
    v_xor_b32 v32, s49, v48
    v_xor_b32 v33, s49, v49
    v_xor_b32 v34, s49, v50
    v_xor_b32 v35, s49, v51
    s_nop 1
    v_mfma_f32_32x32x16_bf16 v[216:231], v[112:115], v[32:35], v[216:231]
    s_waitcnt lgkmcnt(2)
    v_mfma_f32_32x32x16_bf16 v[200:215], v[116:119], v[52:55], v[200:215]
    v_xor_b32 v36, s49, v52
    v_xor_b32 v37, s49, v53
    v_xor_b32 v38, s49, v54
    v_xor_b32 v39, s49, v55
    s_nop 1
    v_mfma_f32_32x32x16_bf16 v[216:231], v[116:119], v[36:39], v[216:231]
    s_waitcnt lgkmcnt(1)
    v_mfma_f32_32x32x16_bf16 v[200:215], v[120:123], v[56:59], v[200:215]
    v_xor_b32 v40, s49, v56
    v_xor_b32 v41, s49, v57
    v_xor_b32 v42, s49, v58
    v_xor_b32 v43, s49, v59
    s_nop 1
    v_mfma_f32_32x32x16_bf16 v[216:231], v[120:123], v[40:43], v[216:231]
    s_waitcnt lgkmcnt(0)
    v_mfma_f32_32x32x16_bf16 v[200:215], v[124:127], v[60:63], v[200:215]
    v_xor_b32 v44, s49, v60
    v_xor_b32 v45, s49, v61
    v_xor_b32 v46, s49, v62
    v_xor_b32 v47, s49, v63
    s_nop 1
    v_mfma_f32_32x32x16_bf16 v[216:231], v[124:127], v[44:47], v[216:231]
    s_nop 4
    v_cvt_pk_bf16_f32 v248, v200, v201
    v_cvt_pk_bf16_f32 v249, v202, v203
    v_cvt_pk_bf16_f32 v250, v204, v205
    v_cvt_pk_bf16_f32 v251, v206, v207
    v_cvt_pk_bf16_f32 v252, v208, v209
    v_cvt_pk_bf16_f32 v253, v210, v211
    v_cvt_pk_bf16_f32 v254, v212, v213
    v_cvt_pk_bf16_f32 v255, v214, v215
    s_add_u32 s44, s48, 608256
    buffer_store_dwordx4 v[248:251], v16, s[24:27], s48 offen sc1
    buffer_store_dwordx4 v[252:255], v16, s[24:27], s44 offen sc1
    s_nop 0
    v_cvt_pk_bf16_f32 v248, v216, v217
    v_cvt_pk_bf16_f32 v249, v218, v219
    v_cvt_pk_bf16_f32 v250, v220, v221
    v_cvt_pk_bf16_f32 v251, v222, v223
    v_cvt_pk_bf16_f32 v252, v224, v225
    v_cvt_pk_bf16_f32 v253, v226, v227
    v_cvt_pk_bf16_f32 v254, v228, v229
    v_cvt_pk_bf16_f32 v255, v230, v231
    s_add_u32 s44, s63, 608256
    buffer_store_dwordx4 v[248:251], v17, s[24:27], s63 offen sc1
    buffer_store_dwordx4 v[252:255], v17, s[24:27], s44 offen sc1
    s_branch L_k1s_done
L_k1s_dual:
    ds_read_b128 v[132:135], v24 offset:0
    ds_read_b128 v[136:139], v24 offset:32
    ds_read_b128 v[140:143], v24 offset:64
    ds_read_b128 v[144:147], v24 offset:96
    ds_read_b128 v[148:151], v24 offset:128
    ds_read_b128 v[152:155], v24 offset:160
    ds_read_b128 v[156:159], v24 offset:192
    ds_read_b128 v[160:163], v24 offset:224
    ds_read_b128 v[164:167], v24 offset:256
    ds_read_b128 v[168:171], v24 offset:288
    ds_read_b128 v[172:175], v24 offset:320
    ds_read_b128 v[176:179], v24 offset:352
    ds_read_b128 v[180:183], v24 offset:384
    ds_read_b128 v[184:187], v24 offset:416
    ds_read_b128 v[188:191], v24 offset:448
    ds_read_b128 v[192:195], v24 offset:480
    ds_read_b128 v[196:199], v25 offset:512
    v_lshlrev_b32 v2, 31, v1
    s_waitcnt lgkmcnt(0)
    v_xor_b32 v132, v2, v132
    v_xor_b32 v133, v2, v133
    v_xor_b32 v134, v2, v134
    v_xor_b32 v135, v2, v135
    v_xor_b32 v136, v2, v136
    v_xor_b32 v137, v2, v137
    v_xor_b32 v138, v2, v138
    v_xor_b32 v139, v2, v139
    v_xor_b32 v140, v2, v140
    v_xor_b32 v141, v2, v141
    v_xor_b32 v142, v2, v142
    v_xor_b32 v143, v2, v143
    v_xor_b32 v144, v2, v144
    v_xor_b32 v145, v2, v145
    v_xor_b32 v146, v2, v146
    v_xor_b32 v147, v2, v147
    v_xor_b32 v148, v2, v148
    v_xor_b32 v149, v2, v149
    v_xor_b32 v150, v2, v150
    v_xor_b32 v151, v2, v151
    v_xor_b32 v152, v2, v152
    v_xor_b32 v153, v2, v153
    v_xor_b32 v154, v2, v154
    v_xor_b32 v155, v2, v155
    v_xor_b32 v156, v2, v156
    v_xor_b32 v157, v2, v157
    v_xor_b32 v158, v2, v158
    v_xor_b32 v159, v2, v159
    v_xor_b32 v160, v2, v160
    v_xor_b32 v161, v2, v161
    v_xor_b32 v162, v2, v162
    v_xor_b32 v163, v2, v163
    v_xor_b32 v164, v2, v164
    v_xor_b32 v165, v2, v165
    v_xor_b32 v166, v2, v166
    v_xor_b32 v167, v2, v167
    v_xor_b32 v168, v2, v168
    v_xor_b32 v169, v2, v169
    v_xor_b32 v170, v2, v170
    v_xor_b32 v171, v2, v171
    v_xor_b32 v172, v2, v172
    v_xor_b32 v173, v2, v173
    v_xor_b32 v174, v2, v174
    v_xor_b32 v175, v2, v175
    v_xor_b32 v176, v2, v176
    v_xor_b32 v177, v2, v177
    v_xor_b32 v178, v2, v178
    v_xor_b32 v179, v2, v179
    v_xor_b32 v180, v2, v180
    v_xor_b32 v181, v2, v181
    v_xor_b32 v182, v2, v182
    v_xor_b32 v183, v2, v183
    v_xor_b32 v184, v2, v184
    v_xor_b32 v185, v2, v185
    v_xor_b32 v186, v2, v186
    v_xor_b32 v187, v2, v187
    v_xor_b32 v188, v2, v188
    v_xor_b32 v189, v2, v189
    v_xor_b32 v190, v2, v190
    v_xor_b32 v191, v2, v191
    v_xor_b32 v192, v2, v192
    v_xor_b32 v193, v2, v193
    v_xor_b32 v194, v2, v194
    v_xor_b32 v195, v2, v195
    v_xor_b32 v196, v2, v196
    v_xor_b32 v197, v2, v197
    v_xor_b32 v198, v2, v198
    v_xor_b32 v199, v2, v199
    s_and_b32 s44, s32, 3
    s_cmp_lg_u32 s44, 1
    s_cbranch_scc1 L_k1s_noxd
    v_mfma_f32_32x32x16_bf16 v[200:215], v[128:131], v[28:31], 0
    v_mfma_f32_32x32x16_bf16 v[232:247], v[196:199], v[28:31], 0
    ds_read_b128 v[48:51], v19 offset:0
    ds_read_b128 v[52:55], v19 offset:32
    ds_read_b128 v[56:59], v19 offset:64
    ds_read_b128 v[60:63], v19 offset:96
    s_waitcnt lgkmcnt(3)
    v_mfma_f32_32x32x16_bf16 v[200:215], v[64:67], v[48:51], v[200:215]
    v_mfma_f32_32x32x16_bf16 v[232:247], v[132:135], v[48:51], v[232:247]
    s_waitcnt lgkmcnt(2)
    v_mfma_f32_32x32x16_bf16 v[200:215], v[68:71], v[52:55], v[200:215]
    v_mfma_f32_32x32x16_bf16 v[232:247], v[136:139], v[52:55], v[232:247]
    s_waitcnt lgkmcnt(1)
    v_mfma_f32_32x32x16_bf16 v[200:215], v[72:75], v[56:59], v[200:215]
    v_mfma_f32_32x32x16_bf16 v[232:247], v[140:143], v[56:59], v[232:247]
    s_waitcnt lgkmcnt(0)
    v_mfma_f32_32x32x16_bf16 v[200:215], v[76:79], v[60:63], v[200:215]
    v_mfma_f32_32x32x16_bf16 v[232:247], v[144:147], v[60:63], v[232:247]
    ds_read_b128 v[48:51], v19 offset:128
    ds_read_b128 v[52:55], v19 offset:160
    ds_read_b128 v[56:59], v19 offset:192
    ds_read_b128 v[60:63], v19 offset:224
    s_waitcnt lgkmcnt(3)
    v_mfma_f32_32x32x16_bf16 v[200:215], v[80:83], v[48:51], v[200:215]
    v_mfma_f32_32x32x16_bf16 v[232:247], v[148:151], v[48:51], v[232:247]
    s_waitcnt lgkmcnt(2)
    v_mfma_f32_32x32x16_bf16 v[200:215], v[84:87], v[52:55], v[200:215]
    v_mfma_f32_32x32x16_bf16 v[232:247], v[152:155], v[52:55], v[232:247]
    s_waitcnt lgkmcnt(1)
    v_mfma_f32_32x32x16_bf16 v[200:215], v[88:91], v[56:59], v[200:215]
    v_mfma_f32_32x32x16_bf16 v[232:247], v[156:159], v[56:59], v[232:247]
    s_waitcnt lgkmcnt(0)
    v_mfma_f32_32x32x16_bf16 v[200:215], v[92:95], v[60:63], v[200:215]
    v_mfma_f32_32x32x16_bf16 v[232:247], v[160:163], v[60:63], v[232:247]
    ds_read_b128 v[48:51], v19 offset:256
    ds_read_b128 v[52:55], v19 offset:288
    ds_read_b128 v[56:59], v19 offset:320
    ds_read_b128 v[60:63], v19 offset:352
    s_waitcnt lgkmcnt(3)
    v_mfma_f32_32x32x16_bf16 v[200:215], v[96:99], v[48:51], v[200:215]
    v_mfma_f32_32x32x16_bf16 v[232:247], v[164:167], v[48:51], v[232:247]
    s_waitcnt lgkmcnt(2)
    v_mfma_f32_32x32x16_bf16 v[200:215], v[100:103], v[52:55], v[200:215]
    v_mfma_f32_32x32x16_bf16 v[232:247], v[168:171], v[52:55], v[232:247]
    s_waitcnt lgkmcnt(1)
    v_mfma_f32_32x32x16_bf16 v[200:215], v[104:107], v[56:59], v[200:215]
    v_mfma_f32_32x32x16_bf16 v[232:247], v[172:175], v[56:59], v[232:247]
    s_waitcnt lgkmcnt(0)
    v_mfma_f32_32x32x16_bf16 v[200:215], v[108:111], v[60:63], v[200:215]
    v_mfma_f32_32x32x16_bf16 v[232:247], v[176:179], v[60:63], v[232:247]
    ds_read_b128 v[48:51], v19 offset:384
    ds_read_b128 v[52:55], v19 offset:416
    ds_read_b128 v[56:59], v19 offset:448
    ds_read_b128 v[60:63], v19 offset:480
    s_waitcnt lgkmcnt(3)
    v_mfma_f32_32x32x16_bf16 v[200:215], v[112:115], v[48:51], v[200:215]
    v_mfma_f32_32x32x16_bf16 v[232:247], v[180:183], v[48:51], v[232:247]
    s_waitcnt lgkmcnt(2)
    v_mfma_f32_32x32x16_bf16 v[200:215], v[116:119], v[52:55], v[200:215]
    v_mfma_f32_32x32x16_bf16 v[232:247], v[184:187], v[52:55], v[232:247]
    s_waitcnt lgkmcnt(1)
    v_mfma_f32_32x32x16_bf16 v[200:215], v[120:123], v[56:59], v[200:215]
    v_mfma_f32_32x32x16_bf16 v[232:247], v[188:191], v[56:59], v[232:247]
    s_waitcnt lgkmcnt(0)
    v_mfma_f32_32x32x16_bf16 v[200:215], v[124:127], v[60:63], v[200:215]
    v_mfma_f32_32x32x16_bf16 v[232:247], v[192:195], v[60:63], v[232:247]
    s_nop 10
    v_cvt_pk_bf16_f32 v248, v200, v201
    v_cvt_pk_bf16_f32 v249, v202, v203
    v_cvt_pk_bf16_f32 v250, v204, v205
    v_cvt_pk_bf16_f32 v251, v206, v207
    v_cvt_pk_bf16_f32 v252, v208, v209
    v_cvt_pk_bf16_f32 v253, v210, v211
    v_cvt_pk_bf16_f32 v254, v212, v213
    v_cvt_pk_bf16_f32 v255, v214, v215
    s_add_u32 s44, s55, 608256
    buffer_store_dwordx4 v[248:251], v18, s[24:27], s55 offen sc1
    buffer_store_dwordx4 v[252:255], v18, s[24:27], s44 offen sc1
    v_cvt_pk_bf16_f32 v2, v232, v233
    s_mov_b64 exec, 0xffffffff
    s_add_u32 s44, s55, 32768
    buffer_store_short v2, v18, s[24:27], s44 offen sc1
    s_mov_b64 exec, -1
L_k1s_noxd:
    s_mul_i32 s44, s62, 33792
    s_add_u32 s48, s55, s44
    s_sub_u32 s63, s55, s44
    s_xor_b32 s62, s62, 1
    v_xor_b32 v32, s49, v28
    v_xor_b32 v33, s49, v29
    v_xor_b32 v34, s49, v30
    v_xor_b32 v35, s49, v31
    v_mfma_f32_32x32x16_bf16 v[200:215], v[128:131], v[28:31], 0
    s_nop 0
    v_mfma_f32_32x32x16_bf16 v[216:231], v[128:131], v[32:35], 0
    v_mfma_f32_32x32x16_bf16 v[232:247], v[196:199], v[28:31], 0
    ds_read_b128 v[48:51], v8 offset:0
    ds_read_b128 v[52:55], v9 offset:0
    ds_read_b128 v[56:59], v10 offset:0
    ds_read_b128 v[60:63], v11 offset:0
    s_waitcnt lgkmcnt(3)
    v_mfma_f32_32x32x16_bf16 v[200:215], v[64:67], v[48:51], v[200:215]
    v_xor_b32 v32, s49, v48
    v_xor_b32 v33, s49, v49
    v_xor_b32 v34, s49, v50
    v_xor_b32 v35, s49, v51
    v_mfma_f32_32x32x16_bf16 v[232:247], v[132:135], v[48:51], v[232:247]
    s_nop 0
    v_mfma_f32_32x32x16_bf16 v[216:231], v[64:67], v[32:35], v[216:231]
    s_waitcnt lgkmcnt(2)
    v_mfma_f32_32x32x16_bf16 v[200:215], v[68:71], v[52:55], v[200:215]
    v_xor_b32 v36, s49, v52
    v_xor_b32 v37, s49, v53
    v_xor_b32 v38, s49, v54
    v_xor_b32 v39, s49, v55
    v_mfma_f32_32x32x16_bf16 v[232:247], v[136:139], v[52:55], v[232:247]
    s_nop 0
    v_mfma_f32_32x32x16_bf16 v[216:231], v[68:71], v[36:39], v[216:231]
    s_waitcnt lgkmcnt(1)
    v_mfma_f32_32x32x16_bf16 v[200:215], v[72:75], v[56:59], v[200:215]
    v_xor_b32 v40, s49, v56
    v_xor_b32 v41, s49, v57
    v_xor_b32 v42, s49, v58
    v_xor_b32 v43, s49, v59
    v_mfma_f32_32x32x16_bf16 v[232:247], v[140:143], v[56:59], v[232:247]
    s_nop 0
    v_mfma_f32_32x32x16_bf16 v[216:231], v[72:75], v[40:43], v[216:231]
    s_waitcnt lgkmcnt(0)
    s_add_u32 m0, s50, 0
    s_add_u32 s44, s47, 0
    buffer_load_dwordx4 v20, s[28:31], s44 offen lds
    s_add_u32 m0, s50, 1024
    s_add_u32 s44, s47, 0
    buffer_load_dwordx4 v21, s[28:31], s44 offen lds
    s_add_u32 m0, s50, 2048
    s_add_u32 s44, s47, 65536
    buffer_load_dwordx4 v20, s[28:31], s44 offen lds
    s_add_u32 m0, s50, 3072
    s_add_u32 s44, s47, 65536
    buffer_load_dwordx4 v21, s[28:31], s44 offen lds
    v_mfma_f32_32x32x16_bf16 v[200:215], v[76:79], v[60:63], v[200:215]
    v_xor_b32 v44, s49, v60
    v_xor_b32 v45, s49, v61
    v_xor_b32 v46, s49, v62
    v_xor_b32 v47, s49, v63
    v_mfma_f32_32x32x16_bf16 v[232:247], v[144:147], v[60:63], v[232:247]
    s_nop 0
    v_mfma_f32_32x32x16_bf16 v[216:231], v[76:79], v[44:47], v[216:231]
    ds_read_b128 v[48:51], v8 offset:4096
    ds_read_b128 v[52:55], v9 offset:4096
    ds_read_b128 v[56:59], v10 offset:4096
    ds_read_b128 v[60:63], v11 offset:4096
    s_waitcnt lgkmcnt(3)
    v_mfma_f32_32x32x16_bf16 v[200:215], v[80:83], v[48:51], v[200:215]
    v_xor_b32 v32, s49, v48
    v_xor_b32 v33, s49, v49
    v_xor_b32 v34, s49, v50
    v_xor_b32 v35, s49, v51
    v_mfma_f32_32x32x16_bf16 v[232:247], v[148:151], v[48:51], v[232:247]
    s_nop 0
    v_mfma_f32_32x32x16_bf16 v[216:231], v[80:83], v[32:35], v[216:231]
    s_waitcnt lgkmcnt(2)
    v_mfma_f32_32x32x16_bf16 v[200:215], v[84:87], v[52:55], v[200:215]
    v_xor_b32 v36, s49, v52
    v_xor_b32 v37, s49, v53
    v_xor_b32 v38, s49, v54
    v_xor_b32 v39, s49, v55
    v_mfma_f32_32x32x16_bf16 v[232:247], v[152:155], v[52:55], v[232:247]
    s_nop 0
    v_mfma_f32_32x32x16_bf16 v[216:231], v[84:87], v[36:39], v[216:231]
    s_waitcnt lgkmcnt(1)
    v_mfma_f32_32x32x16_bf16 v[200:215], v[88:91], v[56:59], v[200:215]
    v_xor_b32 v40, s49, v56
    v_xor_b32 v41, s49, v57
    v_xor_b32 v42, s49, v58
    v_xor_b32 v43, s49, v59
    v_mfma_f32_32x32x16_bf16 v[232:247], v[156:159], v[56:59], v[232:247]
    s_nop 0
    v_mfma_f32_32x32x16_bf16 v[216:231], v[88:91], v[40:43], v[216:231]
    s_waitcnt lgkmcnt(0)
    s_add_u32 m0, s51, 0
    s_add_u32 s44, s47, 128
    buffer_load_dwordx4 v20, s[28:31], s44 offen lds
    s_add_u32 m0, s51, 1024
    s_add_u32 s44, s47, 128
    buffer_load_dwordx4 v21, s[28:31], s44 offen lds
    s_add_u32 m0, s51, 2048
    s_add_u32 s44, s47, 65664
    buffer_load_dwordx4 v20, s[28:31], s44 offen lds
    s_add_u32 m0, s51, 3072
    s_add_u32 s44, s47, 65664
    buffer_load_dwordx4 v21, s[28:31], s44 offen lds
    v_mfma_f32_32x32x16_bf16 v[200:215], v[92:95], v[60:63], v[200:215]
    v_xor_b32 v44, s49, v60
    v_xor_b32 v45, s49, v61
    v_xor_b32 v46, s49, v62
    v_xor_b32 v47, s49, v63
    v_mfma_f32_32x32x16_bf16 v[232:247], v[160:163], v[60:63], v[232:247]
    s_nop 0
    v_mfma_f32_32x32x16_bf16 v[216:231], v[92:95], v[44:47], v[216:231]
    s_waitcnt vmcnt(12)
    ds_read_b128 v[48:51], v12 offset:0
    ds_read_b128 v[52:55], v13 offset:0
    ds_read_b128 v[56:59], v14 offset:0
    ds_read_b128 v[60:63], v15 offset:0
    s_waitcnt lgkmcnt(3)
    v_mfma_f32_32x32x16_bf16 v[200:215], v[96:99], v[48:51], v[200:215]
    v_xor_b32 v32, s49, v48
    v_xor_b32 v33, s49, v49
    v_xor_b32 v34, s49, v50
    v_xor_b32 v35, s49, v51
    v_mfma_f32_32x32x16_bf16 v[232:247], v[164:167], v[48:51], v[232:247]
    s_nop 0
    v_mfma_f32_32x32x16_bf16 v[216:231], v[96:99], v[32:35], v[216:231]
    s_waitcnt lgkmcnt(2)
    v_mfma_f32_32x32x16_bf16 v[200:215], v[100:103], v[52:55], v[200:215]
    v_xor_b32 v36, s49, v52
    v_xor_b32 v37, s49, v53
    v_xor_b32 v38, s49, v54
    v_xor_b32 v39, s49, v55
    v_mfma_f32_32x32x16_bf16 v[232:247], v[168:171], v[52:55], v[232:247]
    s_nop 0
    v_mfma_f32_32x32x16_bf16 v[216:231], v[100:103], v[36:39], v[216:231]
    s_waitcnt lgkmcnt(1)
    v_mfma_f32_32x32x16_bf16 v[200:215], v[104:107], v[56:59], v[200:215]
    v_xor_b32 v40, s49, v56
    v_xor_b32 v41, s49, v57
    v_xor_b32 v42, s49, v58
    v_xor_b32 v43, s49, v59
    v_mfma_f32_32x32x16_bf16 v[232:247], v[172:175], v[56:59], v[232:247]
    s_nop 0
    v_mfma_f32_32x32x16_bf16 v[216:231], v[104:107], v[40:43], v[216:231]
    s_waitcnt lgkmcnt(0)
    s_add_u32 m0, s52, 0
    s_add_u32 s44, s47, 256
    buffer_load_dwordx4 v20, s[28:31], s44 offen lds
    s_add_u32 m0, s52, 1024
    s_add_u32 s44, s47, 256
    buffer_load_dwordx4 v21, s[28:31], s44 offen lds
    s_add_u32 m0, s52, 2048
    s_add_u32 s44, s47, 65792
    buffer_load_dwordx4 v20, s[28:31], s44 offen lds
    s_add_u32 m0, s52, 3072
    s_add_u32 s44, s47, 65792
    buffer_load_dwordx4 v21, s[28:31], s44 offen lds
    v_mfma_f32_32x32x16_bf16 v[200:215], v[108:111], v[60:63], v[200:215]
    v_xor_b32 v44, s49, v60
    v_xor_b32 v45, s49, v61
    v_xor_b32 v46, s49, v62
    v_xor_b32 v47, s49, v63
    v_mfma_f32_32x32x16_bf16 v[232:247], v[176:179], v[60:63], v[232:247]
    s_nop 0
    v_mfma_f32_32x32x16_bf16 v[216:231], v[108:111], v[44:47], v[216:231]
    s_waitcnt vmcnt(12)
    ds_read_b128 v[48:51], v12 offset:4096
    ds_read_b128 v[52:55], v13 offset:4096
    ds_read_b128 v[56:59], v14 offset:4096
    ds_read_b128 v[60:63], v15 offset:4096
    s_waitcnt lgkmcnt(3)
    v_mfma_f32_32x32x16_bf16 v[200:215], v[112:115], v[48:51], v[200:215]
    v_xor_b32 v32, s49, v48
    v_xor_b32 v33, s49, v49
    v_xor_b32 v34, s49, v50
    v_xor_b32 v35, s49, v51
    v_mfma_f32_32x32x16_bf16 v[232:247], v[180:183], v[48:51], v[232:247]
    s_nop 0
    v_mfma_f32_32x32x16_bf16 v[216:231], v[112:115], v[32:35], v[216:231]
    s_waitcnt lgkmcnt(2)
    v_mfma_f32_32x32x16_bf16 v[200:215], v[116:119], v[52:55], v[200:215]
    v_xor_b32 v36, s49, v52
    v_xor_b32 v37, s49, v53
    v_xor_b32 v38, s49, v54
    v_xor_b32 v39, s49, v55
    v_mfma_f32_32x32x16_bf16 v[232:247], v[184:187], v[52:55], v[232:247]
    s_nop 0
    v_mfma_f32_32x32x16_bf16 v[216:231], v[116:119], v[36:39], v[216:231]
    s_waitcnt lgkmcnt(1)
    v_mfma_f32_32x32x16_bf16 v[200:215], v[120:123], v[56:59], v[200:215]
    v_xor_b32 v40, s49, v56
    v_xor_b32 v41, s49, v57
    v_xor_b32 v42, s49, v58
    v_xor_b32 v43, s49, v59
    v_mfma_f32_32x32x16_bf16 v[232:247], v[188:191], v[56:59], v[232:247]
    s_nop 0
    v_mfma_f32_32x32x16_bf16 v[216:231], v[120:123], v[40:43], v[216:231]
    s_waitcnt lgkmcnt(0)
    s_add_u32 m0, s53, 0
    s_add_u32 s44, s47, 384
    buffer_load_dwordx4 v20, s[28:31], s44 offen lds
    s_add_u32 m0, s53, 1024
    s_add_u32 s44, s47, 384
    buffer_load_dwordx4 v21, s[28:31], s44 offen lds
    s_add_u32 m0, s53, 2048
    s_add_u32 s44, s47, 65920
    buffer_load_dwordx4 v20, s[28:31], s44 offen lds
    s_add_u32 m0, s53, 3072
    s_add_u32 s44, s47, 65920
    buffer_load_dwordx4 v21, s[28:31], s44 offen lds
    v_mfma_f32_32x32x16_bf16 v[200:215], v[124:127], v[60:63], v[200:215]
    v_xor_b32 v44, s49, v60
    v_xor_b32 v45, s49, v61
    v_xor_b32 v46, s49, v62
    v_xor_b32 v47, s49, v63
    v_mfma_f32_32x32x16_bf16 v[232:247], v[192:195], v[60:63], v[232:247]
    s_nop 0
    v_mfma_f32_32x32x16_bf16 v[216:231], v[124:127], v[44:47], v[216:231]
    s_nop 4
    v_cvt_pk_bf16_f32 v248, v200, v201
    v_cvt_pk_bf16_f32 v249, v202, v203
    v_cvt_pk_bf16_f32 v250, v204, v205
    v_cvt_pk_bf16_f32 v251, v206, v207
    v_cvt_pk_bf16_f32 v252, v208, v209
    v_cvt_pk_bf16_f32 v253, v210, v211
    v_cvt_pk_bf16_f32 v254, v212, v213
    v_cvt_pk_bf16_f32 v255, v214, v215
    s_add_u32 s44, s48, 608256
    buffer_store_dwordx4 v[248:251], v16, s[24:27], s48 offen sc1
    buffer_store_dwordx4 v[252:255], v16, s[24:27], s44 offen sc1
    s_nop 0
    v_cvt_pk_bf16_f32 v248, v216, v217
    v_cvt_pk_bf16_f32 v249, v218, v219
    v_cvt_pk_bf16_f32 v250, v220, v221
    v_cvt_pk_bf16_f32 v251, v222, v223
    v_cvt_pk_bf16_f32 v252, v224, v225
    v_cvt_pk_bf16_f32 v253, v226, v227
    v_cvt_pk_bf16_f32 v254, v228, v229
    v_cvt_pk_bf16_f32 v255, v230, v231
    s_add_u32 s44, s63, 608256
    buffer_store_dwordx4 v[248:251], v17, s[24:27], s63 offen sc1
    buffer_store_dwordx4 v[252:255], v17, s[24:27], s44 offen sc1
    v_cvt_pk_bf16_f32 v2, v232, v233
    s_mov_b64 exec, 0xffffffff
    s_add_u32 s44, s48, 32768
    buffer_store_short v2, v16, s[24:27], s44 offen sc1
    s_add_u32 s44, s63, 32768
    buffer_store_short_d16_hi v2, v17, s[24:27], s44 offen sc1
    s_mov_b64 exec, -1
    s_mul_i32 s44, s62, 33792
    s_add_u32 s48, s55, s44
    s_sub_u32 s63, s55, s44
    s_xor_b32 s62, s62, 1
    v_xor_b32 v32, s49, v28
    v_xor_b32 v33, s49, v29
    v_xor_b32 v34, s49, v30
    v_xor_b32 v35, s49, v31
    v_mfma_f32_32x32x16_bf16 v[200:215], v[128:131], v[28:31], 0
    s_nop 0
    v_mfma_f32_32x32x16_bf16 v[216:231], v[128:131], v[32:35], 0
    v_mfma_f32_32x32x16_bf16 v[232:247], v[196:199], v[28:31], 0
    s_waitcnt vmcnt(18)
    ds_read_b128 v[48:51], v8 offset:0
    ds_read_b128 v[52:55], v9 offset:0
    ds_read_b128 v[56:59], v10 offset:0
    ds_read_b128 v[60:63], v11 offset:0
    s_waitcnt lgkmcnt(3)
    v_mfma_f32_32x32x16_bf16 v[200:215], v[64:67], v[48:51], v[200:215]
    v_xor_b32 v32, s49, v48
    v_xor_b32 v33, s49, v49
    v_xor_b32 v34, s49, v50
    v_xor_b32 v35, s49, v51
    v_mfma_f32_32x32x16_bf16 v[232:247], v[132:135], v[48:51], v[232:247]
    s_nop 0
    v_mfma_f32_32x32x16_bf16 v[216:231], v[64:67], v[32:35], v[216:231]
    s_waitcnt lgkmcnt(2)
    v_mfma_f32_32x32x16_bf16 v[200:215], v[68:71], v[52:55], v[200:215]
    v_xor_b32 v36, s49, v52
    v_xor_b32 v37, s49, v53
    v_xor_b32 v38, s49, v54
    v_xor_b32 v39, s49, v55
    v_mfma_f32_32x32x16_bf16 v[232:247], v[136:139], v[52:55], v[232:247]
    s_nop 0
    v_mfma_f32_32x32x16_bf16 v[216:231], v[68:71], v[36:39], v[216:231]
    s_waitcnt lgkmcnt(1)
    v_mfma_f32_32x32x16_bf16 v[200:215], v[72:75], v[56:59], v[200:215]
    v_xor_b32 v40, s49, v56
    v_xor_b32 v41, s49, v57
    v_xor_b32 v42, s49, v58
    v_xor_b32 v43, s49, v59
    v_mfma_f32_32x32x16_bf16 v[232:247], v[140:143], v[56:59], v[232:247]
    s_nop 0
    v_mfma_f32_32x32x16_bf16 v[216:231], v[72:75], v[40:43], v[216:231]
    s_waitcnt lgkmcnt(0)
    v_mfma_f32_32x32x16_bf16 v[200:215], v[76:79], v[60:63], v[200:215]
    v_xor_b32 v44, s49, v60
    v_xor_b32 v45, s49, v61
    v_xor_b32 v46, s49, v62
    v_xor_b32 v47, s49, v63
    v_mfma_f32_32x32x16_bf16 v[232:247], v[144:147], v[60:63], v[232:247]
    s_nop 0
    v_mfma_f32_32x32x16_bf16 v[216:231], v[76:79], v[44:47], v[216:231]
    s_waitcnt vmcnt(14)
    ds_read_b128 v[48:51], v8 offset:4096
    ds_read_b128 v[52:55], v9 offset:4096
    ds_read_b128 v[56:59], v10 offset:4096
    ds_read_b128 v[60:63], v11 offset:4096
    s_waitcnt lgkmcnt(3)
    v_mfma_f32_32x32x16_bf16 v[200:215], v[80:83], v[48:51], v[200:215]
    v_xor_b32 v32, s49, v48
    v_xor_b32 v33, s49, v49
    v_xor_b32 v34, s49, v50
    v_xor_b32 v35, s49, v51
    v_mfma_f32_32x32x16_bf16 v[232:247], v[148:151], v[48:51], v[232:247]
    s_nop 0
    v_mfma_f32_32x32x16_bf16 v[216:231], v[80:83], v[32:35], v[216:231]
    s_waitcnt lgkmcnt(2)
    v_mfma_f32_32x32x16_bf16 v[200:215], v[84:87], v[52:55], v[200:215]
    v_xor_b32 v36, s49, v52
    v_xor_b32 v37, s49, v53
    v_xor_b32 v38, s49, v54
    v_xor_b32 v39, s49, v55
    v_mfma_f32_32x32x16_bf16 v[232:247], v[152:155], v[52:55], v[232:247]
    s_nop 0
    v_mfma_f32_32x32x16_bf16 v[216:231], v[84:87], v[36:39], v[216:231]
    s_waitcnt lgkmcnt(1)
    v_mfma_f32_32x32x16_bf16 v[200:215], v[88:91], v[56:59], v[200:215]
    v_xor_b32 v40, s49, v56
    v_xor_b32 v41, s49, v57
    v_xor_b32 v42, s49, v58
    v_xor_b32 v43, s49, v59
    v_mfma_f32_32x32x16_bf16 v[232:247], v[156:159], v[56:59], v[232:247]
    s_nop 0
    v_mfma_f32_32x32x16_bf16 v[216:231], v[88:91], v[40:43], v[216:231]
    s_waitcnt lgkmcnt(0)
    v_mfma_f32_32x32x16_bf16 v[200:215], v[92:95], v[60:63], v[200:215]
    v_xor_b32 v44, s49, v60
    v_xor_b32 v45, s49, v61
    v_xor_b32 v46, s49, v62
    v_xor_b32 v47, s49, v63
    v_mfma_f32_32x32x16_bf16 v[232:247], v[160:163], v[60:63], v[232:247]
    s_nop 0
    v_mfma_f32_32x32x16_bf16 v[216:231], v[92:95], v[44:47], v[216:231]
    s_waitcnt vmcnt(10)
    ds_read_b128 v[48:51], v12 offset:0
    ds_read_b128 v[52:55], v13 offset:0
    ds_read_b128 v[56:59], v14 offset:0
    ds_read_b128 v[60:63], v15 offset:0
    s_waitcnt lgkmcnt(3)
    v_mfma_f32_32x32x16_bf16 v[200:215], v[96:99], v[48:51], v[200:215]
    v_xor_b32 v32, s49, v48
    v_xor_b32 v33, s49, v49
    v_xor_b32 v34, s49, v50
    v_xor_b32 v35, s49, v51
    v_mfma_f32_32x32x16_bf16 v[232:247], v[164:167], v[48:51], v[232:247]
    s_nop 0
    v_mfma_f32_32x32x16_bf16 v[216:231], v[96:99], v[32:35], v[216:231]
    s_waitcnt lgkmcnt(2)
    v_mfma_f32_32x32x16_bf16 v[200:215], v[100:103], v[52:55], v[200:215]
    v_xor_b32 v36, s49, v52
    v_xor_b32 v37, s49, v53
    v_xor_b32 v38, s49, v54
    v_xor_b32 v39, s49, v55
    v_mfma_f32_32x32x16_bf16 v[232:247], v[168:171], v[52:55], v[232:247]
    s_nop 0
    v_mfma_f32_32x32x16_bf16 v[216:231], v[100:103], v[36:39], v[216:231]
    s_waitcnt lgkmcnt(1)
    v_mfma_f32_32x32x16_bf16 v[200:215], v[104:107], v[56:59], v[200:215]
    v_xor_b32 v40, s49, v56
    v_xor_b32 v41, s49, v57
    v_xor_b32 v42, s49, v58
    v_xor_b32 v43, s49, v59
    v_mfma_f32_32x32x16_bf16 v[232:247], v[172:175], v[56:59], v[232:247]
    s_nop 0
    v_mfma_f32_32x32x16_bf16 v[216:231], v[104:107], v[40:43], v[216:231]
    s_waitcnt lgkmcnt(0)
    v_mfma_f32_32x32x16_bf16 v[200:215], v[108:111], v[60:63], v[200:215]
    v_xor_b32 v44, s49, v60
    v_xor_b32 v45, s49, v61
    v_xor_b32 v46, s49, v62
    v_xor_b32 v47, s49, v63
    v_mfma_f32_32x32x16_bf16 v[232:247], v[176:179], v[60:63], v[232:247]
    s_nop 0
    v_mfma_f32_32x32x16_bf16 v[216:231], v[108:111], v[44:47], v[216:231]
    s_waitcnt vmcnt(6)
    ds_read_b128 v[48:51], v12 offset:4096
    ds_read_b128 v[52:55], v13 offset:4096
    ds_read_b128 v[56:59], v14 offset:4096
    ds_read_b128 v[60:63], v15 offset:4096
    s_waitcnt lgkmcnt(3)
    v_mfma_f32_32x32x16_bf16 v[200:215], v[112:115], v[48:51], v[200:215]
    v_xor_b32 v32, s49, v48
    v_xor_b32 v33, s49, v49
    v_xor_b32 v34, s49, v50
    v_xor_b32 v35, s49, v51
    v_mfma_f32_32x32x16_bf16 v[232:247], v[180:183], v[48:51], v[232:247]
    s_nop 0
    v_mfma_f32_32x32x16_bf16 v[216:231], v[112:115], v[32:35], v[216:231]
    s_waitcnt lgkmcnt(2)
    v_mfma_f32_32x32x16_bf16 v[200:215], v[116:119], v[52:55], v[200:215]
    v_xor_b32 v36, s49, v52
    v_xor_b32 v37, s49, v53
    v_xor_b32 v38, s49, v54
    v_xor_b32 v39, s49, v55
    v_mfma_f32_32x32x16_bf16 v[232:247], v[184:187], v[52:55], v[232:247]
    s_nop 0
    v_mfma_f32_32x32x16_bf16 v[216:231], v[116:119], v[36:39], v[216:231]
    s_waitcnt lgkmcnt(1)
    v_mfma_f32_32x32x16_bf16 v[200:215], v[120:123], v[56:59], v[200:215]
    v_xor_b32 v40, s49, v56
    v_xor_b32 v41, s49, v57
    v_xor_b32 v42, s49, v58
    v_xor_b32 v43, s49, v59
    v_mfma_f32_32x32x16_bf16 v[232:247], v[188:191], v[56:59], v[232:247]
    s_nop 0
    v_mfma_f32_32x32x16_bf16 v[216:231], v[120:123], v[40:43], v[216:231]
    s_waitcnt lgkmcnt(0)
    v_mfma_f32_32x32x16_bf16 v[200:215], v[124:127], v[60:63], v[200:215]
    v_xor_b32 v44, s49, v60
    v_xor_b32 v45, s49, v61
    v_xor_b32 v46, s49, v62
    v_xor_b32 v47, s49, v63
    v_mfma_f32_32x32x16_bf16 v[232:247], v[192:195], v[60:63], v[232:247]
    s_nop 0
    v_mfma_f32_32x32x16_bf16 v[216:231], v[124:127], v[44:47], v[216:231]
    s_nop 4
    v_cvt_pk_bf16_f32 v248, v200, v201
    v_cvt_pk_bf16_f32 v249, v202, v203
    v_cvt_pk_bf16_f32 v250, v204, v205
    v_cvt_pk_bf16_f32 v251, v206, v207
    v_cvt_pk_bf16_f32 v252, v208, v209
    v_cvt_pk_bf16_f32 v253, v210, v211
    v_cvt_pk_bf16_f32 v254, v212, v213
    v_cvt_pk_bf16_f32 v255, v214, v215
    s_add_u32 s44, s48, 608256
    buffer_store_dwordx4 v[248:251], v16, s[24:27], s48 offen sc1
    buffer_store_dwordx4 v[252:255], v16, s[24:27], s44 offen sc1
    s_nop 0
    v_cvt_pk_bf16_f32 v248, v216, v217
    v_cvt_pk_bf16_f32 v249, v218, v219
    v_cvt_pk_bf16_f32 v250, v220, v221
    v_cvt_pk_bf16_f32 v251, v222, v223
    v_cvt_pk_bf16_f32 v252, v224, v225
    v_cvt_pk_bf16_f32 v253, v226, v227
    v_cvt_pk_bf16_f32 v254, v228, v229
    v_cvt_pk_bf16_f32 v255, v230, v231
    s_add_u32 s44, s63, 608256
    buffer_store_dwordx4 v[248:251], v17, s[24:27], s63 offen sc1
    buffer_store_dwordx4 v[252:255], v17, s[24:27], s44 offen sc1
    v_cvt_pk_bf16_f32 v2, v232, v233
    s_mov_b64 exec, 0xffffffff
    s_add_u32 s44, s48, 32768
    buffer_store_short v2, v16, s[24:27], s44 offen sc1
    s_add_u32 s44, s63, 32768
    buffer_store_short_d16_hi v2, v17, s[24:27], s44 offen sc1
    s_mov_b64 exec, -1
L_k1s_done:
    s_waitcnt vmcnt(0) lgkmcnt(0)
    s_barrier
    v_min_u32 v2, 1, v0
    v_lshlrev_b32 v2, 30, v2
    v_mov_b32 v3, 1
    s_lshl_b32 s38, s37, 7
    s_add_u32 s38, s38, 21037056
    buffer_store_dword v3, v2, s[24:27], s38 offen offset:96 sc1
    s_and_b32 s84, s32, 3
    s_lshl2_add_u32 s84, s35, s84
    s_lshl1_add_u32 s84, s84, s34
    s_mul_i32 s84, s84, 28
    v_lshrrev_b32 v2, 1, v1
    v_add_u32 v2, s84, v2
    v_mul_u32_u24 v2, 2048, v2
    v_and_b32 v3, 1, v1
    v_lshl_add_u32 v2, v3, 7, v2
    v_add_u32 v3, 8, v1
    v_lshrrev_b32 v3, 6, v3
    v_lshl_add_u32 v4, v3, 30, v2
    s_mul_i32 s85, s33, 7168
    s_add_u32 s85, s85, s36
    s_lshl_b32 s85, s85, 8
    s_cmp_ge_u32 s32, 4
    s_cbranch_scc1 L_nopf3
    buffer_load_dword v43, v4, s[68:71], s85 offen
    s_mul_i32 s84, s34, -114688
    s_add_u32 s84, s84, 57344
    v_add_u32 v4, s84, v4
    buffer_load_dword v43, v4, s[68:71], s85 offen
L_nopf3:
    s_cmp_ge_u32 s32, 4
    s_cbranch_scc1 L_prod2
    s_setprio 1
    s_lshr_b32 s40, s32, 1
    s_and_b32 s41, s32, 1
    v_and_b32 v2, 15, v1
    v_lshrrev_b32 v3, 4, v1
    s_lshl_b32 s38, s40, 12
    s_lshl_b32 s39, s41, 12
    v_lshlrev_b32 v20, 4, v1
    v_bfe_u32 v4, v1, 2, 2
    v_lshl_add_u32 v5, v3, 3, v4
    v_lshlrev_b32 v5, 8, v5
    v_and_b32 v6, 1, v3
    v_lshl_add_u32 v4, v6, 2, v4
    s_lshl_b32 s84, s41, 1
    v_xor_b32 v4, s84, v4
    v_lshl_add_u32 v5, v4, 5, v5
    v_and_b32 v4, 3, v1
    v_lshl_add_u32 v12, v4, 3, v5
    v_xor_b32 v13, 32, v12
    v_xor_b32 v14, 128, v12
    v_xor_b32 v15, 160, v12
    v_lshrrev_b32 v4, 1, v2
    v_xor_b32 v4, v3, v4
    v_lshl_add_u32 v5, v2, 7, s38
    v_add_u32 v5, 0, v5
    v_lshl_add_u32 v8, v4, 4, v5
    v_xor_b32 v9, 64, v8
    v_add_u32 v10, s38, v20
    v_add_u32 v11, s39, v20
    s_lshl_b32 s84, s40, 5
    v_add_u32 v4, s84, v2
    s_lshr_b32 s84, s33, 1
    s_lshl_b32 s84, s84, 6
    v_xor_b32 v4, s84, v4
    s_lshl_b32 s84, s35, 8
    s_add_u32 s84, s84, s34
    v_lshl_add_u32 v4, v4, 1, s84
    v_bfrev_b32 v5, 1
    v_cmp_eq_u32 vcc, 0, v4
    s_nop 1
    v_cndmask_b32 v22, 0, v5, vcc
    v_cmp_eq_u32 vcc, 128, v4
    s_nop 1
    v_cndmask_b32 v23, 0, v5, vcc
    s_barrier
    v_add_u32 v11, 65536, v11
    ds_read_b128 v[96:99], v11 offset:49152
    ds_read_b128 v[64:67], v8 offset:0
    ds_read_b128 v[100:103], v11 offset:51200
    ds_read_b128 v[104:107], v11 offset:57344
    ds_read_b128 v[108:111], v11 offset:59392
    ds_read_b128 v[68:71], v8 offset:2048
    ds_read_b128 v[72:75], v8 offset:8192
    ds_read_b128 v[76:79], v8 offset:10240
    ds_read_b128 v[112:115], v11 offset:50176
    ds_read_b128 v[80:83], v9 offset:0
    ds_read_b128 v[116:119], v11 offset:52224
    ds_read_b128 v[120:123], v11 offset:58368
    ds_read_b128 v[124:127], v11 offset:60416
    ds_read_b128 v[84:87], v9 offset:2048
    ds_read_b128 v[88:91], v9 offset:8192
    ds_read_b128 v[92:95], v9 offset:10240
    s_waitcnt lgkmcnt(14)
    v_mfma_f32_16x16x32_bf16 v[128:131], v[96:99], v[64:67], 0
    s_waitcnt lgkmcnt(13)
    v_mfma_f32_16x16x32_bf16 v[132:135], v[100:103], v[64:67], 0
    s_waitcnt lgkmcnt(12)
    v_mfma_f32_16x16x32_bf16 v[136:139], v[104:107], v[64:67], 0
    s_waitcnt lgkmcnt(11)
    v_mfma_f32_16x16x32_bf16 v[140:143], v[108:111], v[64:67], 0
    s_waitcnt lgkmcnt(10)
    v_mfma_f32_16x16x32_bf16 v[144:147], v[96:99], v[68:71], 0
    v_mfma_f32_16x16x32_bf16 v[148:151], v[100:103], v[68:71], 0
    v_mfma_f32_16x16x32_bf16 v[152:155], v[104:107], v[68:71], 0
    v_mfma_f32_16x16x32_bf16 v[156:159], v[108:111], v[68:71], 0
    s_waitcnt lgkmcnt(0)
    s_barrier
    ds_read_b128 v[64:67], v8 offset:32768
    ds_read_b128 v[68:71], v8 offset:34816
    v_mfma_f32_16x16x32_bf16 v[160:163], v[96:99], v[72:75], 0
    v_mfma_f32_16x16x32_bf16 v[164:167], v[100:103], v[72:75], 0
    v_mfma_f32_16x16x32_bf16 v[168:171], v[104:107], v[72:75], 0
    v_mfma_f32_16x16x32_bf16 v[172:175], v[108:111], v[72:75], 0
    ds_read_b128 v[72:75], v8 offset:40960
    v_mfma_f32_16x16x32_bf16 v[176:179], v[96:99], v[76:79], 0
    v_add_u32 v11, 16384, v11
    ds_read_b128 v[96:99], v11 offset:49152
    v_mfma_f32_16x16x32_bf16 v[180:183], v[100:103], v[76:79], 0
    ds_read_b128 v[100:103], v11 offset:51200
    v_mfma_f32_16x16x32_bf16 v[184:187], v[104:107], v[76:79], 0
    ds_read_b128 v[104:107], v11 offset:57344
    v_mfma_f32_16x16x32_bf16 v[188:191], v[108:111], v[76:79], 0
    ds_read_b128 v[108:111], v11 offset:59392
    ds_read_b128 v[76:79], v8 offset:43008
    v_mfma_f32_16x16x32_bf16 v[128:131], v[112:115], v[80:83], v[128:131]
    v_mfma_f32_16x16x32_bf16 v[132:135], v[116:119], v[80:83], v[132:135]
    v_mfma_f32_16x16x32_bf16 v[136:139], v[120:123], v[80:83], v[136:139]
    v_mfma_f32_16x16x32_bf16 v[140:143], v[124:127], v[80:83], v[140:143]
    ds_read_b128 v[80:83], v9 offset:32768
    v_mfma_f32_16x16x32_bf16 v[144:147], v[112:115], v[84:87], v[144:147]
    v_mfma_f32_16x16x32_bf16 v[148:151], v[116:119], v[84:87], v[148:151]
    v_mfma_f32_16x16x32_bf16 v[152:155], v[120:123], v[84:87], v[152:155]
    v_mfma_f32_16x16x32_bf16 v[156:159], v[124:127], v[84:87], v[156:159]
    ds_read_b128 v[84:87], v9 offset:34816
    v_mfma_f32_16x16x32_bf16 v[160:163], v[112:115], v[88:91], v[160:163]
    v_mfma_f32_16x16x32_bf16 v[164:167], v[116:119], v[88:91], v[164:167]
    v_mfma_f32_16x16x32_bf16 v[168:171], v[120:123], v[88:91], v[168:171]
    v_mfma_f32_16x16x32_bf16 v[172:175], v[124:127], v[88:91], v[172:175]
    ds_read_b128 v[88:91], v9 offset:40960
    v_mfma_f32_16x16x32_bf16 v[176:179], v[112:115], v[92:95], v[176:179]
    ds_read_b128 v[112:115], v11 offset:50176
    v_mfma_f32_16x16x32_bf16 v[180:183], v[116:119], v[92:95], v[180:183]
    ds_read_b128 v[116:119], v11 offset:52224
    v_mfma_f32_16x16x32_bf16 v[184:187], v[120:123], v[92:95], v[184:187]
    ds_read_b128 v[120:123], v11 offset:58368
    v_mfma_f32_16x16x32_bf16 v[188:191], v[124:127], v[92:95], v[188:191]
    ds_read_b128 v[124:127], v11 offset:60416
    ds_read_b128 v[92:95], v9 offset:43008
    s_waitcnt lgkmcnt(12)
    v_mfma_f32_16x16x32_bf16 v[128:131], v[96:99], v[64:67], v[128:131]
    s_waitcnt lgkmcnt(11)
    v_mfma_f32_16x16x32_bf16 v[132:135], v[100:103], v[64:67], v[132:135]
    s_waitcnt lgkmcnt(10)
    v_mfma_f32_16x16x32_bf16 v[136:139], v[104:107], v[64:67], v[136:139]
    s_waitcnt lgkmcnt(9)
    v_mfma_f32_16x16x32_bf16 v[140:143], v[108:111], v[64:67], v[140:143]
    v_mfma_f32_16x16x32_bf16 v[144:147], v[96:99], v[68:71], v[144:147]
    v_mfma_f32_16x16x32_bf16 v[148:151], v[100:103], v[68:71], v[148:151]
    v_mfma_f32_16x16x32_bf16 v[152:155], v[104:107], v[68:71], v[152:155]
    v_mfma_f32_16x16x32_bf16 v[156:159], v[108:111], v[68:71], v[156:159]
    s_waitcnt lgkmcnt(0)
    s_barrier
    v_add_u32 v10, 65536, v10
    ds_read_b128 v[64:67], v10 offset:0
    v_mfma_f32_16x16x32_bf16 v[160:163], v[96:99], v[72:75], v[160:163]
    ds_read_b128 v[68:71], v10 offset:2048
    v_mfma_f32_16x16x32_bf16 v[164:167], v[100:103], v[72:75], v[164:167]
    v_mfma_f32_16x16x32_bf16 v[168:171], v[104:107], v[72:75], v[168:171]
    v_mfma_f32_16x16x32_bf16 v[172:175], v[108:111], v[72:75], v[172:175]
    ds_read_b128 v[72:75], v10 offset:8192
    v_mfma_f32_16x16x32_bf16 v[176:179], v[96:99], v[76:79], v[176:179]
    ds_read_b64_tr_b16 v[96:97], v12 offset:16384
    ds_read_b64_tr_b16 v[98:99], v12 offset:17408
    v_mfma_f32_16x16x32_bf16 v[180:183], v[100:103], v[76:79], v[180:183]
    ds_read_b64_tr_b16 v[100:101], v13 offset:16384
    ds_read_b64_tr_b16 v[102:103], v13 offset:17408
    v_mfma_f32_16x16x32_bf16 v[184:187], v[104:107], v[76:79], v[184:187]
    ds_read_b64_tr_b16 v[104:105], v14 offset:16384
    ds_read_b64_tr_b16 v[106:107], v14 offset:17408
    v_mfma_f32_16x16x32_bf16 v[188:191], v[108:111], v[76:79], v[188:191]
    ds_read_b64_tr_b16 v[108:109], v15 offset:16384
    ds_read_b64_tr_b16 v[110:111], v15 offset:17408
    v_mfma_f32_16x16x32_bf16 v[128:131], v[112:115], v[80:83], v[128:131]
    ds_read_b128 v[76:79], v10 offset:10240
    v_mfma_f32_16x16x32_bf16 v[132:135], v[116:119], v[80:83], v[132:135]
    v_mfma_f32_16x16x32_bf16 v[136:139], v[120:123], v[80:83], v[136:139]
    v_mfma_f32_16x16x32_bf16 v[140:143], v[124:127], v[80:83], v[140:143]
    ds_read_b128 v[80:83], v10 offset:1024
    v_mfma_f32_16x16x32_bf16 v[144:147], v[112:115], v[84:87], v[144:147]
    v_mfma_f32_16x16x32_bf16 v[148:151], v[116:119], v[84:87], v[148:151]
    v_mfma_f32_16x16x32_bf16 v[152:155], v[120:123], v[84:87], v[152:155]
    v_mfma_f32_16x16x32_bf16 v[156:159], v[124:127], v[84:87], v[156:159]
    ds_read_b128 v[84:87], v10 offset:3072
    v_mfma_f32_16x16x32_bf16 v[160:163], v[112:115], v[88:91], v[160:163]
    v_mfma_f32_16x16x32_bf16 v[164:167], v[116:119], v[88:91], v[164:167]
    v_mfma_f32_16x16x32_bf16 v[168:171], v[120:123], v[88:91], v[168:171]
    v_mfma_f32_16x16x32_bf16 v[172:175], v[124:127], v[88:91], v[172:175]
    ds_read_b128 v[88:91], v10 offset:9216
    v_mfma_f32_16x16x32_bf16 v[176:179], v[112:115], v[92:95], v[176:179]
    ds_read_b64_tr_b16 v[112:113], v12 offset:24576
    ds_read_b64_tr_b16 v[114:115], v12 offset:25600
    v_mfma_f32_16x16x32_bf16 v[180:183], v[116:119], v[92:95], v[180:183]
    ds_read_b64_tr_b16 v[116:117], v13 offset:24576
    ds_read_b64_tr_b16 v[118:119], v13 offset:25600
    v_mfma_f32_16x16x32_bf16 v[184:187], v[120:123], v[92:95], v[184:187]
    ds_read_b64_tr_b16 v[120:121], v14 offset:24576
    ds_read_b64_tr_b16 v[122:123], v14 offset:25600
    v_mfma_f32_16x16x32_bf16 v[188:191], v[124:127], v[92:95], v[188:191]
    ds_read_b64_tr_b16 v[124:125], v15 offset:24576
    ds_read_b64_tr_b16 v[126:127], v15 offset:25600
    s_waitcnt lgkmcnt(15)
    v_mfma_f32_16x16x32_bf16 v[128:131], v[96:99], v[64:67], v[128:131]
    ds_read_b128 v[92:95], v10 offset:11264
    v_mfma_f32_16x16x32_bf16 v[132:135], v[100:103], v[64:67], v[132:135]
    s_waitcnt lgkmcnt(15)
    v_mfma_f32_16x16x32_bf16 v[136:139], v[104:107], v[64:67], v[136:139]
    s_waitcnt lgkmcnt(13)
    v_mfma_f32_16x16x32_bf16 v[140:143], v[108:111], v[64:67], v[140:143]
    v_mfma_f32_16x16x32_bf16 v[144:147], v[96:99], v[68:71], v[144:147]
    v_mfma_f32_16x16x32_bf16 v[148:151], v[100:103], v[68:71], v[148:151]
    v_mfma_f32_16x16x32_bf16 v[152:155], v[104:107], v[68:71], v[152:155]
    v_mfma_f32_16x16x32_bf16 v[156:159], v[108:111], v[68:71], v[156:159]
    s_waitcnt lgkmcnt(0)
    s_barrier
    ds_read_b128 v[64:67], v10 offset:32768
    ds_read_b128 v[68:71], v10 offset:34816
    v_mfma_f32_16x16x32_bf16 v[160:163], v[96:99], v[72:75], v[160:163]
    v_mfma_f32_16x16x32_bf16 v[164:167], v[100:103], v[72:75], v[164:167]
    v_mfma_f32_16x16x32_bf16 v[168:171], v[104:107], v[72:75], v[168:171]
    v_mfma_f32_16x16x32_bf16 v[172:175], v[108:111], v[72:75], v[172:175]
    ds_read_b128 v[72:75], v10 offset:40960
    v_mfma_f32_16x16x32_bf16 v[176:179], v[96:99], v[76:79], v[176:179]
    ds_read_b64_tr_b16 v[96:97], v12 offset:49152
    ds_read_b64_tr_b16 v[98:99], v12 offset:50176
    v_mfma_f32_16x16x32_bf16 v[180:183], v[100:103], v[76:79], v[180:183]
    ds_read_b64_tr_b16 v[100:101], v13 offset:49152
    ds_read_b64_tr_b16 v[102:103], v13 offset:50176
    v_mfma_f32_16x16x32_bf16 v[184:187], v[104:107], v[76:79], v[184:187]
    ds_read_b64_tr_b16 v[104:105], v14 offset:49152
    ds_read_b64_tr_b16 v[106:107], v14 offset:50176
    v_mfma_f32_16x16x32_bf16 v[188:191], v[108:111], v[76:79], v[188:191]
    ds_read_b64_tr_b16 v[108:109], v15 offset:49152
    ds_read_b64_tr_b16 v[110:111], v15 offset:50176
    v_mfma_f32_16x16x32_bf16 v[128:131], v[112:115], v[80:83], v[128:131]
    ds_read_b128 v[76:79], v10 offset:43008
    v_mfma_f32_16x16x32_bf16 v[132:135], v[116:119], v[80:83], v[132:135]
    v_mfma_f32_16x16x32_bf16 v[136:139], v[120:123], v[80:83], v[136:139]
    v_mfma_f32_16x16x32_bf16 v[140:143], v[124:127], v[80:83], v[140:143]
    ds_read_b128 v[80:83], v10 offset:33792
    v_mfma_f32_16x16x32_bf16 v[144:147], v[112:115], v[84:87], v[144:147]
    v_mfma_f32_16x16x32_bf16 v[148:151], v[116:119], v[84:87], v[148:151]
    v_mfma_f32_16x16x32_bf16 v[152:155], v[120:123], v[84:87], v[152:155]
    v_mfma_f32_16x16x32_bf16 v[156:159], v[124:127], v[84:87], v[156:159]
    ds_read_b128 v[84:87], v10 offset:35840
    v_mfma_f32_16x16x32_bf16 v[160:163], v[112:115], v[88:91], v[160:163]
    v_mfma_f32_16x16x32_bf16 v[164:167], v[116:119], v[88:91], v[164:167]
    v_mfma_f32_16x16x32_bf16 v[168:171], v[120:123], v[88:91], v[168:171]
    v_mfma_f32_16x16x32_bf16 v[172:175], v[124:127], v[88:91], v[172:175]
    ds_read_b128 v[88:91], v10 offset:41984
    v_mfma_f32_16x16x32_bf16 v[176:179], v[112:115], v[92:95], v[176:179]
    ds_read_b64_tr_b16 v[112:113], v12 offset:57344
    ds_read_b64_tr_b16 v[114:115], v12 offset:58368
    v_mfma_f32_16x16x32_bf16 v[180:183], v[116:119], v[92:95], v[180:183]
    ds_read_b64_tr_b16 v[116:117], v13 offset:57344
    ds_read_b64_tr_b16 v[118:119], v13 offset:58368
    v_mfma_f32_16x16x32_bf16 v[184:187], v[120:123], v[92:95], v[184:187]
    ds_read_b64_tr_b16 v[120:121], v14 offset:57344
    ds_read_b64_tr_b16 v[122:123], v14 offset:58368
    v_mfma_f32_16x16x32_bf16 v[188:191], v[124:127], v[92:95], v[188:191]
    ds_read_b64_tr_b16 v[124:125], v15 offset:57344
    ds_read_b64_tr_b16 v[126:127], v15 offset:58368
    s_waitcnt lgkmcnt(15)
    v_mfma_f32_16x16x32_bf16 v[128:131], v[96:99], v[64:67], v[128:131]
    ds_read_b128 v[92:95], v10 offset:44032
    v_mfma_f32_16x16x32_bf16 v[132:135], v[100:103], v[64:67], v[132:135]
    s_waitcnt lgkmcnt(15)
    v_mfma_f32_16x16x32_bf16 v[136:139], v[104:107], v[64:67], v[136:139]
    s_waitcnt lgkmcnt(13)
    v_mfma_f32_16x16x32_bf16 v[140:143], v[108:111], v[64:67], v[140:143]
    v_mfma_f32_16x16x32_bf16 v[144:147], v[96:99], v[68:71], v[144:147]
    v_mfma_f32_16x16x32_bf16 v[148:151], v[100:103], v[68:71], v[148:151]
    v_mfma_f32_16x16x32_bf16 v[152:155], v[104:107], v[68:71], v[152:155]
    v_mfma_f32_16x16x32_bf16 v[156:159], v[108:111], v[68:71], v[156:159]
    s_waitcnt lgkmcnt(0)
    s_barrier
    ds_read_b128 v[64:67], v8 offset:0
    ds_read_b128 v[68:71], v8 offset:2048
    v_mfma_f32_16x16x32_bf16 v[160:163], v[96:99], v[72:75], v[160:163]
    v_mfma_f32_16x16x32_bf16 v[164:167], v[100:103], v[72:75], v[164:167]
    v_mfma_f32_16x16x32_bf16 v[168:171], v[104:107], v[72:75], v[168:171]
    v_mfma_f32_16x16x32_bf16 v[172:175], v[108:111], v[72:75], v[172:175]
    ds_read_b128 v[72:75], v8 offset:8192
    v_mfma_f32_16x16x32_bf16 v[176:179], v[96:99], v[76:79], v[176:179]
    ds_read_b128 v[96:99], v11 offset:32768
    v_mfma_f32_16x16x32_bf16 v[180:183], v[100:103], v[76:79], v[180:183]
    ds_read_b128 v[100:103], v11 offset:34816
    v_mfma_f32_16x16x32_bf16 v[184:187], v[104:107], v[76:79], v[184:187]
    ds_read_b128 v[104:107], v11 offset:40960
    v_mfma_f32_16x16x32_bf16 v[188:191], v[108:111], v[76:79], v[188:191]
    ds_read_b128 v[108:111], v11 offset:43008
    ds_read_b128 v[76:79], v8 offset:10240
    v_mfma_f32_16x16x32_bf16 v[128:131], v[112:115], v[80:83], v[128:131]
    v_mfma_f32_16x16x32_bf16 v[132:135], v[116:119], v[80:83], v[132:135]
    v_mfma_f32_16x16x32_bf16 v[136:139], v[120:123], v[80:83], v[136:139]
    v_mfma_f32_16x16x32_bf16 v[140:143], v[124:127], v[80:83], v[140:143]
    ds_read_b128 v[80:83], v9 offset:0
    v_mfma_f32_16x16x32_bf16 v[144:147], v[112:115], v[84:87], v[144:147]
    v_mfma_f32_16x16x32_bf16 v[148:151], v[116:119], v[84:87], v[148:151]
    v_mfma_f32_16x16x32_bf16 v[152:155], v[120:123], v[84:87], v[152:155]
    v_mfma_f32_16x16x32_bf16 v[156:159], v[124:127], v[84:87], v[156:159]
    ds_read_b128 v[84:87], v9 offset:2048
    v_mfma_f32_16x16x32_bf16 v[160:163], v[112:115], v[88:91], v[160:163]
    v_mfma_f32_16x16x32_bf16 v[164:167], v[116:119], v[88:91], v[164:167]
    v_mfma_f32_16x16x32_bf16 v[168:171], v[120:123], v[88:91], v[168:171]
    v_mfma_f32_16x16x32_bf16 v[172:175], v[124:127], v[88:91], v[172:175]
    ds_read_b128 v[88:91], v9 offset:8192
    v_mfma_f32_16x16x32_bf16 v[176:179], v[112:115], v[92:95], v[176:179]
    s_waitcnt lgkmcnt(10)
    v_xor_b32 v64, v22, v64
    ds_read_b128 v[112:115], v11 offset:33792
    v_mfma_f32_16x16x32_bf16 v[180:183], v[116:119], v[92:95], v[180:183]
    v_xor_b32 v65, v22, v65
    ds_read_b128 v[116:119], v11 offset:35840
    v_mfma_f32_16x16x32_bf16 v[184:187], v[120:123], v[92:95], v[184:187]
    v_xor_b32 v66, v22, v66
    ds_read_b128 v[120:123], v11 offset:41984
    v_mfma_f32_16x16x32_bf16 v[188:191], v[124:127], v[92:95], v[188:191]
    v_xor_b32 v67, v22, v67
    ds_read_b128 v[124:127], v11 offset:44032
    s_waitcnt lgkmcnt(11)
    v_mfma_f32_16x16x32_bf16 v[192:195], v[96:99], v[64:67], 0
    ds_read_b128 v[92:95], v9 offset:10240
    s_waitcnt lgkmcnt(11)
    v_mfma_f32_16x16x32_bf16 v[196:199], v[100:103], v[64:67], 0
    s_waitcnt lgkmcnt(10)
    v_mfma_f32_16x16x32_bf16 v[200:203], v[104:107], v[64:67], 0
    s_waitcnt lgkmcnt(9)
    v_mfma_f32_16x16x32_bf16 v[204:207], v[108:111], v[64:67], 0
    v_mfma_f32_16x16x32_bf16 v[208:211], v[96:99], v[68:71], 0
    v_xor_b32 v72, v23, v72
    v_mfma_f32_16x16x32_bf16 v[212:215], v[100:103], v[68:71], 0
    v_xor_b32 v73, v23, v73
    v_mfma_f32_16x16x32_bf16 v[216:219], v[104:107], v[68:71], 0
    v_xor_b32 v74, v23, v74
    v_mfma_f32_16x16x32_bf16 v[220:223], v[108:111], v[68:71], 0
    v_xor_b32 v75, v23, v75
    s_waitcnt lgkmcnt(0)
    s_barrier
    ds_read_b128 v[64:67], v8 offset:32768
    v_mfma_f32_16x16x32_bf16 v[224:227], v[96:99], v[72:75], 0
    ds_read_b128 v[68:71], v8 offset:34816
    v_mfma_f32_16x16x32_bf16 v[228:231], v[100:103], v[72:75], 0
    v_mfma_f32_16x16x32_bf16 v[232:235], v[104:107], v[72:75], 0
    v_mfma_f32_16x16x32_bf16 v[236:239], v[108:111], v[72:75], 0
    ds_read_b128 v[72:75], v8 offset:40960
    v_mfma_f32_16x16x32_bf16 v[240:243], v[96:99], v[76:79], 0
    v_xor_b32 v80, v22, v80
    ds_read_b128 v[96:99], v11 offset:49152
    v_mfma_f32_16x16x32_bf16 v[244:247], v[100:103], v[76:79], 0
    v_xor_b32 v81, v22, v81
    ds_read_b128 v[100:103], v11 offset:51200
    v_mfma_f32_16x16x32_bf16 v[248:251], v[104:107], v[76:79], 0
    v_xor_b32 v82, v22, v82
    ds_read_b128 v[104:107], v11 offset:57344
    v_mfma_f32_16x16x32_bf16 v[252:255], v[108:111], v[76:79], 0
    v_xor_b32 v83, v22, v83
    ds_read_b128 v[108:111], v11 offset:59392
    s_nop 0
    v_mfma_f32_16x16x32_bf16 v[192:195], v[112:115], v[80:83], v[192:195]
    ds_read_b128 v[76:79], v8 offset:43008
    v_mfma_f32_16x16x32_bf16 v[196:199], v[116:119], v[80:83], v[196:199]
    v_mfma_f32_16x16x32_bf16 v[200:203], v[120:123], v[80:83], v[200:203]
    v_mfma_f32_16x16x32_bf16 v[204:207], v[124:127], v[80:83], v[204:207]
    ds_read_b128 v[80:83], v9 offset:32768
    v_mfma_f32_16x16x32_bf16 v[208:211], v[112:115], v[84:87], v[208:211]
    v_xor_b32 v88, v23, v88
    v_mfma_f32_16x16x32_bf16 v[212:215], v[116:119], v[84:87], v[212:215]
    v_xor_b32 v89, v23, v89
    v_mfma_f32_16x16x32_bf16 v[216:219], v[120:123], v[84:87], v[216:219]
    v_xor_b32 v90, v23, v90
    v_mfma_f32_16x16x32_bf16 v[220:223], v[124:127], v[84:87], v[220:223]
    v_xor_b32 v91, v23, v91
    ds_read_b128 v[84:87], v9 offset:34816
    s_nop 0
    v_mfma_f32_16x16x32_bf16 v[224:227], v[112:115], v[88:91], v[224:227]
    v_mfma_f32_16x16x32_bf16 v[228:231], v[116:119], v[88:91], v[228:231]
    v_mfma_f32_16x16x32_bf16 v[232:235], v[120:123], v[88:91], v[232:235]
    v_mfma_f32_16x16x32_bf16 v[236:239], v[124:127], v[88:91], v[236:239]
    ds_read_b128 v[88:91], v9 offset:40960
    v_mfma_f32_16x16x32_bf16 v[240:243], v[112:115], v[92:95], v[240:243]
    s_waitcnt lgkmcnt(10)
    v_xor_b32 v64, v22, v64
    ds_read_b128 v[112:115], v11 offset:50176
    v_mfma_f32_16x16x32_bf16 v[244:247], v[116:119], v[92:95], v[244:247]
    v_xor_b32 v65, v22, v65
    ds_read_b128 v[116:119], v11 offset:52224
    v_mfma_f32_16x16x32_bf16 v[248:251], v[120:123], v[92:95], v[248:251]
    v_xor_b32 v66, v22, v66
    ds_read_b128 v[120:123], v11 offset:58368
    v_mfma_f32_16x16x32_bf16 v[252:255], v[124:127], v[92:95], v[252:255]
    v_xor_b32 v67, v22, v67
    ds_read_b128 v[124:127], v11 offset:60416
    s_waitcnt lgkmcnt(11)
    v_mfma_f32_16x16x32_bf16 v[192:195], v[96:99], v[64:67], v[192:195]
    ds_read_b128 v[92:95], v9 offset:43008
    s_waitcnt lgkmcnt(11)
    v_mfma_f32_16x16x32_bf16 v[196:199], v[100:103], v[64:67], v[196:199]
    s_waitcnt lgkmcnt(10)
    v_mfma_f32_16x16x32_bf16 v[200:203], v[104:107], v[64:67], v[200:203]
    s_waitcnt lgkmcnt(9)
    v_mfma_f32_16x16x32_bf16 v[204:207], v[108:111], v[64:67], v[204:207]
    v_mfma_f32_16x16x32_bf16 v[208:211], v[96:99], v[68:71], v[208:211]
    v_xor_b32 v72, v23, v72
    v_mfma_f32_16x16x32_bf16 v[212:215], v[100:103], v[68:71], v[212:215]
    v_xor_b32 v73, v23, v73
    v_mfma_f32_16x16x32_bf16 v[216:219], v[104:107], v[68:71], v[216:219]
    v_xor_b32 v74, v23, v74
    v_mfma_f32_16x16x32_bf16 v[220:223], v[108:111], v[68:71], v[220:223]
    v_xor_b32 v75, v23, v75
    s_waitcnt lgkmcnt(0)
    s_barrier
    v_add_u32 v8, 65536, v8
    v_add_u32 v9, 65536, v9
    ds_read_b128 v[64:67], v8 offset:0
    v_mfma_f32_16x16x32_bf16 v[224:227], v[96:99], v[72:75], v[224:227]
    ds_read_b128 v[68:71], v8 offset:2048
    v_mfma_f32_16x16x32_bf16 v[228:231], v[100:103], v[72:75], v[228:231]
    v_mfma_f32_16x16x32_bf16 v[232:235], v[104:107], v[72:75], v[232:235]
    v_mfma_f32_16x16x32_bf16 v[236:239], v[108:111], v[72:75], v[236:239]
    ds_read_b128 v[72:75], v8 offset:8192
    v_mfma_f32_16x16x32_bf16 v[240:243], v[96:99], v[76:79], v[240:243]
    v_xor_b32 v80, v22, v80
    ds_read_b128 v[96:99], v11 offset:0
    v_mfma_f32_16x16x32_bf16 v[244:247], v[100:103], v[76:79], v[244:247]
    v_xor_b32 v81, v22, v81
    ds_read_b128 v[100:103], v11 offset:2048
    v_mfma_f32_16x16x32_bf16 v[248:251], v[104:107], v[76:79], v[248:251]
    v_xor_b32 v82, v22, v82
    ds_read_b128 v[104:107], v11 offset:8192
    v_mfma_f32_16x16x32_bf16 v[252:255], v[108:111], v[76:79], v[252:255]
    v_xor_b32 v83, v22, v83
    ds_read_b128 v[108:111], v11 offset:10240
    s_nop 0
    v_mfma_f32_16x16x32_bf16 v[192:195], v[112:115], v[80:83], v[192:195]
    ds_read_b128 v[76:79], v8 offset:10240
    v_mfma_f32_16x16x32_bf16 v[196:199], v[116:119], v[80:83], v[196:199]
    v_mfma_f32_16x16x32_bf16 v[200:203], v[120:123], v[80:83], v[200:203]
    v_mfma_f32_16x16x32_bf16 v[204:207], v[124:127], v[80:83], v[204:207]
    ds_read_b128 v[80:83], v9 offset:0
    v_mfma_f32_16x16x32_bf16 v[208:211], v[112:115], v[84:87], v[208:211]
    v_xor_b32 v88, v23, v88
    v_mfma_f32_16x16x32_bf16 v[212:215], v[116:119], v[84:87], v[212:215]
    v_xor_b32 v89, v23, v89
    v_mfma_f32_16x16x32_bf16 v[216:219], v[120:123], v[84:87], v[216:219]
    v_xor_b32 v90, v23, v90
    v_mfma_f32_16x16x32_bf16 v[220:223], v[124:127], v[84:87], v[220:223]
    v_xor_b32 v91, v23, v91
    ds_read_b128 v[84:87], v9 offset:2048
    s_nop 0
    v_mfma_f32_16x16x32_bf16 v[224:227], v[112:115], v[88:91], v[224:227]
    v_mfma_f32_16x16x32_bf16 v[228:231], v[116:119], v[88:91], v[228:231]
    v_mfma_f32_16x16x32_bf16 v[232:235], v[120:123], v[88:91], v[232:235]
    v_mfma_f32_16x16x32_bf16 v[236:239], v[124:127], v[88:91], v[236:239]
    ds_read_b128 v[88:91], v9 offset:8192
    v_mfma_f32_16x16x32_bf16 v[240:243], v[112:115], v[92:95], v[240:243]
    ds_read_b128 v[112:115], v11 offset:1024
    v_mfma_f32_16x16x32_bf16 v[244:247], v[116:119], v[92:95], v[244:247]
    ds_read_b128 v[116:119], v11 offset:3072
    v_mfma_f32_16x16x32_bf16 v[248:251], v[120:123], v[92:95], v[248:251]
    ds_read_b128 v[120:123], v11 offset:9216
    v_mfma_f32_16x16x32_bf16 v[252:255], v[124:127], v[92:95], v[252:255]
    ds_read_b128 v[124:127], v11 offset:11264
    ds_read_b128 v[92:95], v9 offset:10240
    s_branch L_c_join
L_prod2:
    s_sub_u32 s40, s32, 4
    s_lshl_b32 s48, s40, 12
    v_lshrrev_b32 v3, 4, v1
    v_and_b32 v2, 15, v1
    v_lshlrev_b32 v4, 1, v3
    v_xor_b32 v2, v2, v4
    v_lshlrev_b32 v2, 4, v2
    v_lshrrev_b32 v3, 4, v1
    v_and_b32 v2, 15, v1
    v_lshlrev_b32 v4, 1, v3
    v_xor_b32 v2, v2, v4
    v_lshlrev_b32 v2, 4, v2
    s_lshl_b32 s38, s3, 7
    v_xor_b32 v2, s38, v2
    s_mul_i32 s38, s33, 896
    s_lshr_b32 s39, s40, 1
    s_lshl_b32 s39, s39, 5
    s_add_u32 s38, s38, s39
    s_and_b32 s39, s40, 1
    s_lshl_b32 s39, s39, 3
    s_add_u32 s38, s38, s39
    s_lshl_b32 s38, s38, 11
    s_lshl_b32 s39, s36, 8
    s_add_u32 s38, s38, s39
    v_lshl_add_u32 v4, v3, 11, v2
    v_add_u32 v20, s38, v4
    v_add_u32 v21, 31744, v20
    v_xor_b32 v4, 128, v20
    v_add_u32 v22, 6144, v4
    v_add_u32 v23, 37888, v4
    s_lshl_b32 s38, s34, 2
    s_add_u32 s38, s38, s35
    s_mul_i32 s38, s38, 112
    s_mul_i32 s39, s33, 14
    s_add_u32 s38, s38, s39
    s_lshl_b32 s38, s38, 14
    v_lshl_add_u32 v30, v1, 4, s48
    v_add_u32 v31, 49152, v30
    v_add_u32 v32, 98304, v30
    v_add_u32 v28, s38, v30
    v_add_u32 v29, 917504, v28
    s_max_u32 s38, s36, 1
    s_sub_u32 s38, s38, 1
    s_lshl_b32 s45, s38, 15
    s_mov_b32 s47, s45
    s_mov_b32 s57, 0
    s_mov_b32 s46, s45
    s_lshl_b32 s56, s37, 7
    s_add_u32 s56, s56, 21037056
    v_and_b32 v35, 15, v1
    v_lshlrev_b32 v35, 2, v35
    s_mul_i32 s54, s35, 0
    s_add_u32 s54, s54, s33
    s_and_b32 s54, s54, 3
    s_lshl_b32 s38, s54, 3
    s_and_b32 s39, s36, 0
    s_lshl1_add_u32 s54, s54, s39
    s_lshl_b32 s54, s54, 7
    v_add_u32 v36, s38, v1
    v_cmp_gt_u32 vcc, 8, v1
    s_nop 1
    v_cndmask_b32 v36, 0, v36, vcc
    v_lshlrev_b32 v36, 7, v36
    v_add_u32 v36, 21037056, v36
    s_lshl_b32 s51, s37, 7
    s_lshl_b32 s38, s36, 2
    s_add_u32 s51, s51, s38
    s_add_u32 s51, s51, 21037056
    v_add_u32 v4, s40, v1
    v_min_u32 v4, 1, v4
    v_lshlrev_b32 v56, 30, v4
    v_mov_b32 v57, 1
    v_and_b32 v49, 31, v1
    v_lshlrev_b32 v49, 2, v49
    buffer_load_dword v50, v49, s[64:67], 0 offen sc1
    s_add_u32 m0, s48, 16384
    s_lshl_b32 s44, s47, 3
    buffer_load_dwordx4 v20, s[68:71], s44 offen offset:0 lds
    buffer_load_dwordx4 v21, s[68:71], s44 offen offset:1024 lds
    buffer_load_dwordx4 v22, s[68:71], s44 offen offset:2048 lds
    buffer_load_dwordx4 v23, s[68:71], s44 offen offset:3072 lds
    s_add_u32 s47, s47, 16384
    s_cmp_eq_u32 s47, 229376
    s_cselect_b32 s47, 0, s47
    s_lshl_b32 s38, s40, 5
    v_lshrrev_b32 v4, 3, v1
    v_add_u32 v4, s38, v4
    s_lshr_b32 s38, s33, 1
    s_lshl_b32 s38, s38, 6
    v_xor_b32 v4, s38, v4
    s_lshl_b32 s38, s35, 8
    s_add_u32 s38, s38, s34
    v_lshl_add_u32 v4, v4, 1, s38
    v_and_b32 v5, 7, v1
    v_lshrrev_b32 v6, 4, v1
    v_xor_b32 v5, v5, v6
    v_lshlrev_b32 v5, 4, v5
    v_lshl_add_u32 v24, v4, 12, v5
    v_xor_b32 v6, 64, v24
    v_add_u32 v25, 64512, v6
    v_add_u32 v26, 129024, v24
    v_add_u32 v27, 193536, v6
    v_sub_u32 v58, 2048, v4
    v_mov_b32 v6, 1024
    v_cmp_eq_u32 vcc, 0, v4
    s_nop 1
    v_cndmask_b32 v58, v58, v6, vcc
    v_lshl_add_u32 v84, v58, 12, v5
    v_sub_u32 v4, 2048, v4
    v_lshl_add_u32 v4, v4, 12, v5
    v_xor_b32 v6, 64, v4
    v_subrev_u32 v85, 66560, v6
    v_subrev_u32 v86, 133120, v4
    v_subrev_u32 v87, 199680, v6
    s_cmp_ge_u32 s36, 4
    s_cselect_b64 vcc, -1, 0
    v_cndmask_b32 v84, v84, v24, vcc
    v_cndmask_b32 v85, v85, v25, vcc
    v_cndmask_b32 v86, v86, v26, vcc
    v_cndmask_b32 v87, v87, v27, vcc
    s_lshl_b32 s38, s40, 5
    s_lshl_b32 s84, s3, 6
    s_xor_b32 s38, s38, s84
    s_lshl_b32 s39, s36, 7
    s_add_u32 s39, s38, s39
    s_mov_b32 s38, 0
    s_mul_i32 s84, s34, 608256
    s_add_u32 s38, s38, s84
    s_add_u32 s38, s38, 16777216
    s_mov_b32 s85, 304128
    v_lshrrev_b32 v3, 4, v1
    v_lshl_add_u32 v3, v3, 9, s38
    v_and_b32 v4, 15, v1
    v_add_u32 v4, s39, v4
    v_sub_u32 v5, 1024, v4
    v_min_u32 v4, v4, v5
    v_lshrrev_b32 v5, 6, v4
    v_mul_u32_u24 v5, 33792, v5
    v_and_b32 v6, 1, v4
    v_mad_u32_u24 v5, v6, s85, v5
    v_bfe_u32 v4, v4, 1, 5
    v_lshl_add_u32 v4, v4, 4, v5
    v_add_u32 v4, v3, v4
    v_mov_b32 v74, v4
    v_add_u32 v75, 1024, v4
    v_and_b32 v4, 15, v1
    v_add_u32 v4, s39, v4
    v_add_u32 v4, 16, v4
    v_sub_u32 v5, 1024, v4
    v_min_u32 v4, v4, v5
    v_lshrrev_b32 v5, 6, v4
    v_mul_u32_u24 v5, 33792, v5
    v_and_b32 v6, 1, v4
    v_mad_u32_u24 v5, v6, s85, v5
    v_bfe_u32 v4, v4, 1, 5
    v_lshl_add_u32 v4, v4, 4, v5
    v_add_u32 v4, v3, v4
    v_subrev_u32 v4, 2048, v4
    v_mov_b32 v76, v4
    v_add_u32 v77, 1024, v4
    s_add_u32 m0, s48, 0
    s_xor_b32 s49, s54, 0
    buffer_load_dwordx4 v24, s[76:79], s49 offen offset:0 lds
    buffer_load_dwordx4 v25, s[76:79], s49 offen offset:1024 lds
    buffer_load_dwordx4 v26, s[76:79], s49 offen offset:2048 lds
    buffer_load_dwordx4 v27, s[76:79], s49 offen offset:3072 lds
    s_add_u32 m0, s48, 32768
    s_xor_b32 s49, s54, 128
    buffer_load_dwordx4 v24, s[76:79], s49 offen offset:0 lds
    buffer_load_dwordx4 v25, s[76:79], s49 offen offset:1024 lds
    buffer_load_dwordx4 v26, s[76:79], s49 offen offset:2048 lds
    buffer_load_dwordx4 v27, s[76:79], s49 offen offset:3072 lds
    s_mov_b32 s87, 0x40000
    s_waitcnt vmcnt(12)
L_pl_4:
    v_cmp_ne_u32 vcc, 0, v50
    s_cmp_eq_u64 vcc, -1
    s_cbranch_scc1 L_ok_4
    buffer_load_dword v50, v49, s[64:67], 0 offen sc1
    s_waitcnt vmcnt(0)
    s_sub_u32 s87, s87, 1
    s_cbranch_scc0 L_pl_4
L_ok_4:
    buffer_load_dword v40, v36, s[24:27], 0 offen offset:96 sc1
    s_mov_b32 s87, 0x40000
    s_waitcnt vmcnt(0)
L_pl_5:
    v_cmp_ne_u32 vcc, 0, v40
    s_cmp_eq_u64 vcc, -1
    s_cbranch_scc1 L_ok_5
    buffer_load_dword v40, v36, s[24:27], 0 offen offset:96 sc1
    s_waitcnt vmcnt(0)
    s_sub_u32 s87, s87, 1
    s_cbranch_scc0 L_pl_5
L_ok_5:
    s_add_u32 m0, s48, 114688
    s_lshl_b32 s52, s54, 5
    s_xor_b32 s52, s52, 0
    buffer_load_dwordx4 v74, s[24:27], s52 offen offset:0 sc1 lds
    buffer_load_dwordx4 v75, s[24:27], s52 offen offset:1024 sc1 lds
    buffer_load_dwordx4 v76, s[24:27], s52 offen offset:2048 sc1 lds
    buffer_load_dwordx4 v77, s[24:27], s52 offen offset:3072 sc1 lds
    s_add_u32 m0, s48, 131072
    s_lshl_b32 s52, s54, 5
    s_xor_b32 s52, s52, 4096
    buffer_load_dwordx4 v74, s[24:27], s52 offen offset:0 sc1 lds
    buffer_load_dwordx4 v75, s[24:27], s52 offen offset:1024 sc1 lds
    buffer_load_dwordx4 v76, s[24:27], s52 offen offset:2048 sc1 lds
    buffer_load_dwordx4 v77, s[24:27], s52 offen offset:3072 sc1 lds
    s_waitcnt vmcnt(4)
    s_barrier
    s_add_u32 m0, s48, 65536
    s_lshr_b32 s58, s45, 15
    s_add_u32 s58, s58, 1
    s_bitcmp1_b32 s57, s58
    s_cbranch_scc1 L_tk_13
    s_mov_b32 s87, 0x40000
L_tl_13:
    buffer_load_dword v38, v35, s[24:27], s56 offen sc1
    s_waitcnt vmcnt(0)
    v_cmp_ne_u32 vcc, 0, v38
    s_or_b32 s57, s57, vcc_lo
    s_bitcmp1_b32 s57, s58
    s_cbranch_scc1 L_tj_13
    s_sub_u32 s87, s87, 1
    s_cbranch_scc0 L_tl_13
L_tj_13:
L_tk_13:
    buffer_load_dwordx4 v28, s[24:27], s45 offen offset:0 sc1 lds
    buffer_load_dwordx4 v28, s[24:27], s45 offen offset:1024 sc1 lds
    buffer_load_dwordx4 v28, s[24:27], s45 offen offset:2048 sc1 lds
    buffer_load_dwordx4 v28, s[24:27], s45 offen offset:3072 sc1 lds
    s_add_u32 s45, s45, 16384
    s_cmp_eq_u32 s45, 229376
    s_cselect_b32 s45, 0, s45
    s_add_u32 m0, s48, 49152
    s_lshl_b32 s44, s47, 3
    buffer_load_dwordx4 v20, s[68:71], s44 offen offset:0 lds
    buffer_load_dwordx4 v21, s[68:71], s44 offen offset:1024 lds
    buffer_load_dwordx4 v22, s[68:71], s44 offen offset:2048 lds
    buffer_load_dwordx4 v23, s[68:71], s44 offen offset:3072 lds
    s_add_u32 s47, s47, 16384
    s_cmp_eq_u32 s47, 229376
    s_cselect_b32 s47, 0, s47
    s_add_u32 m0, s48, 98304
    s_nop 0
    buffer_load_dwordx4 v28, s[24:27], s45 offen offset:0 sc1 lds
    buffer_load_dwordx4 v28, s[24:27], s45 offen offset:1024 sc1 lds
    buffer_load_dwordx4 v28, s[24:27], s45 offen offset:2048 sc1 lds
    buffer_load_dwordx4 v28, s[24:27], s45 offen offset:3072 sc1 lds
    s_add_u32 s45, s45, 16384
    s_cmp_eq_u32 s45, 229376
    s_cselect_b32 s45, 0, s45
    s_waitcnt vmcnt(12)
    s_barrier
    s_add_u32 m0, s48, 81920
    s_lshl_b32 s52, s54, 5
    s_xor_b32 s52, s52, 2097152
    buffer_load_dwordx4 v74, s[24:27], s52 offen offset:0 sc1 lds
    buffer_load_dwordx4 v75, s[24:27], s52 offen offset:1024 sc1 lds
    buffer_load_dwordx4 v76, s[24:27], s52 offen offset:2048 sc1 lds
    buffer_load_dwordx4 v77, s[24:27], s52 offen offset:3072 sc1 lds
    s_waitcnt vmcnt(12)
    s_barrier
    s_waitcnt vmcnt(8)
    s_waitcnt vmcnt(4)
    s_barrier
    s_add_u32 m0, s48, 65536
    s_xor_b32 s49, s54, 0
    buffer_load_dwordx4 v84, s[80:83], s49 offen offset:0 lds
    buffer_load_dwordx4 v85, s[80:83], s49 offen offset:1024 lds
    buffer_load_dwordx4 v86, s[80:83], s49 offen offset:2048 lds
    buffer_load_dwordx4 v87, s[80:83], s49 offen offset:3072 lds
    s_barrier
    s_add_u32 m0, s48, 98304
    s_lshl_b32 s52, s54, 5
    s_xor_b32 s52, s52, 2101248
    buffer_load_dwordx4 v74, s[24:27], s52 offen offset:0 sc1 lds
    buffer_load_dwordx4 v75, s[24:27], s52 offen offset:1024 sc1 lds
    buffer_load_dwordx4 v76, s[24:27], s52 offen offset:2048 sc1 lds
    buffer_load_dwordx4 v77, s[24:27], s52 offen offset:3072 sc1 lds
    s_barrier
    s_add_u32 m0, s48, 114688
    s_xor_b32 s49, s54, 128
    buffer_load_dwordx4 v84, s[80:83], s49 offen offset:0 lds
    buffer_load_dwordx4 v85, s[80:83], s49 offen offset:1024 lds
    buffer_load_dwordx4 v86, s[80:83], s49 offen offset:2048 lds
    buffer_load_dwordx4 v87, s[80:83], s49 offen offset:3072 lds
    s_add_u32 m0, s48, 0
    s_lshr_b32 s58, s46, 15
    s_add_u32 s58, s58, 9
    s_bitcmp1_b32 s57, s58
    s_cbranch_scc1 L_tk_14
    s_mov_b32 s87, 0x40000
L_tl_14:
    buffer_load_dword v38, v35, s[24:27], s56 offen sc1
    s_waitcnt vmcnt(0)
    v_cmp_ne_u32 vcc, 0, v38
    s_or_b32 s57, s57, vcc_lo
    s_bitcmp1_b32 s57, s58
    s_cbranch_scc1 L_tj_14
    s_sub_u32 s87, s87, 1
    s_cbranch_scc0 L_tl_14
L_tj_14:
L_tk_14:
    buffer_load_dwordx4 v29, s[24:27], s46 offen offset:0 sc1 lds
    buffer_load_dwordx4 v29, s[24:27], s46 offen offset:1024 sc1 lds
    buffer_load_dwordx4 v29, s[24:27], s46 offen offset:2048 sc1 lds
    buffer_load_dwordx4 v29, s[24:27], s46 offen offset:3072 sc1 lds
    s_add_u32 s46, s46, 16384
    s_cmp_eq_u32 s46, 229376
    s_cselect_b32 s46, 0, s46
    s_mul_i32 s53, s2, 49152
    s_add_u32 s53, s53, 25165824
    v_mov_b32 v80, -1
    v_mov_b32 v81, -1
    v_mov_b32 v82, -1
    v_mov_b32 v83, -1
    buffer_store_dwordx4 v[80:83], v30, s[24:27], s53 offen offset:0 sc1
    buffer_store_dwordx4 v[80:83], v30, s[24:27], s53 offen offset:1024 sc1
    s_waitcnt vmcnt(18)
    s_waitcnt vmcnt(14)
    s_barrier
    s_add_u32 m0, s48, 131072
    s_nop 0
    buffer_load_dwordx4 v29, s[24:27], s46 offen offset:0 sc1 lds
    buffer_load_dwordx4 v29, s[24:27], s46 offen offset:1024 sc1 lds
    buffer_load_dwordx4 v29, s[24:27], s46 offen offset:2048 sc1 lds
    buffer_load_dwordx4 v29, s[24:27], s46 offen offset:3072 sc1 lds
    s_add_u32 s46, s46, 16384
    s_cmp_eq_u32 s46, 229376
    s_cselect_b32 s46, 0, s46
    s_add_u32 m0, s48, 32768
    s_lshl_b32 s44, s47, 3
    buffer_load_dwordx4 v20, s[68:71], s44 offen offset:0 lds
    buffer_load_dwordx4 v21, s[68:71], s44 offen offset:1024 lds
    buffer_load_dwordx4 v22, s[68:71], s44 offen offset:2048 lds
    buffer_load_dwordx4 v23, s[68:71], s44 offen offset:3072 lds
    s_add_u32 s47, s47, 16384
    s_cmp_eq_u32 s47, 229376
    s_cselect_b32 s47, 0, s47
    s_barrier
    s_add_u32 m0, s48, 81920
    s_lshr_b32 s58, s45, 15
    s_add_u32 s58, s58, 1
    s_bitcmp1_b32 s57, s58
    s_cbranch_scc1 L_tk_15
    s_mov_b32 s87, 0x40000
L_tl_15:
    buffer_load_dword v38, v35, s[24:27], s56 offen sc1
    s_waitcnt vmcnt(0)
    v_cmp_ne_u32 vcc, 0, v38
    s_or_b32 s57, s57, vcc_lo
    s_bitcmp1_b32 s57, s58
    s_cbranch_scc1 L_tj_15
    s_sub_u32 s87, s87, 1
    s_cbranch_scc0 L_tl_15
L_tj_15:
L_tk_15:
    buffer_load_dwordx4 v28, s[24:27], s45 offen offset:0 sc1 lds
    buffer_load_dwordx4 v28, s[24:27], s45 offen offset:1024 sc1 lds
    buffer_load_dwordx4 v28, s[24:27], s45 offen offset:2048 sc1 lds
    buffer_load_dwordx4 v28, s[24:27], s45 offen offset:3072 sc1 lds
    s_add_u32 s45, s45, 16384
    s_cmp_eq_u32 s45, 229376
    s_cselect_b32 s45, 0, s45
    s_add_u32 m0, s48, 65536
    s_lshr_b32 s58, s46, 15
    s_add_u32 s58, s58, 9
    s_bitcmp1_b32 s57, s58
    s_cbranch_scc1 L_tk_16
    s_mov_b32 s87, 0x40000
L_tl_16:
    buffer_load_dword v38, v35, s[24:27], s56 offen sc1
    s_waitcnt vmcnt(0)
    v_cmp_ne_u32 vcc, 0, v38
    s_or_b32 s57, s57, vcc_lo
    s_bitcmp1_b32 s57, s58
    s_cbranch_scc1 L_tj_16
    s_sub_u32 s87, s87, 1
    s_cbranch_scc0 L_tl_16
L_tj_16:
L_tk_16:
    buffer_load_dwordx4 v29, s[24:27], s46 offen offset:0 sc1 lds
    buffer_load_dwordx4 v29, s[24:27], s46 offen offset:1024 sc1 lds
    buffer_load_dwordx4 v29, s[24:27], s46 offen offset:2048 sc1 lds
    buffer_load_dwordx4 v29, s[24:27], s46 offen offset:3072 sc1 lds
    s_add_u32 s46, s46, 16384
    s_cmp_eq_u32 s46, 229376
    s_cselect_b32 s46, 0, s46
    buffer_store_dwordx4 v[80:83], v30, s[24:27], s53 offen offset:2048 sc1
    buffer_store_dwordx4 v[80:83], v30, s[24:27], s53 offen offset:3072 sc1
    s_add_u32 s53, s53, 16384
    s_waitcnt vmcnt(28)
    s_waitcnt vmcnt(24)
    s_barrier
    s_barrier
    buffer_load_dword v37, v35, s[24:27], s56 offen sc1
    s_add_u32 m0, s48, 98304
    s_lshl_b32 s44, s47, 3
    buffer_load_dwordx4 v20, s[68:71], s44 offen offset:0 lds
    buffer_load_dwordx4 v21, s[68:71], s44 offen offset:1024 lds
    buffer_load_dwordx4 v22, s[68:71], s44 offen offset:2048 lds
    buffer_load_dwordx4 v23, s[68:71], s44 offen offset:3072 lds
    s_add_u32 s47, s47, 16384
    s_cmp_eq_u32 s47, 229376
    s_cselect_b32 s47, 0, s47
    s_add_u32 m0, s48, 114688
    s_nop 0
    buffer_load_dwordx4 v28, s[24:27], s45 offen offset:0 sc1 lds
    buffer_load_dwordx4 v28, s[24:27], s45 offen offset:1024 sc1 lds
    buffer_load_dwordx4 v28, s[24:27], s45 offen offset:2048 sc1 lds
    buffer_load_dwordx4 v28, s[24:27], s45 offen offset:3072 sc1 lds
    s_add_u32 s45, s45, 16384
    s_cmp_eq_u32 s45, 229376
    s_cselect_b32 s45, 0, s45
    buffer_store_dwordx4 v[80:83], v30, s[24:27], s53 offen offset:0 sc1
    buffer_store_dwordx4 v[80:83], v30, s[24:27], s53 offen offset:1024 sc1
    s_waitcnt vmcnt(31)
    s_barrier
    s_waitcnt vmcnt(10)
    v_cmp_ne_u32 vcc, 0, v37
    s_or_b32 s57, s57, vcc_lo
    s_barrier
    buffer_load_dword v37, v35, s[24:27], s56 offen sc1
    s_add_u32 m0, s48, 16384
    s_nop 0
    buffer_load_dwordx4 v29, s[24:27], s46 offen offset:0 sc1 lds
    buffer_load_dwordx4 v29, s[24:27], s46 offen offset:1024 sc1 lds
    buffer_load_dwordx4 v29, s[24:27], s46 offen offset:2048 sc1 lds
    buffer_load_dwordx4 v29, s[24:27], s46 offen offset:3072 sc1 lds
    s_add_u32 s46, s46, 16384
    s_cmp_eq_u32 s46, 229376
    s_cselect_b32 s46, 0, s46
    s_add_u32 m0, s48, 0
    s_lshl_b32 s44, s47, 3
    buffer_load_dwordx4 v20, s[68:71], s44 offen offset:0 lds
    buffer_load_dwordx4 v21, s[68:71], s44 offen offset:1024 lds
    buffer_load_dwordx4 v22, s[68:71], s44 offen offset:2048 lds
    buffer_load_dwordx4 v23, s[68:71], s44 offen offset:3072 lds
    s_add_u32 s47, s47, 16384
    s_cmp_eq_u32 s47, 229376
    s_cselect_b32 s47, 0, s47
    buffer_store_dwordx4 v[80:83], v30, s[24:27], s53 offen offset:2048 sc1
    buffer_store_dwordx4 v[80:83], v30, s[24:27], s53 offen offset:3072 sc1
    s_add_u32 s53, s53, 16384
    s_barrier
    s_waitcnt vmcnt(10)
    v_cmp_ne_u32 vcc, 0, v37
    s_or_b32 s57, s57, vcc_lo
    s_add_u32 m0, s48, 49152
    s_lshr_b32 s58, s45, 15
    s_add_u32 s58, s58, 1
    s_bitcmp1_b32 s57, s58
    s_cbranch_scc1 L_tk_17
    s_mov_b32 s87, 0x40000
L_tl_17:
    buffer_load_dword v38, v35, s[24:27], s56 offen sc1
    s_waitcnt vmcnt(0)
    v_cmp_ne_u32 vcc, 0, v38
    s_or_b32 s57, s57, vcc_lo
    s_bitcmp1_b32 s57, s58
    s_cbranch_scc1 L_tj_17
    s_sub_u32 s87, s87, 1
    s_cbranch_scc0 L_tl_17
L_tj_17:
L_tk_17:
    buffer_load_dwordx4 v28, s[24:27], s45 offen offset:0 sc1 lds
    buffer_load_dwordx4 v28, s[24:27], s45 offen offset:1024 sc1 lds
    buffer_load_dwordx4 v28, s[24:27], s45 offen offset:2048 sc1 lds
    buffer_load_dwordx4 v28, s[24:27], s45 offen offset:3072 sc1 lds
    s_add_u32 s45, s45, 16384
    s_cmp_eq_u32 s45, 229376
    s_cselect_b32 s45, 0, s45
    s_add_u32 m0, s48, 131072
    s_lshr_b32 s58, s46, 15
    s_add_u32 s58, s58, 9
    s_bitcmp1_b32 s57, s58
    s_cbranch_scc1 L_tk_18
    s_mov_b32 s87, 0x40000
L_tl_18:
    buffer_load_dword v38, v35, s[24:27], s56 offen sc1
    s_waitcnt vmcnt(0)
    v_cmp_ne_u32 vcc, 0, v38
    s_or_b32 s57, s57, vcc_lo
    s_bitcmp1_b32 s57, s58
    s_cbranch_scc1 L_tj_18
    s_sub_u32 s87, s87, 1
    s_cbranch_scc0 L_tl_18
L_tj_18:
L_tk_18:
    buffer_load_dwordx4 v29, s[24:27], s46 offen offset:0 sc1 lds
    buffer_load_dwordx4 v29, s[24:27], s46 offen offset:1024 sc1 lds
    buffer_load_dwordx4 v29, s[24:27], s46 offen offset:2048 sc1 lds
    buffer_load_dwordx4 v29, s[24:27], s46 offen offset:3072 sc1 lds
    s_add_u32 s46, s46, 16384
    s_cmp_eq_u32 s46, 229376
    s_cselect_b32 s46, 0, s46
    s_barrier
    buffer_load_dword v37, v35, s[24:27], s56 offen sc1
    s_add_u32 m0, s48, 32768
    s_lshl_b32 s44, s47, 3
    buffer_load_dwordx4 v20, s[68:71], s44 offen offset:0 lds
    buffer_load_dwordx4 v21, s[68:71], s44 offen offset:1024 lds
    buffer_load_dwordx4 v22, s[68:71], s44 offen offset:2048 lds
    buffer_load_dwordx4 v23, s[68:71], s44 offen offset:3072 lds
    s_add_u32 s47, s47, 16384
    s_cmp_eq_u32 s47, 229376
    s_cselect_b32 s47, 0, s47
    s_add_u32 m0, s48, 81920
    s_nop 0
    buffer_load_dwordx4 v28, s[24:27], s45 offen offset:0 sc1 lds
    buffer_load_dwordx4 v28, s[24:27], s45 offen offset:1024 sc1 lds
    buffer_load_dwordx4 v28, s[24:27], s45 offen offset:2048 sc1 lds
    buffer_load_dwordx4 v28, s[24:27], s45 offen offset:3072 sc1 lds
    s_add_u32 s45, s45, 16384
    s_cmp_eq_u32 s45, 229376
    s_cselect_b32 s45, 0, s45
    buffer_store_dwordx4 v[80:83], v30, s[24:27], s53 offen offset:0 sc1
    buffer_store_dwordx4 v[80:83], v30, s[24:27], s53 offen offset:1024 sc1
    s_barrier
    s_waitcnt vmcnt(10)
    v_cmp_ne_u32 vcc, 0, v37
    s_or_b32 s57, s57, vcc_lo
    s_add_u32 m0, s48, 65536
    s_nop 0
    buffer_load_dwordx4 v29, s[24:27], s46 offen offset:0 sc1 lds
    buffer_load_dwordx4 v29, s[24:27], s46 offen offset:1024 sc1 lds
    buffer_load_dwordx4 v29, s[24:27], s46 offen offset:2048 sc1 lds
    buffer_load_dwordx4 v29, s[24:27], s46 offen offset:3072 sc1 lds
    s_add_u32 s46, s46, 16384
    s_cmp_eq_u32 s46, 229376
    s_cselect_b32 s46, 0, s46
    s_barrier
    s_add_u32 m0, s48, 98304
    s_lshl_b32 s44, s47, 3
    buffer_load_dwordx4 v20, s[68:71], s44 offen offset:0 lds
    buffer_load_dwordx4 v21, s[68:71], s44 offen offset:1024 lds
    buffer_load_dwordx4 v22, s[68:71], s44 offen offset:2048 lds
    buffer_load_dwordx4 v23, s[68:71], s44 offen offset:3072 lds
    s_add_u32 s47, s47, 16384
    s_cmp_eq_u32 s47, 229376
    s_cselect_b32 s47, 0, s47
    s_add_u32 m0, s48, 114688
    s_lshr_b32 s58, s45, 15
    s_add_u32 s58, s58, 1
    s_bitcmp1_b32 s57, s58
    s_cbranch_scc1 L_tk_19
    s_mov_b32 s87, 0x40000
L_tl_19:
    buffer_load_dword v38, v35, s[24:27], s56 offen sc1
    s_waitcnt vmcnt(0)
    v_cmp_ne_u32 vcc, 0, v38
    s_or_b32 s57, s57, vcc_lo
    s_bitcmp1_b32 s57, s58
    s_cbranch_scc1 L_tj_19
    s_sub_u32 s87, s87, 1
    s_cbranch_scc0 L_tl_19
L_tj_19:
L_tk_19:
    buffer_load_dwordx4 v28, s[24:27], s45 offen offset:0 sc1 lds
    buffer_load_dwordx4 v28, s[24:27], s45 offen offset:1024 sc1 lds
    buffer_load_dwordx4 v28, s[24:27], s45 offen offset:2048 sc1 lds
    buffer_load_dwordx4 v28, s[24:27], s45 offen offset:3072 sc1 lds
    s_add_u32 s45, s45, 16384
    s_cmp_eq_u32 s45, 229376
    s_cselect_b32 s45, 0, s45
    buffer_store_dwordx4 v[80:83], v30, s[24:27], s53 offen offset:2048 sc1
    buffer_store_dwordx4 v[80:83], v30, s[24:27], s53 offen offset:3072 sc1
    s_add_u32 s53, s53, 16384
    s_barrier
    s_add_u32 m0, s48, 16384
    s_lshr_b32 s58, s46, 15
    s_add_u32 s58, s58, 9
    s_bitcmp1_b32 s57, s58
    s_cbranch_scc1 L_tk_20
    s_mov_b32 s87, 0x40000
L_tl_20:
    buffer_load_dword v38, v35, s[24:27], s56 offen sc1
    s_waitcnt vmcnt(0)
    v_cmp_ne_u32 vcc, 0, v38
    s_or_b32 s57, s57, vcc_lo
    s_bitcmp1_b32 s57, s58
    s_cbranch_scc1 L_tj_20
    s_sub_u32 s87, s87, 1
    s_cbranch_scc0 L_tl_20
L_tj_20:
L_tk_20:
    buffer_load_dwordx4 v29, s[24:27], s46 offen offset:0 sc1 lds
    buffer_load_dwordx4 v29, s[24:27], s46 offen offset:1024 sc1 lds
    buffer_load_dwordx4 v29, s[24:27], s46 offen offset:2048 sc1 lds
    buffer_load_dwordx4 v29, s[24:27], s46 offen offset:3072 sc1 lds
    s_add_u32 s46, s46, 16384
    s_cmp_eq_u32 s46, 229376
    s_cselect_b32 s46, 0, s46
    s_barrier
    s_add_u32 m0, s48, 0
    s_lshl_b32 s44, s47, 3
    buffer_load_dwordx4 v20, s[68:71], s44 offen offset:0 lds
    buffer_load_dwordx4 v21, s[68:71], s44 offen offset:1024 lds
    buffer_load_dwordx4 v22, s[68:71], s44 offen offset:2048 lds
    buffer_load_dwordx4 v23, s[68:71], s44 offen offset:3072 lds
    s_add_u32 s47, s47, 16384
    s_cmp_eq_u32 s47, 229376
    s_cselect_b32 s47, 0, s47
    s_add_u32 m0, s48, 49152
    s_nop 0
    buffer_load_dwordx4 v28, s[24:27], s45 offen offset:0 sc1 lds
    buffer_load_dwordx4 v28, s[24:27], s45 offen offset:1024 sc1 lds
    buffer_load_dwordx4 v28, s[24:27], s45 offen offset:2048 sc1 lds
    buffer_load_dwordx4 v28, s[24:27], s45 offen offset:3072 sc1 lds
    s_add_u32 s45, s45, 16384
    s_cmp_eq_u32 s45, 229376
    s_cselect_b32 s45, 0, s45
    s_waitcnt vmcnt(32)
    s_waitcnt vmcnt(28)
    s_barrier
    s_add_u32 m0, s48, 131072
    s_nop 0
    buffer_load_dwordx4 v29, s[24:27], s46 offen offset:0 sc1 lds
    buffer_load_dwordx4 v29, s[24:27], s46 offen offset:1024 sc1 lds
    buffer_load_dwordx4 v29, s[24:27], s46 offen offset:2048 sc1 lds
    buffer_load_dwordx4 v29, s[24:27], s46 offen offset:3072 sc1 lds
    s_add_u32 s46, s46, 16384
    s_cmp_eq_u32 s46, 229376
    s_cselect_b32 s46, 0, s46
    s_waitcnt vmcnt(16)
    s_barrier
    buffer_store_dword v57, v56, s[24:27], s51 offen offset:64 sc1
    s_add_u32 m0, s48, 32768
    s_lshl_b32 s44, s47, 3
    buffer_load_dwordx4 v20, s[68:71], s44 offen offset:0 lds
    buffer_load_dwordx4 v21, s[68:71], s44 offen offset:1024 lds
    buffer_load_dwordx4 v22, s[68:71], s44 offen offset:2048 lds
    buffer_load_dwordx4 v23, s[68:71], s44 offen offset:3072 lds
    s_add_u32 s47, s47, 16384
    s_cmp_eq_u32 s47, 229376
    s_cselect_b32 s47, 0, s47
    s_add_u32 m0, s48, 81920
    s_lshr_b32 s58, s45, 15
    s_add_u32 s58, s58, 1
    s_bitcmp1_b32 s57, s58
    s_cbranch_scc1 L_tk_21
    s_mov_b32 s87, 0x40000
L_tl_21:
    buffer_load_dword v38, v35, s[24:27], s56 offen sc1
    s_waitcnt vmcnt(0)
    v_cmp_ne_u32 vcc, 0, v38
    s_or_b32 s57, s57, vcc_lo
    s_bitcmp1_b32 s57, s58
    s_cbranch_scc1 L_tj_21
    s_sub_u32 s87, s87, 1
    s_cbranch_scc0 L_tl_21
L_tj_21:
L_tk_21:
    buffer_load_dwordx4 v28, s[24:27], s45 offen offset:0 sc1 lds
    buffer_load_dwordx4 v28, s[24:27], s45 offen offset:1024 sc1 lds
    buffer_load_dwordx4 v28, s[24:27], s45 offen offset:2048 sc1 lds
    buffer_load_dwordx4 v28, s[24:27], s45 offen offset:3072 sc1 lds
    s_add_u32 s45, s45, 16384
    s_cmp_eq_u32 s45, 229376
    s_cselect_b32 s45, 0, s45
    s_barrier
    s_add_u32 m0, s48, 65536
    s_lshr_b32 s58, s46, 15
    s_add_u32 s58, s58, 9
    s_bitcmp1_b32 s57, s58
    s_cbranch_scc1 L_tk_22
    s_mov_b32 s87, 0x40000
L_tl_22:
    buffer_load_dword v38, v35, s[24:27], s56 offen sc1
    s_waitcnt vmcnt(0)
    v_cmp_ne_u32 vcc, 0, v38
    s_or_b32 s57, s57, vcc_lo
    s_bitcmp1_b32 s57, s58
    s_cbranch_scc1 L_tj_22
    s_sub_u32 s87, s87, 1
    s_cbranch_scc0 L_tl_22
L_tj_22:
L_tk_22:
    buffer_load_dwordx4 v29, s[24:27], s46 offen offset:0 sc1 lds
    buffer_load_dwordx4 v29, s[24:27], s46 offen offset:1024 sc1 lds
    buffer_load_dwordx4 v29, s[24:27], s46 offen offset:2048 sc1 lds
    buffer_load_dwordx4 v29, s[24:27], s46 offen offset:3072 sc1 lds
    s_add_u32 s46, s46, 16384
    s_cmp_eq_u32 s46, 229376
    s_cselect_b32 s46, 0, s46
    s_waitcnt vmcnt(25)
    s_barrier
    s_add_u32 m0, s48, 98304
    s_lshl_b32 s44, s47, 3
    buffer_load_dwordx4 v20, s[68:71], s44 offen offset:0 lds
    buffer_load_dwordx4 v21, s[68:71], s44 offen offset:1024 lds
    buffer_load_dwordx4 v22, s[68:71], s44 offen offset:2048 lds
    buffer_load_dwordx4 v23, s[68:71], s44 offen offset:3072 lds
    s_add_u32 s47, s47, 16384
    s_cmp_eq_u32 s47, 229376
    s_cselect_b32 s47, 0, s47
    s_add_u32 m0, s48, 114688
    s_nop 0
    buffer_load_dwordx4 v28, s[24:27], s45 offen offset:0 sc1 lds
    buffer_load_dwordx4 v28, s[24:27], s45 offen offset:1024 sc1 lds
    buffer_load_dwordx4 v28, s[24:27], s45 offen offset:2048 sc1 lds
    buffer_load_dwordx4 v28, s[24:27], s45 offen offset:3072 sc1 lds
    s_add_u32 s45, s45, 16384
    s_cmp_eq_u32 s45, 229376
    s_cselect_b32 s45, 0, s45
    s_waitcnt vmcnt(29)
    s_waitcnt vmcnt(25)
    s_barrier
    s_add_u32 m0, s48, 16384
    s_nop 0
    buffer_load_dwordx4 v29, s[24:27], s46 offen offset:0 sc1 lds
    buffer_load_dwordx4 v29, s[24:27], s46 offen offset:1024 sc1 lds
    buffer_load_dwordx4 v29, s[24:27], s46 offen offset:2048 sc1 lds
    buffer_load_dwordx4 v29, s[24:27], s46 offen offset:3072 sc1 lds
    s_add_u32 s46, s46, 16384
    s_cmp_eq_u32 s46, 229376
    s_cselect_b32 s46, 0, s46
    s_waitcnt vmcnt(25)
    s_branch L_p_join
L_rr_00:
    s_sub_u32 s87, s87, 1
    s_cbranch_scc1 L_rk_00
    buffer_load_dwordx4 v[136:139], v20, s[24:27], s55 offen offset:0 sc1
    buffer_load_dwordx4 v[140:143], v20, s[24:27], s56 offen offset:0 sc1
    buffer_load_dwordx4 v[152:155], v20, s[24:27], s57 offen offset:0 sc1
    buffer_load_dwordx4 v[156:159], v20, s[24:27], s55 offen offset:1024 sc1
    buffer_load_dwordx4 v[160:163], v20, s[24:27], s56 offen offset:1024 sc1
    buffer_load_dwordx4 v[164:167], v20, s[24:27], s57 offen offset:1024 sc1
    s_waitcnt vmcnt(0)
    s_branch L_rv_00
L_rr_01:
    s_sub_u32 s87, s87, 1
    s_cbranch_scc1 L_rk_01
    buffer_load_dwordx4 v[156:159], v20, s[24:27], s55 offen offset:1024 sc1
    buffer_load_dwordx4 v[160:163], v20, s[24:27], s56 offen offset:1024 sc1
    buffer_load_dwordx4 v[164:167], v20, s[24:27], s57 offen offset:1024 sc1
    s_waitcnt vmcnt(0)
    s_branch L_rv_01
L_rr_10:
    s_sub_u32 s87, s87, 1
    s_cbranch_scc1 L_rk_10
    buffer_load_dwordx4 v[168:171], v20, s[24:27], s55 offen offset:2048 sc1
    buffer_load_dwordx4 v[172:175], v20, s[24:27], s56 offen offset:2048 sc1
    buffer_load_dwordx4 v[176:179], v20, s[24:27], s57 offen offset:2048 sc1
    buffer_load_dwordx4 v[180:183], v20, s[24:27], s55 offen offset:3072 sc1
    buffer_load_dwordx4 v[184:187], v20, s[24:27], s56 offen offset:3072 sc1
    buffer_load_dwordx4 v[188:191], v20, s[24:27], s57 offen offset:3072 sc1
    s_waitcnt vmcnt(0)
    s_branch L_rv_10
L_rr_11:
    s_sub_u32 s87, s87, 1
    s_cbranch_scc1 L_rk_11
    buffer_load_dwordx4 v[180:183], v20, s[24:27], s55 offen offset:3072 sc1
    buffer_load_dwordx4 v[184:187], v20, s[24:27], s56 offen offset:3072 sc1
    buffer_load_dwordx4 v[188:191], v20, s[24:27], s57 offen offset:3072 sc1
    s_waitcnt vmcnt(0)
    s_branch L_rv_11
L_fin:
L_end:
    s_endpgm
.section .rodata,"a"
.p2align 6
.amdhsa_kernel pk_kernel
  .amdhsa_next_free_vgpr 256
  .amdhsa_next_free_sgpr 102
  .amdhsa_accum_offset 256
  .amdhsa_group_segment_fixed_size 0
  .amdhsa_kernarg_size 88
  .amdhsa_user_sgpr_count 2
  .amdhsa_user_sgpr_kernarg_segment_ptr 1
  .amdhsa_system_sgpr_workgroup_id_x 1
.end_amdhsa_kernel
```
